```python
import torch

def _softmax(x, axis=-1):
    return torch.softmax(x, dim=axis)
def _gelu(x):
    return torch.nn.functional.gelu(x, approximate="tanh")
def _silu(x):
    return torch.nn.functional.silu(x)
def _sigmoid(x):
    return torch.sigmoid(x)
def _layernorm(x, axis=-1, eps=1e-5):
    m = x.mean(dim=axis, keepdim=True)
    v = x.var(dim=axis, keepdim=True, unbiased=False)
    return (x - m) / torch.sqrt(v + eps)
def _scatter_add(tgt, idx, src, axis=0):
    return tgt.clone().index_add_(axis, idx, src)
def _segment_sum(src, seg, n):
    out = torch.zeros((n,) + src.shape[1:], dtype=src.dtype)
    return out.index_add_(0, seg, src)
def _pad(x, pw):
    flat = tuple(v for pair in reversed(pw) for v in pair)
    return torch.nn.functional.pad(x, flat)

kernel_name = 'parallel_sum__mha_block__glu_gated_geglu__prompt'

def setup_inputs():

    _w = (lambda a: (lambda t: t.to(torch.bfloat16) if t.is_floating_point() else t)(torch.as_tensor(a)))
    def _A_setup():
        B, S, D, H = 1, 2048, 640, 32
        return {
            "x": _w((lambda *s: torch.randn(*s, dtype=torch.bfloat16) * 0.05)(B, S, D)),
            "wqkv": _w((lambda *s: torch.randn(*s, dtype=torch.bfloat16) * 0.05)(D, 3 * D)),
            "wo": _w((lambda *s: torch.randn(*s, dtype=torch.bfloat16) * 0.05)(D, D)),
        }
    _A_in = _A_setup()

    def _B_setup():
        B, S, Dm, Df = 1, 2048, 640, 1728
        return {
            "x": _w((lambda *s: torch.randn(*s, dtype=torch.bfloat16) * 0.05)(B, S, Dm)),
            "w_gate": _w((lambda *s: torch.randn(*s, dtype=torch.bfloat16) * 0.8)(Dm, Df) * (Dm ** -0.5)),
            "w_up": _w((lambda *s: torch.randn(*s, dtype=torch.bfloat16) * 0.8)(Dm, Df) * (Dm ** -0.5)),
            "w_down": _w((lambda *s: torch.randn(*s, dtype=torch.bfloat16) * 0.8)(Df, Dm) * (Df ** -0.5)),
        }
    _B_in = _B_setup()

    return {
        "A_x": _A_in["x"],
        "A_wqkv": _A_in["wqkv"],
        "A_wo": _A_in["wo"],
        "B_x": _B_in["x"],
        "B_w_gate": _B_in["w_gate"],
        "B_w_up": _B_in["w_up"],
        "B_w_down": _B_in["w_down"],
    }

def reference(A_x, A_wqkv, A_wo, B_x, B_w_gate, B_w_up, B_w_down):
    def _A_ref(x, wqkv, wo):
        B, S, D = x.shape
        H = 32
        Dh = D // H
        qkv = (lambda x, *d: x.permute(*d))((x @ wqkv).reshape(B, S, 3, H, Dh), 2, 0, 3, 1, 4)
        q, k, v = qkv[0], qkv[1], qkv[2]
        scores = torch.einsum("bhqd,bhkd->bhqk", q, k) * (Dh ** -0.5)
        p = _softmax(scores, axis=-1)
        o = torch.einsum("bhqk,bhkd->bhqd", p, v)
        return (lambda x, *d: x.permute(*d))(o, 0, 2, 1, 3).reshape(B, S, D) @ wo

    def _B_ref(x, w_gate, w_up, w_down):
        g = torch.einsum("bsd,df->bsf", x, w_gate)
        u = torch.einsum("bsd,df->bsf", x, w_up)
        h = _gelu(g) * u
        return torch.einsum("bsf,fd->bsd", h, w_down)

    x = A_x
    xn = _layernorm(x, axis=-1)
    return x + _A_ref(xn, A_wqkv, A_wo) + _B_ref(xn, B_w_gate, B_w_up, B_w_down)
```

```asm
; @launch kernel=ln_kernel grid=(512,1,1) block=(256,1,1) lds=0
; @launch kernel=gemm1_kernel grid=(256,1,1) block=(512,1,1) lds=114688
; @launch kernel=attn_kernel grid=(416,1,1) block=(512,1,1) lds=65536
; @launch kernel=gemm2_kernel grid=(160,1,1) block=(256,1,1) lds=65536
.amdgcn_target "amdgcn-amd-amdhsa--gfx950"
.text
.globl ln_kernel
.p2align 8
.type ln_kernel,@function
ln_kernel:
    s_cmp_ge_u32 s2, 512
    s_cbranch_scc1 ln_end
    s_load_dwordx2 s[4:5], s[0:1], 0
    s_load_dwordx2 s[6:7], s[0:1], 72
    v_lshrrev_b32 v1, 6, v0
    v_and_b32 v2, 63, v0
    s_nop 0
    v_readfirstlane_b32 s8, v1
    s_lshl_b32 s9, s2, 2
    s_add_u32 s9, s9, s8
    s_mul_i32 s10, s9, 1280
    s_waitcnt lgkmcnt(0)
    s_mov_b32 s12, s4
    s_and_b32 s13, s5, 0xffff
    s_mov_b32 s14, 2621440
    s_mov_b32 s15, 0x00020000
    s_mov_b32 s16, s6
    s_and_b32 s17, s7, 0xffff
    s_mov_b32 s18, 268435456
    s_mov_b32 s19, 0x00020000
    v_lshlrev_b32 v3, 2, v2
    buffer_load_dword v10, v3, s[12:15], s10 offen offset:0
    buffer_load_dword v11, v3, s[12:15], s10 offen offset:256
    buffer_load_dword v12, v3, s[12:15], s10 offen offset:512
    buffer_load_dword v13, v3, s[12:15], s10 offen offset:768
    buffer_load_dword v14, v3, s[12:15], s10 offen offset:1024
    s_waitcnt vmcnt(0)
    v_lshlrev_b32 v20, 16, v10
    v_and_b32 v21, 0xffff0000, v10
    v_lshlrev_b32 v22, 16, v11
    v_and_b32 v23, 0xffff0000, v11
    v_lshlrev_b32 v24, 16, v12
    v_and_b32 v25, 0xffff0000, v12
    v_lshlrev_b32 v26, 16, v13
    v_and_b32 v27, 0xffff0000, v13
    v_lshlrev_b32 v28, 16, v14
    v_and_b32 v29, 0xffff0000, v14
    v_add_f32 v30, v20, v21
    v_add_f32 v30, v30, v22
    v_add_f32 v30, v30, v23
    v_add_f32 v30, v30, v24
    v_add_f32 v30, v30, v25
    v_add_f32 v30, v30, v26
    v_add_f32 v30, v30, v27
    v_add_f32 v30, v30, v28
    v_add_f32 v30, v30, v29
    v_xor_b32 v41, 1, v2
    v_lshlrev_b32 v41, 2, v41
    ds_bpermute_b32 v40, v41, v30
    s_waitcnt lgkmcnt(0)
    v_add_f32 v30, v30, v40
    v_xor_b32 v41, 2, v2
    v_lshlrev_b32 v41, 2, v41
    ds_bpermute_b32 v40, v41, v30
    s_waitcnt lgkmcnt(0)
    v_add_f32 v30, v30, v40
    v_xor_b32 v41, 4, v2
    v_lshlrev_b32 v41, 2, v41
    ds_bpermute_b32 v40, v41, v30
    s_waitcnt lgkmcnt(0)
    v_add_f32 v30, v30, v40
    v_xor_b32 v41, 8, v2
    v_lshlrev_b32 v41, 2, v41
    ds_bpermute_b32 v40, v41, v30
    s_waitcnt lgkmcnt(0)
    v_add_f32 v30, v30, v40
    v_xor_b32 v41, 16, v2
    v_lshlrev_b32 v41, 2, v41
    ds_bpermute_b32 v40, v41, v30
    s_waitcnt lgkmcnt(0)
    v_add_f32 v30, v30, v40
    v_xor_b32 v41, 32, v2
    v_lshlrev_b32 v41, 2, v41
    ds_bpermute_b32 v40, v41, v30
    s_waitcnt lgkmcnt(0)
    v_add_f32 v30, v30, v40
    v_mul_f32 v31, 0x3acccccd, v30
    v_mov_b32 v32, 0
    v_sub_f32 v33, v20, v31
    v_fmac_f32 v32, v33, v33
    v_sub_f32 v33, v21, v31
    v_fmac_f32 v32, v33, v33
    v_sub_f32 v33, v22, v31
    v_fmac_f32 v32, v33, v33
    v_sub_f32 v33, v23, v31
    v_fmac_f32 v32, v33, v33
    v_sub_f32 v33, v24, v31
    v_fmac_f32 v32, v33, v33
    v_sub_f32 v33, v25, v31
    v_fmac_f32 v32, v33, v33
    v_sub_f32 v33, v26, v31
    v_fmac_f32 v32, v33, v33
    v_sub_f32 v33, v27, v31
    v_fmac_f32 v32, v33, v33
    v_sub_f32 v33, v28, v31
    v_fmac_f32 v32, v33, v33
    v_sub_f32 v33, v29, v31
    v_fmac_f32 v32, v33, v33
    v_xor_b32 v41, 1, v2
    v_lshlrev_b32 v41, 2, v41
    ds_bpermute_b32 v40, v41, v32
    s_waitcnt lgkmcnt(0)
    v_add_f32 v32, v32, v40
    v_xor_b32 v41, 2, v2
    v_lshlrev_b32 v41, 2, v41
    ds_bpermute_b32 v40, v41, v32
    s_waitcnt lgkmcnt(0)
    v_add_f32 v32, v32, v40
    v_xor_b32 v41, 4, v2
    v_lshlrev_b32 v41, 2, v41
    ds_bpermute_b32 v40, v41, v32
    s_waitcnt lgkmcnt(0)
    v_add_f32 v32, v32, v40
    v_xor_b32 v41, 8, v2
    v_lshlrev_b32 v41, 2, v41
    ds_bpermute_b32 v40, v41, v32
    s_waitcnt lgkmcnt(0)
    v_add_f32 v32, v32, v40
    v_xor_b32 v41, 16, v2
    v_lshlrev_b32 v41, 2, v41
    ds_bpermute_b32 v40, v41, v32
    s_waitcnt lgkmcnt(0)
    v_add_f32 v32, v32, v40
    v_xor_b32 v41, 32, v2
    v_lshlrev_b32 v41, 2, v41
    ds_bpermute_b32 v40, v41, v32
    s_waitcnt lgkmcnt(0)
    v_add_f32 v32, v32, v40
    v_mul_f32 v32, 0x3acccccd, v32
    v_cvt_pk_bf16_f32 v34, v31, v31
    v_lshlrev_b32 v34, 16, v34
    v_cvt_pk_bf16_f32 v35, v32, v32
    v_lshlrev_b32 v35, 16, v35
    v_add_f32 v35, 0x3727c5ac, v35
    v_cvt_pk_bf16_f32 v35, v35, v35
    v_lshlrev_b32 v35, 16, v35
    v_sqrt_f32 v35, v35
    s_nop 0
    v_cvt_pk_bf16_f32 v35, v35, v35
    v_lshlrev_b32 v35, 16, v35
    v_rcp_f32 v36, v35
    s_nop 0
    v_sub_f32 v20, v20, v34
    v_cvt_pk_bf16_f32 v20, v20, v20
    v_lshlrev_b32 v20, 16, v20
    v_mul_f32 v37, v20, v36
    v_fma_f32 v38, -v37, v35, v20
    v_fma_f32 v20, v38, v36, v37
    v_sub_f32 v21, v21, v34
    v_cvt_pk_bf16_f32 v21, v21, v21
    v_lshlrev_b32 v21, 16, v21
    v_mul_f32 v37, v21, v36
    v_fma_f32 v38, -v37, v35, v21
    v_fma_f32 v21, v38, v36, v37
    v_sub_f32 v22, v22, v34
    v_cvt_pk_bf16_f32 v22, v22, v22
    v_lshlrev_b32 v22, 16, v22
    v_mul_f32 v37, v22, v36
    v_fma_f32 v38, -v37, v35, v22
    v_fma_f32 v22, v38, v36, v37
    v_sub_f32 v23, v23, v34
    v_cvt_pk_bf16_f32 v23, v23, v23
    v_lshlrev_b32 v23, 16, v23
    v_mul_f32 v37, v23, v36
    v_fma_f32 v38, -v37, v35, v23
    v_fma_f32 v23, v38, v36, v37
    v_sub_f32 v24, v24, v34
    v_cvt_pk_bf16_f32 v24, v24, v24
    v_lshlrev_b32 v24, 16, v24
    v_mul_f32 v37, v24, v36
    v_fma_f32 v38, -v37, v35, v24
    v_fma_f32 v24, v38, v36, v37
    v_sub_f32 v25, v25, v34
    v_cvt_pk_bf16_f32 v25, v25, v25
    v_lshlrev_b32 v25, 16, v25
    v_mul_f32 v37, v25, v36
    v_fma_f32 v38, -v37, v35, v25
    v_fma_f32 v25, v38, v36, v37
    v_sub_f32 v26, v26, v34
    v_cvt_pk_bf16_f32 v26, v26, v26
    v_lshlrev_b32 v26, 16, v26
    v_mul_f32 v37, v26, v36
    v_fma_f32 v38, -v37, v35, v26
    v_fma_f32 v26, v38, v36, v37
    v_sub_f32 v27, v27, v34
    v_cvt_pk_bf16_f32 v27, v27, v27
    v_lshlrev_b32 v27, 16, v27
    v_mul_f32 v37, v27, v36
    v_fma_f32 v38, -v37, v35, v27
    v_fma_f32 v27, v38, v36, v37
    v_sub_f32 v28, v28, v34
    v_cvt_pk_bf16_f32 v28, v28, v28
    v_lshlrev_b32 v28, 16, v28
    v_mul_f32 v37, v28, v36
    v_fma_f32 v38, -v37, v35, v28
    v_fma_f32 v28, v38, v36, v37
    v_sub_f32 v29, v29, v34
    v_cvt_pk_bf16_f32 v29, v29, v29
    v_lshlrev_b32 v29, 16, v29
    v_mul_f32 v37, v29, v36
    v_fma_f32 v38, -v37, v35, v29
    v_fma_f32 v29, v38, v36, v37
    v_cvt_pk_bf16_f32 v10, v20, v21
    v_cvt_pk_bf16_f32 v11, v22, v23
    v_cvt_pk_bf16_f32 v12, v24, v25
    v_cvt_pk_bf16_f32 v13, v26, v27
    v_cvt_pk_bf16_f32 v14, v28, v29
    buffer_store_dword v10, v3, s[16:19], s10 offen offset:0
    buffer_store_dword v11, v3, s[16:19], s10 offen offset:256
    buffer_store_dword v12, v3, s[16:19], s10 offen offset:512
    buffer_store_dword v13, v3, s[16:19], s10 offen offset:768
    buffer_store_dword v14, v3, s[16:19], s10 offen offset:1024
    v_lshlrev_b32 v4, 17, v2
    s_lshl_b32 s11, s9, 6
    s_add_u32 s11, s11, 7340072
    v_mov_b32 v6, 0x3f80
    v_mov_b32 v7, 0
    v_mov_b32 v8, 0
    v_mov_b32 v9, 0
    v_cmp_gt_u32 vcc, 32, v2
    s_and_saveexec_b64 s[20:21], vcc
    buffer_store_dwordx2 v[6:7], v4, s[16:19], s11 offen
    buffer_store_dwordx2 v[8:9], v4, s[16:19], s11 offen offset:8
    buffer_store_dwordx2 v[8:9], v4, s[16:19], s11 offen offset:16
    s_mov_b64 exec, s[20:21]
    s_lshr_b32 s22, s9, 6
    s_and_b32 s23, s9, 63
    s_mul_i32 s23, s23, 48
    s_lshl_b32 s22, s22, 17
    s_add_u32 s22, s22, 11616256
    v_add_u32 v4, s23, v2
    v_mov_b32 v5, 0x3f803f80
    v_cmp_gt_u32 vcc, 256, v4
    s_nop 1
    v_cndmask_b32 v6, 0, v5, vcc
    v_mov_b32 v7, v6
    v_mov_b32 v8, v6
    v_mov_b32 v9, v6
    v_lshlrev_b32 v4, 4, v4
    v_cmp_gt_u32 vcc, 48, v2
    s_and_saveexec_b64 s[20:21], vcc
    buffer_store_dwordx4 v[6:9], v4, s[16:19], s22 offen
    s_mov_b64 exec, s[20:21]
ln_end:
    s_endpgm
.globl gemm1_kernel
.p2align 8
.type gemm1_kernel,@function
gemm1_kernel:
    s_cmp_ge_u32 s2, 256
    s_cbranch_scc1 g1_end
    s_load_dwordx2 s[4:5], s[0:1], 8
    s_load_dwordx2 s[6:7], s[0:1], 72
    s_load_dwordx4 s[24:27], s[0:1], 32
    v_and_b32 v20, 63, v0
    v_lshrrev_b32 v1, 6, v0
    s_nop 0
    v_readfirstlane_b32 s20, v1
    s_lshr_b32 s21, s20, 1
    s_and_b32 s22, s20, 1
    s_lshl_b32 s38, s20, 10
    s_and_b32 s3, s2, 7
    s_lshr_b32 s46, s2, 3
    s_lshr_b32 s47, s46, 3
    s_lshl_b32 s47, s47, 3
    s_add_u32 s47, s47, s3
    s_and_b32 s46, s46, 7
    s_cmp_ge_u32 s47, 28
    s_cbranch_scc1 g1_end
    s_waitcnt lgkmcnt(0)
    s_mov_b32 s8, s6
    s_and_b32 s9, s7, 0xffff
    s_mov_b32 s10, 268435456
    s_mov_b32 s11, 0x00020000
    s_cmp_lt_u32 s47, 10
    s_cbranch_scc1 g1_qkv
    s_mov_b32 s12, s24
    s_and_b32 s13, s25, 0xffff
    s_mov_b32 s14, 2211840
    s_mov_b32 s15, 0x00020000
    s_mov_b32 s16, s26
    s_and_b32 s17, s27, 0xffff
    s_mov_b32 s18, 2211840
    s_mov_b32 s19, 0x00020000
    s_sub_u32 s4, s47, 10
    s_mul_i32 s6, s4, 192
    s_mov_b32 s7, s6
    s_mov_b32 s44, 3456
    s_mov_b32 s45, 2
    s_branch g1_common
g1_qkv:
    s_mov_b32 s12, s4
    s_and_b32 s13, s5, 0xffff
    s_mov_b32 s14, 2457600
    s_mov_b32 s15, 0x00020000
    s_mov_b32 s16, s4
    s_and_b32 s17, s5, 0xffff
    s_mov_b32 s18, 2457600
    s_mov_b32 s19, 0x00020000
    s_mov_b32 s4, s47
    s_mul_i32 s6, s4, 384
    s_add_u32 s7, s6, 192
    s_mov_b32 s44, 3840
    s_mov_b32 s45, 0
g1_common:
    s_lshl_b32 s23, s46, 8
    v_and_b32 v1, 15, v20
    s_lshl_b32 s3, s21, 6
    v_add_u32 v1, s3, v1
    v_lshlrev_b32 v1, 6, v1
    v_bfe_u32 v2, v20, 2, 2
    v_sub_u32 v2, 4, v2
    v_and_b32 v2, 3, v2
    v_lshrrev_b32 v3, 4, v20
    v_xor_b32 v2, v2, v3
    v_lshl_add_u32 v16, v2, 4, v1
    v_lshrrev_b32 v1, 4, v20
    v_lshlrev_b32 v1, 3, v1
    v_bfe_u32 v2, v20, 2, 2
    v_add_u32 v1, v1, v2
    v_lshlrev_b32 v1, 6, v1
    v_bfe_u32 v2, v20, 1, 1
    v_add_u32 v2, 0, v2
    v_bfe_u32 v3, v20, 4, 1
    v_lshlrev_b32 v3, 1, v3
    v_xor_b32 v2, v2, v3
    v_lshl_add_u32 v1, v2, 4, v1
    v_and_b32 v2, 1, v20
    v_lshl_add_u32 v1, v2, 3, v1
    v_add_u32 v21, 16384, v1
    v_lshrrev_b32 v1, 4, v20
    v_lshlrev_b32 v1, 3, v1
    v_bfe_u32 v2, v20, 2, 2
    v_add_u32 v1, v1, v2
    v_lshlrev_b32 v1, 6, v1
    v_bfe_u32 v2, v20, 1, 1
    v_add_u32 v2, 2, v2
    v_bfe_u32 v3, v20, 4, 1
    v_lshlrev_b32 v3, 1, v3
    v_xor_b32 v2, v2, v3
    v_lshl_add_u32 v1, v2, 4, v1
    v_and_b32 v2, 1, v20
    v_lshl_add_u32 v1, v2, 3, v1
    v_add_u32 v22, 16384, v1
    v_add_u32 v23, 57344, v16
    v_add_u32 v29, 57344, v21
    v_add_u32 v30, 57344, v22
    v_add_u32 v31, 114688, v16
    v_add_u32 v32, 114688, v21
    v_add_u32 v33, 114688, v22
    v_lshrrev_b32 v1, 2, v20
    s_movk_i32 s3, 1280
    v_mul_lo_u32 v1, v1, s3
    v_bfe_u32 v2, v20, 4, 2
    v_sub_u32 v2, 4, v2
    v_and_b32 v2, 3, v2
    v_and_b32 v3, 3, v20
    v_xor_b32 v2, v2, v3
    v_lshl_add_u32 v18, v2, 4, v1
    v_lshrrev_b32 v1, 2, v20
    v_mul_lo_u32 v1, v1, s44
    v_lshrrev_b32 v2, 5, v20
    v_lshlrev_b32 v2, 1, v2
    v_and_b32 v3, 3, v20
    v_xor_b32 v2, v2, v3
    v_lshl_add_u32 v19, v2, 4, v1
    s_lshl_b32 s3, s20, 4
    s_add_u32 s3, s3, 0
    s_add_u32 s3, s3, s23
    s_mul_i32 s28, s3, 1280
    s_lshl_b32 s3, s20, 4
    s_add_u32 s3, s3, 128
    s_add_u32 s3, s3, s23
    s_mul_i32 s29, s3, 1280
    s_lshr_b32 s3, s20, 1
    s_and_b32 s48, s20, 1
    s_lshl_b32 s48, s48, 4
    s_mul_i32 s48, s48, s44
    s_cmp_ge_u32 s3, 3
    s_cselect_b32 s49, s7, s6
    s_cselect_b32 s50, 3, 0
    s_sub_u32 s50, s3, s50
    s_lshl_b32 s50, s50, 6
    s_add_u32 s49, s49, s50
    s_add_u32 s30, s49, s48
    s_add_u32 s50, s3, 1
    s_lshl_b32 s50, s50, 6
    s_add_u32 s49, s7, s50
    s_add_u32 s31, s49, s48
    s_lshl_b32 s36, s44, 5
    s_cmp_ge_u32 s3, 3
    s_cselect_b32 s52, s16, s12
    s_cselect_b32 s53, s17, s13
    s_mov_b32 s54, s14
    s_mov_b32 s55, 0x00020000
    v_mov_b32 v144, 0
    v_mov_b32 v145, 0
    v_mov_b32 v146, 0
    v_mov_b32 v147, 0
    v_mov_b32 v148, 0
    v_mov_b32 v149, 0
    v_mov_b32 v150, 0
    v_mov_b32 v151, 0
    v_mov_b32 v152, 0
    v_mov_b32 v153, 0
    v_mov_b32 v154, 0
    v_mov_b32 v155, 0
    v_mov_b32 v156, 0
    v_mov_b32 v157, 0
    v_mov_b32 v158, 0
    v_mov_b32 v159, 0
    v_mov_b32 v160, 0
    v_mov_b32 v161, 0
    v_mov_b32 v162, 0
    v_mov_b32 v163, 0
    v_mov_b32 v164, 0
    v_mov_b32 v165, 0
    v_mov_b32 v166, 0
    v_mov_b32 v167, 0
    v_mov_b32 v168, 0
    v_mov_b32 v169, 0
    v_mov_b32 v170, 0
    v_mov_b32 v171, 0
    v_mov_b32 v172, 0
    v_mov_b32 v173, 0
    v_mov_b32 v174, 0
    v_mov_b32 v175, 0
    v_mov_b32 v176, 0
    v_mov_b32 v177, 0
    v_mov_b32 v178, 0
    v_mov_b32 v179, 0
    v_mov_b32 v180, 0
    v_mov_b32 v181, 0
    v_mov_b32 v182, 0
    v_mov_b32 v183, 0
    v_mov_b32 v184, 0
    v_mov_b32 v185, 0
    v_mov_b32 v186, 0
    v_mov_b32 v187, 0
    v_mov_b32 v188, 0
    v_mov_b32 v189, 0
    v_mov_b32 v190, 0
    v_mov_b32 v191, 0
    v_mov_b32 v192, 0
    v_mov_b32 v193, 0
    v_mov_b32 v194, 0
    v_mov_b32 v195, 0
    v_mov_b32 v196, 0
    v_mov_b32 v197, 0
    v_mov_b32 v198, 0
    v_mov_b32 v199, 0
    v_mov_b32 v200, 0
    v_mov_b32 v201, 0
    v_mov_b32 v202, 0
    v_mov_b32 v203, 0
    v_mov_b32 v204, 0
    v_mov_b32 v205, 0
    v_mov_b32 v206, 0
    v_mov_b32 v207, 0
    v_mov_b32 v208, 0
    v_mov_b32 v209, 0
    v_mov_b32 v210, 0
    v_mov_b32 v211, 0
    v_mov_b32 v212, 0
    v_mov_b32 v213, 0
    v_mov_b32 v214, 0
    v_mov_b32 v215, 0
    v_mov_b32 v216, 0
    v_mov_b32 v217, 0
    v_mov_b32 v218, 0
    v_mov_b32 v219, 0
    v_mov_b32 v220, 0
    v_mov_b32 v221, 0
    v_mov_b32 v222, 0
    v_mov_b32 v223, 0
    v_mov_b32 v224, 0
    v_mov_b32 v225, 0
    v_mov_b32 v226, 0
    v_mov_b32 v227, 0
    v_mov_b32 v228, 0
    v_mov_b32 v229, 0
    v_mov_b32 v230, 0
    v_mov_b32 v231, 0
    v_mov_b32 v232, 0
    v_mov_b32 v233, 0
    v_mov_b32 v234, 0
    v_mov_b32 v235, 0
    v_mov_b32 v236, 0
    v_mov_b32 v237, 0
    v_mov_b32 v238, 0
    v_mov_b32 v239, 0
    s_cmp_eq_u32 s22, 1
    s_cbranch_scc1 g1_wn1
    s_add_u32 m0, s38, 0
    s_nop 0
    buffer_load_dwordx4 v18, s[8:11], s28 offen lds
    s_add_u32 m0, s38, 8192
    s_nop 0
    buffer_load_dwordx4 v18, s[8:11], s29 offen lds
    s_add_u32 m0, s38, 16384
    s_nop 0
    buffer_load_dwordx4 v19, s[52:55], s30 offen lds
    s_cmp_ge_u32 s20, 4
    s_cbranch_scc1 g1_skipg1ap0
    s_add_u32 m0, s38, 24576
    s_nop 0
    buffer_load_dwordx4 v19, s[16:19], s31 offen lds
g1_skipg1ap0:
    s_add_u32 s28, s28, 64
    s_add_u32 s29, s29, 64
    s_add_u32 s30, s30, s36
    s_add_u32 s31, s31, s36
    s_add_u32 m0, s38, 28672
    s_nop 0
    buffer_load_dwordx4 v18, s[8:11], s28 offen lds
    s_add_u32 m0, s38, 36864
    s_nop 0
    buffer_load_dwordx4 v18, s[8:11], s29 offen lds
    s_add_u32 m0, s38, 45056
    s_nop 0
    buffer_load_dwordx4 v19, s[52:55], s30 offen lds
    s_cmp_ge_u32 s20, 4
    s_cbranch_scc1 g1_skipg1ap1
    s_add_u32 m0, s38, 53248
    s_nop 0
    buffer_load_dwordx4 v19, s[16:19], s31 offen lds
g1_skipg1ap1:
    s_add_u32 s28, s28, 64
    s_add_u32 s29, s29, 64
    s_add_u32 s30, s30, s36
    s_add_u32 s31, s31, s36
    s_add_u32 m0, s38, 57344
    s_nop 0
    buffer_load_dwordx4 v18, s[8:11], s28 offen lds
    s_add_u32 m0, s38, 65536
    s_nop 0
    buffer_load_dwordx4 v18, s[8:11], s29 offen lds
    s_add_u32 m0, s38, 73728
    s_nop 0
    buffer_load_dwordx4 v19, s[52:55], s30 offen lds
    s_cmp_ge_u32 s20, 4
    s_cbranch_scc1 g1_skipg1ap2
    s_add_u32 m0, s38, 81920
    s_nop 0
    buffer_load_dwordx4 v19, s[16:19], s31 offen lds
g1_skipg1ap2:
    s_add_u32 s28, s28, 64
    s_add_u32 s29, s29, 64
    s_add_u32 s30, s30, s36
    s_add_u32 s31, s31, s36
    s_waitcnt vmcnt(6)
    s_barrier
    ds_read_b128 v[64:67], v16 offset:0
    ds_read_b128 v[68:71], v16 offset:1024
    ds_read_b128 v[72:75], v16 offset:2048
    ds_read_b128 v[76:79], v16 offset:3072
    ds_read_b64_tr_b16 v[96:97], v21 offset:0
    ds_read_b64_tr_b16 v[98:99], v21 offset:256
    ds_read_b64_tr_b16 v[100:101], v22 offset:0
    ds_read_b64_tr_b16 v[102:103], v22 offset:256
    ds_read_b64_tr_b16 v[104:105], v21 offset:2048
    ds_read_b64_tr_b16 v[106:107], v21 offset:2304
    ds_read_b64_tr_b16 v[108:109], v21 offset:6144
    ds_read_b64_tr_b16 v[110:111], v21 offset:6400
    ds_read_b64_tr_b16 v[112:113], v22 offset:6144
    ds_read_b64_tr_b16 v[114:115], v22 offset:6400
    ds_read_b64_tr_b16 v[116:117], v21 offset:8192
    ds_read_b64_tr_b16 v[118:119], v21 offset:8448
    s_waitcnt lgkmcnt(0)
    s_waitcnt vmcnt(3)
    s_barrier
    s_add_u32 m0, s38, 86016
    s_nop 0
    buffer_load_dwordx4 v18, s[8:11], s28 offen lds
    s_add_u32 m0, s38, 94208
    s_nop 0
    buffer_load_dwordx4 v18, s[8:11], s29 offen lds
    s_add_u32 m0, s38, 102400
    s_nop 0
    buffer_load_dwordx4 v19, s[52:55], s30 offen lds
    s_cmp_ge_u32 s20, 4
    s_cbranch_scc1 g1_skipg1au0
    s_add_u32 m0, s38, 110592
    s_nop 0
    buffer_load_dwordx4 v19, s[16:19], s31 offen lds
g1_skipg1au0:
    s_add_u32 s28, s28, 64
    s_add_u32 s29, s29, 64
    s_add_u32 s30, s30, s36
    s_add_u32 s31, s31, s36
    ds_read_b128 v[80:83], v16 offset:28672
    ds_read_b128 v[84:87], v16 offset:29696
    ds_read_b128 v[88:91], v16 offset:30720
    ds_read_b128 v[92:95], v16 offset:31744
    ds_read_b64_tr_b16 v[120:121], v21 offset:28672
    ds_read_b64_tr_b16 v[122:123], v21 offset:28928
    ds_read_b64_tr_b16 v[124:125], v22 offset:28672
    ds_read_b64_tr_b16 v[126:127], v22 offset:28928
    ds_read_b64_tr_b16 v[128:129], v21 offset:30720
    ds_read_b64_tr_b16 v[130:131], v21 offset:30976
    ds_read_b64_tr_b16 v[132:133], v21 offset:34816
    ds_read_b64_tr_b16 v[134:135], v21 offset:35072
    ds_read_b64_tr_b16 v[136:137], v22 offset:34816
    ds_read_b64_tr_b16 v[138:139], v22 offset:35072
    ds_read_b64_tr_b16 v[140:141], v21 offset:36864
    ds_read_b64_tr_b16 v[142:143], v21 offset:37120
    v_mfma_f32_16x16x32_bf16 v[144:147], v[96:99], v[64:67], v[144:147]
    v_mfma_f32_16x16x32_bf16 v[148:151], v[100:103], v[64:67], v[148:151]
    v_mfma_f32_16x16x32_bf16 v[152:155], v[104:107], v[64:67], v[152:155]
    v_mfma_f32_16x16x32_bf16 v[156:159], v[108:111], v[64:67], v[156:159]
    v_mfma_f32_16x16x32_bf16 v[160:163], v[112:115], v[64:67], v[160:163]
    v_mfma_f32_16x16x32_bf16 v[164:167], v[116:119], v[64:67], v[164:167]
    v_mfma_f32_16x16x32_bf16 v[168:171], v[96:99], v[68:71], v[168:171]
    v_mfma_f32_16x16x32_bf16 v[172:175], v[100:103], v[68:71], v[172:175]
    v_mfma_f32_16x16x32_bf16 v[176:179], v[104:107], v[68:71], v[176:179]
    v_mfma_f32_16x16x32_bf16 v[180:183], v[108:111], v[68:71], v[180:183]
    v_mfma_f32_16x16x32_bf16 v[184:187], v[112:115], v[68:71], v[184:187]
    v_mfma_f32_16x16x32_bf16 v[188:191], v[116:119], v[68:71], v[188:191]
    v_mfma_f32_16x16x32_bf16 v[192:195], v[96:99], v[72:75], v[192:195]
    v_mfma_f32_16x16x32_bf16 v[196:199], v[100:103], v[72:75], v[196:199]
    v_mfma_f32_16x16x32_bf16 v[200:203], v[104:107], v[72:75], v[200:203]
    v_mfma_f32_16x16x32_bf16 v[204:207], v[108:111], v[72:75], v[204:207]
    v_mfma_f32_16x16x32_bf16 v[208:211], v[112:115], v[72:75], v[208:211]
    v_mfma_f32_16x16x32_bf16 v[212:215], v[116:119], v[72:75], v[212:215]
    v_mfma_f32_16x16x32_bf16 v[216:219], v[96:99], v[76:79], v[216:219]
    v_mfma_f32_16x16x32_bf16 v[220:223], v[100:103], v[76:79], v[220:223]
    v_mfma_f32_16x16x32_bf16 v[224:227], v[104:107], v[76:79], v[224:227]
    v_mfma_f32_16x16x32_bf16 v[228:231], v[108:111], v[76:79], v[228:231]
    v_mfma_f32_16x16x32_bf16 v[232:235], v[112:115], v[76:79], v[232:235]
    v_mfma_f32_16x16x32_bf16 v[236:239], v[116:119], v[76:79], v[236:239]
    s_waitcnt lgkmcnt(0)
    s_waitcnt vmcnt(3)
    s_barrier
    s_add_u32 m0, s38, 0
    s_nop 0
    buffer_load_dwordx4 v18, s[8:11], s28 offen lds
    s_add_u32 m0, s38, 8192
    s_nop 0
    buffer_load_dwordx4 v18, s[8:11], s29 offen lds
    s_add_u32 m0, s38, 16384
    s_nop 0
    buffer_load_dwordx4 v19, s[52:55], s30 offen lds
    s_cmp_ge_u32 s20, 4
    s_cbranch_scc1 g1_skipg1au1
    s_add_u32 m0, s38, 24576
    s_nop 0
    buffer_load_dwordx4 v19, s[16:19], s31 offen lds
g1_skipg1au1:
    s_add_u32 s28, s28, 64
    s_add_u32 s29, s29, 64
    s_add_u32 s30, s30, s36
    s_add_u32 s31, s31, s36
    ds_read_b128 v[64:67], v23 offset:0
    ds_read_b128 v[68:71], v23 offset:1024
    ds_read_b128 v[72:75], v23 offset:2048
    ds_read_b128 v[76:79], v23 offset:3072
    ds_read_b64_tr_b16 v[96:97], v29 offset:0
    ds_read_b64_tr_b16 v[98:99], v29 offset:256
    ds_read_b64_tr_b16 v[100:101], v30 offset:0
    ds_read_b64_tr_b16 v[102:103], v30 offset:256
    ds_read_b64_tr_b16 v[104:105], v29 offset:2048
    ds_read_b64_tr_b16 v[106:107], v29 offset:2304
    ds_read_b64_tr_b16 v[108:109], v29 offset:6144
    ds_read_b64_tr_b16 v[110:111], v29 offset:6400
    ds_read_b64_tr_b16 v[112:113], v30 offset:6144
    ds_read_b64_tr_b16 v[114:115], v30 offset:6400
    ds_read_b64_tr_b16 v[116:117], v29 offset:8192
    ds_read_b64_tr_b16 v[118:119], v29 offset:8448
    v_mfma_f32_16x16x32_bf16 v[144:147], v[120:123], v[80:83], v[144:147]
    v_mfma_f32_16x16x32_bf16 v[148:151], v[124:127], v[80:83], v[148:151]
    v_mfma_f32_16x16x32_bf16 v[152:155], v[128:131], v[80:83], v[152:155]
    v_mfma_f32_16x16x32_bf16 v[156:159], v[132:135], v[80:83], v[156:159]
    v_mfma_f32_16x16x32_bf16 v[160:163], v[136:139], v[80:83], v[160:163]
    v_mfma_f32_16x16x32_bf16 v[164:167], v[140:143], v[80:83], v[164:167]
    v_mfma_f32_16x16x32_bf16 v[168:171], v[120:123], v[84:87], v[168:171]
    v_mfma_f32_16x16x32_bf16 v[172:175], v[124:127], v[84:87], v[172:175]
    v_mfma_f32_16x16x32_bf16 v[176:179], v[128:131], v[84:87], v[176:179]
    v_mfma_f32_16x16x32_bf16 v[180:183], v[132:135], v[84:87], v[180:183]
    v_mfma_f32_16x16x32_bf16 v[184:187], v[136:139], v[84:87], v[184:187]
    v_mfma_f32_16x16x32_bf16 v[188:191], v[140:143], v[84:87], v[188:191]
    v_mfma_f32_16x16x32_bf16 v[192:195], v[120:123], v[88:91], v[192:195]
    v_mfma_f32_16x16x32_bf16 v[196:199], v[124:127], v[88:91], v[196:199]
    v_mfma_f32_16x16x32_bf16 v[200:203], v[128:131], v[88:91], v[200:203]
    v_mfma_f32_16x16x32_bf16 v[204:207], v[132:135], v[88:91], v[204:207]
    v_mfma_f32_16x16x32_bf16 v[208:211], v[136:139], v[88:91], v[208:211]
    v_mfma_f32_16x16x32_bf16 v[212:215], v[140:143], v[88:91], v[212:215]
    v_mfma_f32_16x16x32_bf16 v[216:219], v[120:123], v[92:95], v[216:219]
    v_mfma_f32_16x16x32_bf16 v[220:223], v[124:127], v[92:95], v[220:223]
    v_mfma_f32_16x16x32_bf16 v[224:227], v[128:131], v[92:95], v[224:227]
    v_mfma_f32_16x16x32_bf16 v[228:231], v[132:135], v[92:95], v[228:231]
    v_mfma_f32_16x16x32_bf16 v[232:235], v[136:139], v[92:95], v[232:235]
    v_mfma_f32_16x16x32_bf16 v[236:239], v[140:143], v[92:95], v[236:239]
    s_waitcnt lgkmcnt(0)
    s_waitcnt vmcnt(3)
    s_barrier
    s_add_u32 m0, s38, 28672
    s_nop 0
    buffer_load_dwordx4 v18, s[8:11], s28 offen lds
    s_add_u32 m0, s38, 36864
    s_nop 0
    buffer_load_dwordx4 v18, s[8:11], s29 offen lds
    s_add_u32 m0, s38, 45056
    s_nop 0
    buffer_load_dwordx4 v19, s[52:55], s30 offen lds
    s_cmp_ge_u32 s20, 4
    s_cbranch_scc1 g1_skipg1au2
    s_add_u32 m0, s38, 53248
    s_nop 0
    buffer_load_dwordx4 v19, s[16:19], s31 offen lds
g1_skipg1au2:
    s_add_u32 s28, s28, 64
    s_add_u32 s29, s29, 64
    s_add_u32 s30, s30, s36
    s_add_u32 s31, s31, s36
    ds_read_b128 v[80:83], v23 offset:28672
    ds_read_b128 v[84:87], v23 offset:29696
    ds_read_b128 v[88:91], v23 offset:30720
    ds_read_b128 v[92:95], v23 offset:31744
    ds_read_b64_tr_b16 v[120:121], v29 offset:28672
    ds_read_b64_tr_b16 v[122:123], v29 offset:28928
    ds_read_b64_tr_b16 v[124:125], v30 offset:28672
    ds_read_b64_tr_b16 v[126:127], v30 offset:28928
    ds_read_b64_tr_b16 v[128:129], v29 offset:30720
    ds_read_b64_tr_b16 v[130:131], v29 offset:30976
    ds_read_b64_tr_b16 v[132:133], v29 offset:34816
    ds_read_b64_tr_b16 v[134:135], v29 offset:35072
    ds_read_b64_tr_b16 v[136:137], v30 offset:34816
    ds_read_b64_tr_b16 v[138:139], v30 offset:35072
    ds_read_b64_tr_b16 v[140:141], v29 offset:36864
    ds_read_b64_tr_b16 v[142:143], v29 offset:37120
    v_mfma_f32_16x16x32_bf16 v[144:147], v[96:99], v[64:67], v[144:147]
    v_mfma_f32_16x16x32_bf16 v[148:151], v[100:103], v[64:67], v[148:151]
    v_mfma_f32_16x16x32_bf16 v[152:155], v[104:107], v[64:67], v[152:155]
    v_mfma_f32_16x16x32_bf16 v[156:159], v[108:111], v[64:67], v[156:159]
    v_mfma_f32_16x16x32_bf16 v[160:163], v[112:115], v[64:67], v[160:163]
    v_mfma_f32_16x16x32_bf16 v[164:167], v[116:119], v[64:67], v[164:167]
    v_mfma_f32_16x16x32_bf16 v[168:171], v[96:99], v[68:71], v[168:171]
    v_mfma_f32_16x16x32_bf16 v[172:175], v[100:103], v[68:71], v[172:175]
    v_mfma_f32_16x16x32_bf16 v[176:179], v[104:107], v[68:71], v[176:179]
    v_mfma_f32_16x16x32_bf16 v[180:183], v[108:111], v[68:71], v[180:183]
    v_mfma_f32_16x16x32_bf16 v[184:187], v[112:115], v[68:71], v[184:187]
    v_mfma_f32_16x16x32_bf16 v[188:191], v[116:119], v[68:71], v[188:191]
    v_mfma_f32_16x16x32_bf16 v[192:195], v[96:99], v[72:75], v[192:195]
    v_mfma_f32_16x16x32_bf16 v[196:199], v[100:103], v[72:75], v[196:199]
    v_mfma_f32_16x16x32_bf16 v[200:203], v[104:107], v[72:75], v[200:203]
    v_mfma_f32_16x16x32_bf16 v[204:207], v[108:111], v[72:75], v[204:207]
    v_mfma_f32_16x16x32_bf16 v[208:211], v[112:115], v[72:75], v[208:211]
    v_mfma_f32_16x16x32_bf16 v[212:215], v[116:119], v[72:75], v[212:215]
    v_mfma_f32_16x16x32_bf16 v[216:219], v[96:99], v[76:79], v[216:219]
    v_mfma_f32_16x16x32_bf16 v[220:223], v[100:103], v[76:79], v[220:223]
    v_mfma_f32_16x16x32_bf16 v[224:227], v[104:107], v[76:79], v[224:227]
    v_mfma_f32_16x16x32_bf16 v[228:231], v[108:111], v[76:79], v[228:231]
    v_mfma_f32_16x16x32_bf16 v[232:235], v[112:115], v[76:79], v[232:235]
    v_mfma_f32_16x16x32_bf16 v[236:239], v[116:119], v[76:79], v[236:239]
    s_waitcnt lgkmcnt(0)
    s_waitcnt vmcnt(3)
    s_barrier
    s_add_u32 m0, s38, 57344
    s_nop 0
    buffer_load_dwordx4 v18, s[8:11], s28 offen lds
    s_add_u32 m0, s38, 65536
    s_nop 0
    buffer_load_dwordx4 v18, s[8:11], s29 offen lds
    s_add_u32 m0, s38, 73728
    s_nop 0
    buffer_load_dwordx4 v19, s[52:55], s30 offen lds
    s_cmp_ge_u32 s20, 4
    s_cbranch_scc1 g1_skipg1au3
    s_add_u32 m0, s38, 81920
    s_nop 0
    buffer_load_dwordx4 v19, s[16:19], s31 offen lds
g1_skipg1au3:
    s_add_u32 s28, s28, 64
    s_add_u32 s29, s29, 64
    s_add_u32 s30, s30, s36
    s_add_u32 s31, s31, s36
    ds_read_b128 v[64:67], v16 offset:0
    ds_read_b128 v[68:71], v16 offset:1024
    ds_read_b128 v[72:75], v16 offset:2048
    ds_read_b128 v[76:79], v16 offset:3072
    ds_read_b64_tr_b16 v[96:97], v21 offset:0
    ds_read_b64_tr_b16 v[98:99], v21 offset:256
    ds_read_b64_tr_b16 v[100:101], v22 offset:0
    ds_read_b64_tr_b16 v[102:103], v22 offset:256
    ds_read_b64_tr_b16 v[104:105], v21 offset:2048
    ds_read_b64_tr_b16 v[106:107], v21 offset:2304
    ds_read_b64_tr_b16 v[108:109], v21 offset:6144
    ds_read_b64_tr_b16 v[110:111], v21 offset:6400
    ds_read_b64_tr_b16 v[112:113], v22 offset:6144
    ds_read_b64_tr_b16 v[114:115], v22 offset:6400
    ds_read_b64_tr_b16 v[116:117], v21 offset:8192
    ds_read_b64_tr_b16 v[118:119], v21 offset:8448
    v_mfma_f32_16x16x32_bf16 v[144:147], v[120:123], v[80:83], v[144:147]
    v_mfma_f32_16x16x32_bf16 v[148:151], v[124:127], v[80:83], v[148:151]
    v_mfma_f32_16x16x32_bf16 v[152:155], v[128:131], v[80:83], v[152:155]
    v_mfma_f32_16x16x32_bf16 v[156:159], v[132:135], v[80:83], v[156:159]
    v_mfma_f32_16x16x32_bf16 v[160:163], v[136:139], v[80:83], v[160:163]
    v_mfma_f32_16x16x32_bf16 v[164:167], v[140:143], v[80:83], v[164:167]
    v_mfma_f32_16x16x32_bf16 v[168:171], v[120:123], v[84:87], v[168:171]
    v_mfma_f32_16x16x32_bf16 v[172:175], v[124:127], v[84:87], v[172:175]
    v_mfma_f32_16x16x32_bf16 v[176:179], v[128:131], v[84:87], v[176:179]
    v_mfma_f32_16x16x32_bf16 v[180:183], v[132:135], v[84:87], v[180:183]
    v_mfma_f32_16x16x32_bf16 v[184:187], v[136:139], v[84:87], v[184:187]
    v_mfma_f32_16x16x32_bf16 v[188:191], v[140:143], v[84:87], v[188:191]
    v_mfma_f32_16x16x32_bf16 v[192:195], v[120:123], v[88:91], v[192:195]
    v_mfma_f32_16x16x32_bf16 v[196:199], v[124:127], v[88:91], v[196:199]
    v_mfma_f32_16x16x32_bf16 v[200:203], v[128:131], v[88:91], v[200:203]
    v_mfma_f32_16x16x32_bf16 v[204:207], v[132:135], v[88:91], v[204:207]
    v_mfma_f32_16x16x32_bf16 v[208:211], v[136:139], v[88:91], v[208:211]
    v_mfma_f32_16x16x32_bf16 v[212:215], v[140:143], v[88:91], v[212:215]
    v_mfma_f32_16x16x32_bf16 v[216:219], v[120:123], v[92:95], v[216:219]
    v_mfma_f32_16x16x32_bf16 v[220:223], v[124:127], v[92:95], v[220:223]
    v_mfma_f32_16x16x32_bf16 v[224:227], v[128:131], v[92:95], v[224:227]
    v_mfma_f32_16x16x32_bf16 v[228:231], v[132:135], v[92:95], v[228:231]
    v_mfma_f32_16x16x32_bf16 v[232:235], v[136:139], v[92:95], v[232:235]
    v_mfma_f32_16x16x32_bf16 v[236:239], v[140:143], v[92:95], v[236:239]
    s_waitcnt lgkmcnt(0)
    s_waitcnt vmcnt(3)
    s_barrier
    s_add_u32 m0, s38, 86016
    s_nop 0
    buffer_load_dwordx4 v18, s[8:11], s28 offen lds
    s_add_u32 m0, s38, 94208
    s_nop 0
    buffer_load_dwordx4 v18, s[8:11], s29 offen lds
    s_add_u32 m0, s38, 102400
    s_nop 0
    buffer_load_dwordx4 v19, s[52:55], s30 offen lds
    s_cmp_ge_u32 s20, 4
    s_cbranch_scc1 g1_skipg1au4
    s_add_u32 m0, s38, 110592
    s_nop 0
    buffer_load_dwordx4 v19, s[16:19], s31 offen lds
g1_skipg1au4:
    s_add_u32 s28, s28, 64
    s_add_u32 s29, s29, 64
    s_add_u32 s30, s30, s36
    s_add_u32 s31, s31, s36
    ds_read_b128 v[80:83], v16 offset:28672
    ds_read_b128 v[84:87], v16 offset:29696
    ds_read_b128 v[88:91], v16 offset:30720
    ds_read_b128 v[92:95], v16 offset:31744
    ds_read_b64_tr_b16 v[120:121], v21 offset:28672
    ds_read_b64_tr_b16 v[122:123], v21 offset:28928
    ds_read_b64_tr_b16 v[124:125], v22 offset:28672
    ds_read_b64_tr_b16 v[126:127], v22 offset:28928
    ds_read_b64_tr_b16 v[128:129], v21 offset:30720
    ds_read_b64_tr_b16 v[130:131], v21 offset:30976
    ds_read_b64_tr_b16 v[132:133], v21 offset:34816
    ds_read_b64_tr_b16 v[134:135], v21 offset:35072
    ds_read_b64_tr_b16 v[136:137], v22 offset:34816
    ds_read_b64_tr_b16 v[138:139], v22 offset:35072
    ds_read_b64_tr_b16 v[140:141], v21 offset:36864
    ds_read_b64_tr_b16 v[142:143], v21 offset:37120
    v_mfma_f32_16x16x32_bf16 v[144:147], v[96:99], v[64:67], v[144:147]
    v_mfma_f32_16x16x32_bf16 v[148:151], v[100:103], v[64:67], v[148:151]
    v_mfma_f32_16x16x32_bf16 v[152:155], v[104:107], v[64:67], v[152:155]
    v_mfma_f32_16x16x32_bf16 v[156:159], v[108:111], v[64:67], v[156:159]
    v_mfma_f32_16x16x32_bf16 v[160:163], v[112:115], v[64:67], v[160:163]
    v_mfma_f32_16x16x32_bf16 v[164:167], v[116:119], v[64:67], v[164:167]
    v_mfma_f32_16x16x32_bf16 v[168:171], v[96:99], v[68:71], v[168:171]
    v_mfma_f32_16x16x32_bf16 v[172:175], v[100:103], v[68:71], v[172:175]
    v_mfma_f32_16x16x32_bf16 v[176:179], v[104:107], v[68:71], v[176:179]
    v_mfma_f32_16x16x32_bf16 v[180:183], v[108:111], v[68:71], v[180:183]
    v_mfma_f32_16x16x32_bf16 v[184:187], v[112:115], v[68:71], v[184:187]
    v_mfma_f32_16x16x32_bf16 v[188:191], v[116:119], v[68:71], v[188:191]
    v_mfma_f32_16x16x32_bf16 v[192:195], v[96:99], v[72:75], v[192:195]
    v_mfma_f32_16x16x32_bf16 v[196:199], v[100:103], v[72:75], v[196:199]
    v_mfma_f32_16x16x32_bf16 v[200:203], v[104:107], v[72:75], v[200:203]
    v_mfma_f32_16x16x32_bf16 v[204:207], v[108:111], v[72:75], v[204:207]
    v_mfma_f32_16x16x32_bf16 v[208:211], v[112:115], v[72:75], v[208:211]
    v_mfma_f32_16x16x32_bf16 v[212:215], v[116:119], v[72:75], v[212:215]
    v_mfma_f32_16x16x32_bf16 v[216:219], v[96:99], v[76:79], v[216:219]
    v_mfma_f32_16x16x32_bf16 v[220:223], v[100:103], v[76:79], v[220:223]
    v_mfma_f32_16x16x32_bf16 v[224:227], v[104:107], v[76:79], v[224:227]
    v_mfma_f32_16x16x32_bf16 v[228:231], v[108:111], v[76:79], v[228:231]
    v_mfma_f32_16x16x32_bf16 v[232:235], v[112:115], v[76:79], v[232:235]
    v_mfma_f32_16x16x32_bf16 v[236:239], v[116:119], v[76:79], v[236:239]
    s_waitcnt lgkmcnt(0)
    s_waitcnt vmcnt(3)
    s_barrier
    s_add_u32 m0, s38, 0
    s_nop 0
    buffer_load_dwordx4 v18, s[8:11], s28 offen lds
    s_add_u32 m0, s38, 8192
    s_nop 0
    buffer_load_dwordx4 v18, s[8:11], s29 offen lds
    s_add_u32 m0, s38, 16384
    s_nop 0
    buffer_load_dwordx4 v19, s[52:55], s30 offen lds
    s_cmp_ge_u32 s20, 4
    s_cbranch_scc1 g1_skipg1au5
    s_add_u32 m0, s38, 24576
    s_nop 0
    buffer_load_dwordx4 v19, s[16:19], s31 offen lds
g1_skipg1au5:
    s_add_u32 s28, s28, 64
    s_add_u32 s29, s29, 64
    s_add_u32 s30, s30, s36
    s_add_u32 s31, s31, s36
    ds_read_b128 v[64:67], v23 offset:0
    ds_read_b128 v[68:71], v23 offset:1024
    ds_read_b128 v[72:75], v23 offset:2048
    ds_read_b128 v[76:79], v23 offset:3072
    ds_read_b64_tr_b16 v[96:97], v29 offset:0
    ds_read_b64_tr_b16 v[98:99], v29 offset:256
    ds_read_b64_tr_b16 v[100:101], v30 offset:0
    ds_read_b64_tr_b16 v[102:103], v30 offset:256
    ds_read_b64_tr_b16 v[104:105], v29 offset:2048
    ds_read_b64_tr_b16 v[106:107], v29 offset:2304
    ds_read_b64_tr_b16 v[108:109], v29 offset:6144
    ds_read_b64_tr_b16 v[110:111], v29 offset:6400
    ds_read_b64_tr_b16 v[112:113], v30 offset:6144
    ds_read_b64_tr_b16 v[114:115], v30 offset:6400
    ds_read_b64_tr_b16 v[116:117], v29 offset:8192
    ds_read_b64_tr_b16 v[118:119], v29 offset:8448
    v_mfma_f32_16x16x32_bf16 v[144:147], v[120:123], v[80:83], v[144:147]
    v_mfma_f32_16x16x32_bf16 v[148:151], v[124:127], v[80:83], v[148:151]
    v_mfma_f32_16x16x32_bf16 v[152:155], v[128:131], v[80:83], v[152:155]
    v_mfma_f32_16x16x32_bf16 v[156:159], v[132:135], v[80:83], v[156:159]
    v_mfma_f32_16x16x32_bf16 v[160:163], v[136:139], v[80:83], v[160:163]
    v_mfma_f32_16x16x32_bf16 v[164:167], v[140:143], v[80:83], v[164:167]
    v_mfma_f32_16x16x32_bf16 v[168:171], v[120:123], v[84:87], v[168:171]
    v_mfma_f32_16x16x32_bf16 v[172:175], v[124:127], v[84:87], v[172:175]
    v_mfma_f32_16x16x32_bf16 v[176:179], v[128:131], v[84:87], v[176:179]
    v_mfma_f32_16x16x32_bf16 v[180:183], v[132:135], v[84:87], v[180:183]
    v_mfma_f32_16x16x32_bf16 v[184:187], v[136:139], v[84:87], v[184:187]
    v_mfma_f32_16x16x32_bf16 v[188:191], v[140:143], v[84:87], v[188:191]
    v_mfma_f32_16x16x32_bf16 v[192:195], v[120:123], v[88:91], v[192:195]
    v_mfma_f32_16x16x32_bf16 v[196:199], v[124:127], v[88:91], v[196:199]
    v_mfma_f32_16x16x32_bf16 v[200:203], v[128:131], v[88:91], v[200:203]
    v_mfma_f32_16x16x32_bf16 v[204:207], v[132:135], v[88:91], v[204:207]
    v_mfma_f32_16x16x32_bf16 v[208:211], v[136:139], v[88:91], v[208:211]
    v_mfma_f32_16x16x32_bf16 v[212:215], v[140:143], v[88:91], v[212:215]
    v_mfma_f32_16x16x32_bf16 v[216:219], v[120:123], v[92:95], v[216:219]
    v_mfma_f32_16x16x32_bf16 v[220:223], v[124:127], v[92:95], v[220:223]
    v_mfma_f32_16x16x32_bf16 v[224:227], v[128:131], v[92:95], v[224:227]
    v_mfma_f32_16x16x32_bf16 v[228:231], v[132:135], v[92:95], v[228:231]
    v_mfma_f32_16x16x32_bf16 v[232:235], v[136:139], v[92:95], v[232:235]
    v_mfma_f32_16x16x32_bf16 v[236:239], v[140:143], v[92:95], v[236:239]
    s_waitcnt lgkmcnt(0)
    s_waitcnt vmcnt(3)
    s_barrier
    s_add_u32 m0, s38, 28672
    s_nop 0
    buffer_load_dwordx4 v18, s[8:11], s28 offen lds
    s_add_u32 m0, s38, 36864
    s_nop 0
    buffer_load_dwordx4 v18, s[8:11], s29 offen lds
    s_add_u32 m0, s38, 45056
    s_nop 0
    buffer_load_dwordx4 v19, s[52:55], s30 offen lds
    s_cmp_ge_u32 s20, 4
    s_cbranch_scc1 g1_skipg1au6
    s_add_u32 m0, s38, 53248
    s_nop 0
    buffer_load_dwordx4 v19, s[16:19], s31 offen lds
g1_skipg1au6:
    s_add_u32 s28, s28, 64
    s_add_u32 s29, s29, 64
    s_add_u32 s30, s30, s36
    s_add_u32 s31, s31, s36
    ds_read_b128 v[80:83], v23 offset:28672
    ds_read_b128 v[84:87], v23 offset:29696
    ds_read_b128 v[88:91], v23 offset:30720
    ds_read_b128 v[92:95], v23 offset:31744
    ds_read_b64_tr_b16 v[120:121], v29 offset:28672
    ds_read_b64_tr_b16 v[122:123], v29 offset:28928
    ds_read_b64_tr_b16 v[124:125], v30 offset:28672
    ds_read_b64_tr_b16 v[126:127], v30 offset:28928
    ds_read_b64_tr_b16 v[128:129], v29 offset:30720
    ds_read_b64_tr_b16 v[130:131], v29 offset:30976
    ds_read_b64_tr_b16 v[132:133], v29 offset:34816
    ds_read_b64_tr_b16 v[134:135], v29 offset:35072
    ds_read_b64_tr_b16 v[136:137], v30 offset:34816
    ds_read_b64_tr_b16 v[138:139], v30 offset:35072
    ds_read_b64_tr_b16 v[140:141], v29 offset:36864
    ds_read_b64_tr_b16 v[142:143], v29 offset:37120
    v_mfma_f32_16x16x32_bf16 v[144:147], v[96:99], v[64:67], v[144:147]
    v_mfma_f32_16x16x32_bf16 v[148:151], v[100:103], v[64:67], v[148:151]
    v_mfma_f32_16x16x32_bf16 v[152:155], v[104:107], v[64:67], v[152:155]
    v_mfma_f32_16x16x32_bf16 v[156:159], v[108:111], v[64:67], v[156:159]
    v_mfma_f32_16x16x32_bf16 v[160:163], v[112:115], v[64:67], v[160:163]
    v_mfma_f32_16x16x32_bf16 v[164:167], v[116:119], v[64:67], v[164:167]
    v_mfma_f32_16x16x32_bf16 v[168:171], v[96:99], v[68:71], v[168:171]
    v_mfma_f32_16x16x32_bf16 v[172:175], v[100:103], v[68:71], v[172:175]
    v_mfma_f32_16x16x32_bf16 v[176:179], v[104:107], v[68:71], v[176:179]
    v_mfma_f32_16x16x32_bf16 v[180:183], v[108:111], v[68:71], v[180:183]
    v_mfma_f32_16x16x32_bf16 v[184:187], v[112:115], v[68:71], v[184:187]
    v_mfma_f32_16x16x32_bf16 v[188:191], v[116:119], v[68:71], v[188:191]
    v_mfma_f32_16x16x32_bf16 v[192:195], v[96:99], v[72:75], v[192:195]
    v_mfma_f32_16x16x32_bf16 v[196:199], v[100:103], v[72:75], v[196:199]
    v_mfma_f32_16x16x32_bf16 v[200:203], v[104:107], v[72:75], v[200:203]
    v_mfma_f32_16x16x32_bf16 v[204:207], v[108:111], v[72:75], v[204:207]
    v_mfma_f32_16x16x32_bf16 v[208:211], v[112:115], v[72:75], v[208:211]
    v_mfma_f32_16x16x32_bf16 v[212:215], v[116:119], v[72:75], v[212:215]
    v_mfma_f32_16x16x32_bf16 v[216:219], v[96:99], v[76:79], v[216:219]
    v_mfma_f32_16x16x32_bf16 v[220:223], v[100:103], v[76:79], v[220:223]
    v_mfma_f32_16x16x32_bf16 v[224:227], v[104:107], v[76:79], v[224:227]
    v_mfma_f32_16x16x32_bf16 v[228:231], v[108:111], v[76:79], v[228:231]
    v_mfma_f32_16x16x32_bf16 v[232:235], v[112:115], v[76:79], v[232:235]
    v_mfma_f32_16x16x32_bf16 v[236:239], v[116:119], v[76:79], v[236:239]
    s_waitcnt lgkmcnt(0)
    s_waitcnt vmcnt(3)
    s_barrier
    s_add_u32 m0, s38, 57344
    s_nop 0
    buffer_load_dwordx4 v18, s[8:11], s28 offen lds
    s_add_u32 m0, s38, 65536
    s_nop 0
    buffer_load_dwordx4 v18, s[8:11], s29 offen lds
    s_add_u32 m0, s38, 73728
    s_nop 0
    buffer_load_dwordx4 v19, s[52:55], s30 offen lds
    s_cmp_ge_u32 s20, 4
    s_cbranch_scc1 g1_skipg1au7
    s_add_u32 m0, s38, 81920
    s_nop 0
    buffer_load_dwordx4 v19, s[16:19], s31 offen lds
g1_skipg1au7:
    s_add_u32 s28, s28, 64
    s_add_u32 s29, s29, 64
    s_add_u32 s30, s30, s36
    s_add_u32 s31, s31, s36
    ds_read_b128 v[64:67], v16 offset:0
    ds_read_b128 v[68:71], v16 offset:1024
    ds_read_b128 v[72:75], v16 offset:2048
    ds_read_b128 v[76:79], v16 offset:3072
    ds_read_b64_tr_b16 v[96:97], v21 offset:0
    ds_read_b64_tr_b16 v[98:99], v21 offset:256
    ds_read_b64_tr_b16 v[100:101], v22 offset:0
    ds_read_b64_tr_b16 v[102:103], v22 offset:256
    ds_read_b64_tr_b16 v[104:105], v21 offset:2048
    ds_read_b64_tr_b16 v[106:107], v21 offset:2304
    ds_read_b64_tr_b16 v[108:109], v21 offset:6144
    ds_read_b64_tr_b16 v[110:111], v21 offset:6400
    ds_read_b64_tr_b16 v[112:113], v22 offset:6144
    ds_read_b64_tr_b16 v[114:115], v22 offset:6400
    ds_read_b64_tr_b16 v[116:117], v21 offset:8192
    ds_read_b64_tr_b16 v[118:119], v21 offset:8448
    v_mfma_f32_16x16x32_bf16 v[144:147], v[120:123], v[80:83], v[144:147]
    v_mfma_f32_16x16x32_bf16 v[148:151], v[124:127], v[80:83], v[148:151]
    v_mfma_f32_16x16x32_bf16 v[152:155], v[128:131], v[80:83], v[152:155]
    v_mfma_f32_16x16x32_bf16 v[156:159], v[132:135], v[80:83], v[156:159]
    v_mfma_f32_16x16x32_bf16 v[160:163], v[136:139], v[80:83], v[160:163]
    v_mfma_f32_16x16x32_bf16 v[164:167], v[140:143], v[80:83], v[164:167]
    v_mfma_f32_16x16x32_bf16 v[168:171], v[120:123], v[84:87], v[168:171]
    v_mfma_f32_16x16x32_bf16 v[172:175], v[124:127], v[84:87], v[172:175]
    v_mfma_f32_16x16x32_bf16 v[176:179], v[128:131], v[84:87], v[176:179]
    v_mfma_f32_16x16x32_bf16 v[180:183], v[132:135], v[84:87], v[180:183]
    v_mfma_f32_16x16x32_bf16 v[184:187], v[136:139], v[84:87], v[184:187]
    v_mfma_f32_16x16x32_bf16 v[188:191], v[140:143], v[84:87], v[188:191]
    v_mfma_f32_16x16x32_bf16 v[192:195], v[120:123], v[88:91], v[192:195]
    v_mfma_f32_16x16x32_bf16 v[196:199], v[124:127], v[88:91], v[196:199]
    v_mfma_f32_16x16x32_bf16 v[200:203], v[128:131], v[88:91], v[200:203]
    v_mfma_f32_16x16x32_bf16 v[204:207], v[132:135], v[88:91], v[204:207]
    v_mfma_f32_16x16x32_bf16 v[208:211], v[136:139], v[88:91], v[208:211]
    v_mfma_f32_16x16x32_bf16 v[212:215], v[140:143], v[88:91], v[212:215]
    v_mfma_f32_16x16x32_bf16 v[216:219], v[120:123], v[92:95], v[216:219]
    v_mfma_f32_16x16x32_bf16 v[220:223], v[124:127], v[92:95], v[220:223]
    v_mfma_f32_16x16x32_bf16 v[224:227], v[128:131], v[92:95], v[224:227]
    v_mfma_f32_16x16x32_bf16 v[228:231], v[132:135], v[92:95], v[228:231]
    v_mfma_f32_16x16x32_bf16 v[232:235], v[136:139], v[92:95], v[232:235]
    v_mfma_f32_16x16x32_bf16 v[236:239], v[140:143], v[92:95], v[236:239]
    s_waitcnt lgkmcnt(0)
    s_waitcnt vmcnt(3)
    s_barrier
    s_add_u32 m0, s38, 86016
    s_nop 0
    buffer_load_dwordx4 v18, s[8:11], s28 offen lds
    s_add_u32 m0, s38, 94208
    s_nop 0
    buffer_load_dwordx4 v18, s[8:11], s29 offen lds
    s_add_u32 m0, s38, 102400
    s_nop 0
    buffer_load_dwordx4 v19, s[52:55], s30 offen lds
    s_cmp_ge_u32 s20, 4
    s_cbranch_scc1 g1_skipg1au8
    s_add_u32 m0, s38, 110592
    s_nop 0
    buffer_load_dwordx4 v19, s[16:19], s31 offen lds
g1_skipg1au8:
    s_add_u32 s28, s28, 64
    s_add_u32 s29, s29, 64
    s_add_u32 s30, s30, s36
    s_add_u32 s31, s31, s36
    ds_read_b128 v[80:83], v16 offset:28672
    ds_read_b128 v[84:87], v16 offset:29696
    ds_read_b128 v[88:91], v16 offset:30720
    ds_read_b128 v[92:95], v16 offset:31744
    ds_read_b64_tr_b16 v[120:121], v21 offset:28672
    ds_read_b64_tr_b16 v[122:123], v21 offset:28928
    ds_read_b64_tr_b16 v[124:125], v22 offset:28672
    ds_read_b64_tr_b16 v[126:127], v22 offset:28928
    ds_read_b64_tr_b16 v[128:129], v21 offset:30720
    ds_read_b64_tr_b16 v[130:131], v21 offset:30976
    ds_read_b64_tr_b16 v[132:133], v21 offset:34816
    ds_read_b64_tr_b16 v[134:135], v21 offset:35072
    ds_read_b64_tr_b16 v[136:137], v22 offset:34816
    ds_read_b64_tr_b16 v[138:139], v22 offset:35072
    ds_read_b64_tr_b16 v[140:141], v21 offset:36864
    ds_read_b64_tr_b16 v[142:143], v21 offset:37120
    v_mfma_f32_16x16x32_bf16 v[144:147], v[96:99], v[64:67], v[144:147]
    v_mfma_f32_16x16x32_bf16 v[148:151], v[100:103], v[64:67], v[148:151]
    v_mfma_f32_16x16x32_bf16 v[152:155], v[104:107], v[64:67], v[152:155]
    v_mfma_f32_16x16x32_bf16 v[156:159], v[108:111], v[64:67], v[156:159]
    v_mfma_f32_16x16x32_bf16 v[160:163], v[112:115], v[64:67], v[160:163]
    v_mfma_f32_16x16x32_bf16 v[164:167], v[116:119], v[64:67], v[164:167]
    v_mfma_f32_16x16x32_bf16 v[168:171], v[96:99], v[68:71], v[168:171]
    v_mfma_f32_16x16x32_bf16 v[172:175], v[100:103], v[68:71], v[172:175]
    v_mfma_f32_16x16x32_bf16 v[176:179], v[104:107], v[68:71], v[176:179]
    v_mfma_f32_16x16x32_bf16 v[180:183], v[108:111], v[68:71], v[180:183]
    v_mfma_f32_16x16x32_bf16 v[184:187], v[112:115], v[68:71], v[184:187]
    v_mfma_f32_16x16x32_bf16 v[188:191], v[116:119], v[68:71], v[188:191]
    v_mfma_f32_16x16x32_bf16 v[192:195], v[96:99], v[72:75], v[192:195]
    v_mfma_f32_16x16x32_bf16 v[196:199], v[100:103], v[72:75], v[196:199]
    v_mfma_f32_16x16x32_bf16 v[200:203], v[104:107], v[72:75], v[200:203]
    v_mfma_f32_16x16x32_bf16 v[204:207], v[108:111], v[72:75], v[204:207]
    v_mfma_f32_16x16x32_bf16 v[208:211], v[112:115], v[72:75], v[208:211]
    v_mfma_f32_16x16x32_bf16 v[212:215], v[116:119], v[72:75], v[212:215]
    v_mfma_f32_16x16x32_bf16 v[216:219], v[96:99], v[76:79], v[216:219]
    v_mfma_f32_16x16x32_bf16 v[220:223], v[100:103], v[76:79], v[220:223]
    v_mfma_f32_16x16x32_bf16 v[224:227], v[104:107], v[76:79], v[224:227]
    v_mfma_f32_16x16x32_bf16 v[228:231], v[108:111], v[76:79], v[228:231]
    v_mfma_f32_16x16x32_bf16 v[232:235], v[112:115], v[76:79], v[232:235]
    v_mfma_f32_16x16x32_bf16 v[236:239], v[116:119], v[76:79], v[236:239]
    s_waitcnt lgkmcnt(0)
    s_waitcnt vmcnt(3)
    s_barrier
    s_add_u32 m0, s38, 0
    s_nop 0
    buffer_load_dwordx4 v18, s[8:11], s28 offen lds
    s_add_u32 m0, s38, 8192
    s_nop 0
    buffer_load_dwordx4 v18, s[8:11], s29 offen lds
    s_add_u32 m0, s38, 16384
    s_nop 0
    buffer_load_dwordx4 v19, s[52:55], s30 offen lds
    s_cmp_ge_u32 s20, 4
    s_cbranch_scc1 g1_skipg1au9
    s_add_u32 m0, s38, 24576
    s_nop 0
    buffer_load_dwordx4 v19, s[16:19], s31 offen lds
g1_skipg1au9:
    s_add_u32 s28, s28, 64
    s_add_u32 s29, s29, 64
    s_add_u32 s30, s30, s36
    s_add_u32 s31, s31, s36
    ds_read_b128 v[64:67], v23 offset:0
    ds_read_b128 v[68:71], v23 offset:1024
    ds_read_b128 v[72:75], v23 offset:2048
    ds_read_b128 v[76:79], v23 offset:3072
    ds_read_b64_tr_b16 v[96:97], v29 offset:0
    ds_read_b64_tr_b16 v[98:99], v29 offset:256
    ds_read_b64_tr_b16 v[100:101], v30 offset:0
    ds_read_b64_tr_b16 v[102:103], v30 offset:256
    ds_read_b64_tr_b16 v[104:105], v29 offset:2048
    ds_read_b64_tr_b16 v[106:107], v29 offset:2304
    ds_read_b64_tr_b16 v[108:109], v29 offset:6144
    ds_read_b64_tr_b16 v[110:111], v29 offset:6400
    ds_read_b64_tr_b16 v[112:113], v30 offset:6144
    ds_read_b64_tr_b16 v[114:115], v30 offset:6400
    ds_read_b64_tr_b16 v[116:117], v29 offset:8192
    ds_read_b64_tr_b16 v[118:119], v29 offset:8448
    v_mfma_f32_16x16x32_bf16 v[144:147], v[120:123], v[80:83], v[144:147]
    v_mfma_f32_16x16x32_bf16 v[148:151], v[124:127], v[80:83], v[148:151]
    v_mfma_f32_16x16x32_bf16 v[152:155], v[128:131], v[80:83], v[152:155]
    v_mfma_f32_16x16x32_bf16 v[156:159], v[132:135], v[80:83], v[156:159]
    v_mfma_f32_16x16x32_bf16 v[160:163], v[136:139], v[80:83], v[160:163]
    v_mfma_f32_16x16x32_bf16 v[164:167], v[140:143], v[80:83], v[164:167]
    v_mfma_f32_16x16x32_bf16 v[168:171], v[120:123], v[84:87], v[168:171]
    v_mfma_f32_16x16x32_bf16 v[172:175], v[124:127], v[84:87], v[172:175]
    v_mfma_f32_16x16x32_bf16 v[176:179], v[128:131], v[84:87], v[176:179]
    v_mfma_f32_16x16x32_bf16 v[180:183], v[132:135], v[84:87], v[180:183]
    v_mfma_f32_16x16x32_bf16 v[184:187], v[136:139], v[84:87], v[184:187]
    v_mfma_f32_16x16x32_bf16 v[188:191], v[140:143], v[84:87], v[188:191]
    v_mfma_f32_16x16x32_bf16 v[192:195], v[120:123], v[88:91], v[192:195]
    v_mfma_f32_16x16x32_bf16 v[196:199], v[124:127], v[88:91], v[196:199]
    v_mfma_f32_16x16x32_bf16 v[200:203], v[128:131], v[88:91], v[200:203]
    v_mfma_f32_16x16x32_bf16 v[204:207], v[132:135], v[88:91], v[204:207]
    v_mfma_f32_16x16x32_bf16 v[208:211], v[136:139], v[88:91], v[208:211]
    v_mfma_f32_16x16x32_bf16 v[212:215], v[140:143], v[88:91], v[212:215]
    v_mfma_f32_16x16x32_bf16 v[216:219], v[120:123], v[92:95], v[216:219]
    v_mfma_f32_16x16x32_bf16 v[220:223], v[124:127], v[92:95], v[220:223]
    v_mfma_f32_16x16x32_bf16 v[224:227], v[128:131], v[92:95], v[224:227]
    v_mfma_f32_16x16x32_bf16 v[228:231], v[132:135], v[92:95], v[228:231]
    v_mfma_f32_16x16x32_bf16 v[232:235], v[136:139], v[92:95], v[232:235]
    v_mfma_f32_16x16x32_bf16 v[236:239], v[140:143], v[92:95], v[236:239]
    s_waitcnt lgkmcnt(0)
    s_waitcnt vmcnt(3)
    s_barrier
    s_add_u32 m0, s38, 28672
    s_nop 0
    buffer_load_dwordx4 v18, s[8:11], s28 offen lds
    s_add_u32 m0, s38, 36864
    s_nop 0
    buffer_load_dwordx4 v18, s[8:11], s29 offen lds
    s_add_u32 m0, s38, 45056
    s_nop 0
    buffer_load_dwordx4 v19, s[52:55], s30 offen lds
    s_cmp_ge_u32 s20, 4
    s_cbranch_scc1 g1_skipg1au10
    s_add_u32 m0, s38, 53248
    s_nop 0
    buffer_load_dwordx4 v19, s[16:19], s31 offen lds
g1_skipg1au10:
    s_add_u32 s28, s28, 64
    s_add_u32 s29, s29, 64
    s_add_u32 s30, s30, s36
    s_add_u32 s31, s31, s36
    ds_read_b128 v[80:83], v23 offset:28672
    ds_read_b128 v[84:87], v23 offset:29696
    ds_read_b128 v[88:91], v23 offset:30720
    ds_read_b128 v[92:95], v23 offset:31744
    ds_read_b64_tr_b16 v[120:121], v29 offset:28672
    ds_read_b64_tr_b16 v[122:123], v29 offset:28928
    ds_read_b64_tr_b16 v[124:125], v30 offset:28672
    ds_read_b64_tr_b16 v[126:127], v30 offset:28928
    ds_read_b64_tr_b16 v[128:129], v29 offset:30720
    ds_read_b64_tr_b16 v[130:131], v29 offset:30976
    ds_read_b64_tr_b16 v[132:133], v29 offset:34816
    ds_read_b64_tr_b16 v[134:135], v29 offset:35072
    ds_read_b64_tr_b16 v[136:137], v30 offset:34816
    ds_read_b64_tr_b16 v[138:139], v30 offset:35072
    ds_read_b64_tr_b16 v[140:141], v29 offset:36864
    ds_read_b64_tr_b16 v[142:143], v29 offset:37120
    v_mfma_f32_16x16x32_bf16 v[144:147], v[96:99], v[64:67], v[144:147]
    v_mfma_f32_16x16x32_bf16 v[148:151], v[100:103], v[64:67], v[148:151]
    v_mfma_f32_16x16x32_bf16 v[152:155], v[104:107], v[64:67], v[152:155]
    v_mfma_f32_16x16x32_bf16 v[156:159], v[108:111], v[64:67], v[156:159]
    v_mfma_f32_16x16x32_bf16 v[160:163], v[112:115], v[64:67], v[160:163]
    v_mfma_f32_16x16x32_bf16 v[164:167], v[116:119], v[64:67], v[164:167]
    v_mfma_f32_16x16x32_bf16 v[168:171], v[96:99], v[68:71], v[168:171]
    v_mfma_f32_16x16x32_bf16 v[172:175], v[100:103], v[68:71], v[172:175]
    v_mfma_f32_16x16x32_bf16 v[176:179], v[104:107], v[68:71], v[176:179]
    v_mfma_f32_16x16x32_bf16 v[180:183], v[108:111], v[68:71], v[180:183]
    v_mfma_f32_16x16x32_bf16 v[184:187], v[112:115], v[68:71], v[184:187]
    v_mfma_f32_16x16x32_bf16 v[188:191], v[116:119], v[68:71], v[188:191]
    v_mfma_f32_16x16x32_bf16 v[192:195], v[96:99], v[72:75], v[192:195]
    v_mfma_f32_16x16x32_bf16 v[196:199], v[100:103], v[72:75], v[196:199]
    v_mfma_f32_16x16x32_bf16 v[200:203], v[104:107], v[72:75], v[200:203]
    v_mfma_f32_16x16x32_bf16 v[204:207], v[108:111], v[72:75], v[204:207]
    v_mfma_f32_16x16x32_bf16 v[208:211], v[112:115], v[72:75], v[208:211]
    v_mfma_f32_16x16x32_bf16 v[212:215], v[116:119], v[72:75], v[212:215]
    v_mfma_f32_16x16x32_bf16 v[216:219], v[96:99], v[76:79], v[216:219]
    v_mfma_f32_16x16x32_bf16 v[220:223], v[100:103], v[76:79], v[220:223]
    v_mfma_f32_16x16x32_bf16 v[224:227], v[104:107], v[76:79], v[224:227]
    v_mfma_f32_16x16x32_bf16 v[228:231], v[108:111], v[76:79], v[228:231]
    v_mfma_f32_16x16x32_bf16 v[232:235], v[112:115], v[76:79], v[232:235]
    v_mfma_f32_16x16x32_bf16 v[236:239], v[116:119], v[76:79], v[236:239]
    s_waitcnt lgkmcnt(0)
    s_waitcnt vmcnt(3)
    s_barrier
    s_add_u32 m0, s38, 57344
    s_nop 0
    buffer_load_dwordx4 v18, s[8:11], s28 offen lds
    s_add_u32 m0, s38, 65536
    s_nop 0
    buffer_load_dwordx4 v18, s[8:11], s29 offen lds
    s_add_u32 m0, s38, 73728
    s_nop 0
    buffer_load_dwordx4 v19, s[52:55], s30 offen lds
    s_cmp_ge_u32 s20, 4
    s_cbranch_scc1 g1_skipg1au11
    s_add_u32 m0, s38, 81920
    s_nop 0
    buffer_load_dwordx4 v19, s[16:19], s31 offen lds
g1_skipg1au11:
    s_add_u32 s28, s28, 64
    s_add_u32 s29, s29, 64
    s_add_u32 s30, s30, s36
    s_add_u32 s31, s31, s36
    ds_read_b128 v[64:67], v16 offset:0
    ds_read_b128 v[68:71], v16 offset:1024
    ds_read_b128 v[72:75], v16 offset:2048
    ds_read_b128 v[76:79], v16 offset:3072
    ds_read_b64_tr_b16 v[96:97], v21 offset:0
    ds_read_b64_tr_b16 v[98:99], v21 offset:256
    ds_read_b64_tr_b16 v[100:101], v22 offset:0
    ds_read_b64_tr_b16 v[102:103], v22 offset:256
    ds_read_b64_tr_b16 v[104:105], v21 offset:2048
    ds_read_b64_tr_b16 v[106:107], v21 offset:2304
    ds_read_b64_tr_b16 v[108:109], v21 offset:6144
    ds_read_b64_tr_b16 v[110:111], v21 offset:6400
    ds_read_b64_tr_b16 v[112:113], v22 offset:6144
    ds_read_b64_tr_b16 v[114:115], v22 offset:6400
    ds_read_b64_tr_b16 v[116:117], v21 offset:8192
    ds_read_b64_tr_b16 v[118:119], v21 offset:8448
    v_mfma_f32_16x16x32_bf16 v[144:147], v[120:123], v[80:83], v[144:147]
    v_mfma_f32_16x16x32_bf16 v[148:151], v[124:127], v[80:83], v[148:151]
    v_mfma_f32_16x16x32_bf16 v[152:155], v[128:131], v[80:83], v[152:155]
    v_mfma_f32_16x16x32_bf16 v[156:159], v[132:135], v[80:83], v[156:159]
    v_mfma_f32_16x16x32_bf16 v[160:163], v[136:139], v[80:83], v[160:163]
    v_mfma_f32_16x16x32_bf16 v[164:167], v[140:143], v[80:83], v[164:167]
    v_mfma_f32_16x16x32_bf16 v[168:171], v[120:123], v[84:87], v[168:171]
    v_mfma_f32_16x16x32_bf16 v[172:175], v[124:127], v[84:87], v[172:175]
    v_mfma_f32_16x16x32_bf16 v[176:179], v[128:131], v[84:87], v[176:179]
    v_mfma_f32_16x16x32_bf16 v[180:183], v[132:135], v[84:87], v[180:183]
    v_mfma_f32_16x16x32_bf16 v[184:187], v[136:139], v[84:87], v[184:187]
    v_mfma_f32_16x16x32_bf16 v[188:191], v[140:143], v[84:87], v[188:191]
    v_mfma_f32_16x16x32_bf16 v[192:195], v[120:123], v[88:91], v[192:195]
    v_mfma_f32_16x16x32_bf16 v[196:199], v[124:127], v[88:91], v[196:199]
    v_mfma_f32_16x16x32_bf16 v[200:203], v[128:131], v[88:91], v[200:203]
    v_mfma_f32_16x16x32_bf16 v[204:207], v[132:135], v[88:91], v[204:207]
    v_mfma_f32_16x16x32_bf16 v[208:211], v[136:139], v[88:91], v[208:211]
    v_mfma_f32_16x16x32_bf16 v[212:215], v[140:143], v[88:91], v[212:215]
    v_mfma_f32_16x16x32_bf16 v[216:219], v[120:123], v[92:95], v[216:219]
    v_mfma_f32_16x16x32_bf16 v[220:223], v[124:127], v[92:95], v[220:223]
    v_mfma_f32_16x16x32_bf16 v[224:227], v[128:131], v[92:95], v[224:227]
    v_mfma_f32_16x16x32_bf16 v[228:231], v[132:135], v[92:95], v[228:231]
    v_mfma_f32_16x16x32_bf16 v[232:235], v[136:139], v[92:95], v[232:235]
    v_mfma_f32_16x16x32_bf16 v[236:239], v[140:143], v[92:95], v[236:239]
    s_waitcnt lgkmcnt(0)
    s_waitcnt vmcnt(3)
    s_barrier
    s_add_u32 m0, s38, 86016
    s_nop 0
    buffer_load_dwordx4 v18, s[8:11], s28 offen lds
    s_add_u32 m0, s38, 94208
    s_nop 0
    buffer_load_dwordx4 v18, s[8:11], s29 offen lds
    s_add_u32 m0, s38, 102400
    s_nop 0
    buffer_load_dwordx4 v19, s[52:55], s30 offen lds
    s_cmp_ge_u32 s20, 4
    s_cbranch_scc1 g1_skipg1au12
    s_add_u32 m0, s38, 110592
    s_nop 0
    buffer_load_dwordx4 v19, s[16:19], s31 offen lds
g1_skipg1au12:
    s_add_u32 s28, s28, 64
    s_add_u32 s29, s29, 64
    s_add_u32 s30, s30, s36
    s_add_u32 s31, s31, s36
    ds_read_b128 v[80:83], v16 offset:28672
    ds_read_b128 v[84:87], v16 offset:29696
    ds_read_b128 v[88:91], v16 offset:30720
    ds_read_b128 v[92:95], v16 offset:31744
    ds_read_b64_tr_b16 v[120:121], v21 offset:28672
    ds_read_b64_tr_b16 v[122:123], v21 offset:28928
    ds_read_b64_tr_b16 v[124:125], v22 offset:28672
    ds_read_b64_tr_b16 v[126:127], v22 offset:28928
    ds_read_b64_tr_b16 v[128:129], v21 offset:30720
    ds_read_b64_tr_b16 v[130:131], v21 offset:30976
    ds_read_b64_tr_b16 v[132:133], v21 offset:34816
    ds_read_b64_tr_b16 v[134:135], v21 offset:35072
    ds_read_b64_tr_b16 v[136:137], v22 offset:34816
    ds_read_b64_tr_b16 v[138:139], v22 offset:35072
    ds_read_b64_tr_b16 v[140:141], v21 offset:36864
    ds_read_b64_tr_b16 v[142:143], v21 offset:37120
    v_mfma_f32_16x16x32_bf16 v[144:147], v[96:99], v[64:67], v[144:147]
    v_mfma_f32_16x16x32_bf16 v[148:151], v[100:103], v[64:67], v[148:151]
    v_mfma_f32_16x16x32_bf16 v[152:155], v[104:107], v[64:67], v[152:155]
    v_mfma_f32_16x16x32_bf16 v[156:159], v[108:111], v[64:67], v[156:159]
    v_mfma_f32_16x16x32_bf16 v[160:163], v[112:115], v[64:67], v[160:163]
    v_mfma_f32_16x16x32_bf16 v[164:167], v[116:119], v[64:67], v[164:167]
    v_mfma_f32_16x16x32_bf16 v[168:171], v[96:99], v[68:71], v[168:171]
    v_mfma_f32_16x16x32_bf16 v[172:175], v[100:103], v[68:71], v[172:175]
    v_mfma_f32_16x16x32_bf16 v[176:179], v[104:107], v[68:71], v[176:179]
    v_mfma_f32_16x16x32_bf16 v[180:183], v[108:111], v[68:71], v[180:183]
    v_mfma_f32_16x16x32_bf16 v[184:187], v[112:115], v[68:71], v[184:187]
    v_mfma_f32_16x16x32_bf16 v[188:191], v[116:119], v[68:71], v[188:191]
    v_mfma_f32_16x16x32_bf16 v[192:195], v[96:99], v[72:75], v[192:195]
    v_mfma_f32_16x16x32_bf16 v[196:199], v[100:103], v[72:75], v[196:199]
    v_mfma_f32_16x16x32_bf16 v[200:203], v[104:107], v[72:75], v[200:203]
    v_mfma_f32_16x16x32_bf16 v[204:207], v[108:111], v[72:75], v[204:207]
    v_mfma_f32_16x16x32_bf16 v[208:211], v[112:115], v[72:75], v[208:211]
    v_mfma_f32_16x16x32_bf16 v[212:215], v[116:119], v[72:75], v[212:215]
    v_mfma_f32_16x16x32_bf16 v[216:219], v[96:99], v[76:79], v[216:219]
    v_mfma_f32_16x16x32_bf16 v[220:223], v[100:103], v[76:79], v[220:223]
    v_mfma_f32_16x16x32_bf16 v[224:227], v[104:107], v[76:79], v[224:227]
    v_mfma_f32_16x16x32_bf16 v[228:231], v[108:111], v[76:79], v[228:231]
    v_mfma_f32_16x16x32_bf16 v[232:235], v[112:115], v[76:79], v[232:235]
    v_mfma_f32_16x16x32_bf16 v[236:239], v[116:119], v[76:79], v[236:239]
    s_waitcnt lgkmcnt(0)
    s_waitcnt vmcnt(3)
    s_barrier
    s_add_u32 m0, s38, 0
    s_nop 0
    buffer_load_dwordx4 v18, s[8:11], s28 offen lds
    s_add_u32 m0, s38, 8192
    s_nop 0
    buffer_load_dwordx4 v18, s[8:11], s29 offen lds
    s_add_u32 m0, s38, 16384
    s_nop 0
    buffer_load_dwordx4 v19, s[52:55], s30 offen lds
    s_cmp_ge_u32 s20, 4
    s_cbranch_scc1 g1_skipg1au13
    s_add_u32 m0, s38, 24576
    s_nop 0
    buffer_load_dwordx4 v19, s[16:19], s31 offen lds
g1_skipg1au13:
    s_add_u32 s28, s28, 64
    s_add_u32 s29, s29, 64
    s_add_u32 s30, s30, s36
    s_add_u32 s31, s31, s36
    ds_read_b128 v[64:67], v23 offset:0
    ds_read_b128 v[68:71], v23 offset:1024
    ds_read_b128 v[72:75], v23 offset:2048
    ds_read_b128 v[76:79], v23 offset:3072
    ds_read_b64_tr_b16 v[96:97], v29 offset:0
    ds_read_b64_tr_b16 v[98:99], v29 offset:256
    ds_read_b64_tr_b16 v[100:101], v30 offset:0
    ds_read_b64_tr_b16 v[102:103], v30 offset:256
    ds_read_b64_tr_b16 v[104:105], v29 offset:2048
    ds_read_b64_tr_b16 v[106:107], v29 offset:2304
    ds_read_b64_tr_b16 v[108:109], v29 offset:6144
    ds_read_b64_tr_b16 v[110:111], v29 offset:6400
    ds_read_b64_tr_b16 v[112:113], v30 offset:6144
    ds_read_b64_tr_b16 v[114:115], v30 offset:6400
    ds_read_b64_tr_b16 v[116:117], v29 offset:8192
    ds_read_b64_tr_b16 v[118:119], v29 offset:8448
    v_mfma_f32_16x16x32_bf16 v[144:147], v[120:123], v[80:83], v[144:147]
    v_mfma_f32_16x16x32_bf16 v[148:151], v[124:127], v[80:83], v[148:151]
    v_mfma_f32_16x16x32_bf16 v[152:155], v[128:131], v[80:83], v[152:155]
    v_mfma_f32_16x16x32_bf16 v[156:159], v[132:135], v[80:83], v[156:159]
    v_mfma_f32_16x16x32_bf16 v[160:163], v[136:139], v[80:83], v[160:163]
    v_mfma_f32_16x16x32_bf16 v[164:167], v[140:143], v[80:83], v[164:167]
    v_mfma_f32_16x16x32_bf16 v[168:171], v[120:123], v[84:87], v[168:171]
    v_mfma_f32_16x16x32_bf16 v[172:175], v[124:127], v[84:87], v[172:175]
    v_mfma_f32_16x16x32_bf16 v[176:179], v[128:131], v[84:87], v[176:179]
    v_mfma_f32_16x16x32_bf16 v[180:183], v[132:135], v[84:87], v[180:183]
    v_mfma_f32_16x16x32_bf16 v[184:187], v[136:139], v[84:87], v[184:187]
    v_mfma_f32_16x16x32_bf16 v[188:191], v[140:143], v[84:87], v[188:191]
    v_mfma_f32_16x16x32_bf16 v[192:195], v[120:123], v[88:91], v[192:195]
    v_mfma_f32_16x16x32_bf16 v[196:199], v[124:127], v[88:91], v[196:199]
    v_mfma_f32_16x16x32_bf16 v[200:203], v[128:131], v[88:91], v[200:203]
    v_mfma_f32_16x16x32_bf16 v[204:207], v[132:135], v[88:91], v[204:207]
    v_mfma_f32_16x16x32_bf16 v[208:211], v[136:139], v[88:91], v[208:211]
    v_mfma_f32_16x16x32_bf16 v[212:215], v[140:143], v[88:91], v[212:215]
    v_mfma_f32_16x16x32_bf16 v[216:219], v[120:123], v[92:95], v[216:219]
    v_mfma_f32_16x16x32_bf16 v[220:223], v[124:127], v[92:95], v[220:223]
    v_mfma_f32_16x16x32_bf16 v[224:227], v[128:131], v[92:95], v[224:227]
    v_mfma_f32_16x16x32_bf16 v[228:231], v[132:135], v[92:95], v[228:231]
    v_mfma_f32_16x16x32_bf16 v[232:235], v[136:139], v[92:95], v[232:235]
    v_mfma_f32_16x16x32_bf16 v[236:239], v[140:143], v[92:95], v[236:239]
    s_waitcnt lgkmcnt(0)
    s_waitcnt vmcnt(3)
    s_barrier
    s_add_u32 m0, s38, 28672
    s_nop 0
    buffer_load_dwordx4 v18, s[8:11], s28 offen lds
    s_add_u32 m0, s38, 36864
    s_nop 0
    buffer_load_dwordx4 v18, s[8:11], s29 offen lds
    s_add_u32 m0, s38, 45056
    s_nop 0
    buffer_load_dwordx4 v19, s[52:55], s30 offen lds
    s_cmp_ge_u32 s20, 4
    s_cbranch_scc1 g1_skipg1au14
    s_add_u32 m0, s38, 53248
    s_nop 0
    buffer_load_dwordx4 v19, s[16:19], s31 offen lds
g1_skipg1au14:
    s_add_u32 s28, s28, 64
    s_add_u32 s29, s29, 64
    s_add_u32 s30, s30, s36
    s_add_u32 s31, s31, s36
    ds_read_b128 v[80:83], v23 offset:28672
    ds_read_b128 v[84:87], v23 offset:29696
    ds_read_b128 v[88:91], v23 offset:30720
    ds_read_b128 v[92:95], v23 offset:31744
    ds_read_b64_tr_b16 v[120:121], v29 offset:28672
    ds_read_b64_tr_b16 v[122:123], v29 offset:28928
    ds_read_b64_tr_b16 v[124:125], v30 offset:28672
    ds_read_b64_tr_b16 v[126:127], v30 offset:28928
    ds_read_b64_tr_b16 v[128:129], v29 offset:30720
    ds_read_b64_tr_b16 v[130:131], v29 offset:30976
    ds_read_b64_tr_b16 v[132:133], v29 offset:34816
    ds_read_b64_tr_b16 v[134:135], v29 offset:35072
    ds_read_b64_tr_b16 v[136:137], v30 offset:34816
    ds_read_b64_tr_b16 v[138:139], v30 offset:35072
    ds_read_b64_tr_b16 v[140:141], v29 offset:36864
    ds_read_b64_tr_b16 v[142:143], v29 offset:37120
    v_mfma_f32_16x16x32_bf16 v[144:147], v[96:99], v[64:67], v[144:147]
    v_mfma_f32_16x16x32_bf16 v[148:151], v[100:103], v[64:67], v[148:151]
    v_mfma_f32_16x16x32_bf16 v[152:155], v[104:107], v[64:67], v[152:155]
    v_mfma_f32_16x16x32_bf16 v[156:159], v[108:111], v[64:67], v[156:159]
    v_mfma_f32_16x16x32_bf16 v[160:163], v[112:115], v[64:67], v[160:163]
    v_mfma_f32_16x16x32_bf16 v[164:167], v[116:119], v[64:67], v[164:167]
    v_mfma_f32_16x16x32_bf16 v[168:171], v[96:99], v[68:71], v[168:171]
    v_mfma_f32_16x16x32_bf16 v[172:175], v[100:103], v[68:71], v[172:175]
    v_mfma_f32_16x16x32_bf16 v[176:179], v[104:107], v[68:71], v[176:179]
    v_mfma_f32_16x16x32_bf16 v[180:183], v[108:111], v[68:71], v[180:183]
    v_mfma_f32_16x16x32_bf16 v[184:187], v[112:115], v[68:71], v[184:187]
    v_mfma_f32_16x16x32_bf16 v[188:191], v[116:119], v[68:71], v[188:191]
    v_mfma_f32_16x16x32_bf16 v[192:195], v[96:99], v[72:75], v[192:195]
    v_mfma_f32_16x16x32_bf16 v[196:199], v[100:103], v[72:75], v[196:199]
    v_mfma_f32_16x16x32_bf16 v[200:203], v[104:107], v[72:75], v[200:203]
    v_mfma_f32_16x16x32_bf16 v[204:207], v[108:111], v[72:75], v[204:207]
    v_mfma_f32_16x16x32_bf16 v[208:211], v[112:115], v[72:75], v[208:211]
    v_mfma_f32_16x16x32_bf16 v[212:215], v[116:119], v[72:75], v[212:215]
    v_mfma_f32_16x16x32_bf16 v[216:219], v[96:99], v[76:79], v[216:219]
    v_mfma_f32_16x16x32_bf16 v[220:223], v[100:103], v[76:79], v[220:223]
    v_mfma_f32_16x16x32_bf16 v[224:227], v[104:107], v[76:79], v[224:227]
    v_mfma_f32_16x16x32_bf16 v[228:231], v[108:111], v[76:79], v[228:231]
    v_mfma_f32_16x16x32_bf16 v[232:235], v[112:115], v[76:79], v[232:235]
    v_mfma_f32_16x16x32_bf16 v[236:239], v[116:119], v[76:79], v[236:239]
    s_waitcnt lgkmcnt(0)
    s_waitcnt vmcnt(3)
    s_barrier
    s_add_u32 m0, s38, 57344
    s_nop 0
    buffer_load_dwordx4 v18, s[8:11], s28 offen lds
    s_add_u32 m0, s38, 65536
    s_nop 0
    buffer_load_dwordx4 v18, s[8:11], s29 offen lds
    s_add_u32 m0, s38, 73728
    s_nop 0
    buffer_load_dwordx4 v19, s[52:55], s30 offen lds
    s_cmp_ge_u32 s20, 4
    s_cbranch_scc1 g1_skipg1au15
    s_add_u32 m0, s38, 81920
    s_nop 0
    buffer_load_dwordx4 v19, s[16:19], s31 offen lds
g1_skipg1au15:
    s_add_u32 s28, s28, 64
    s_add_u32 s29, s29, 64
    s_add_u32 s30, s30, s36
    s_add_u32 s31, s31, s36
    ds_read_b128 v[64:67], v16 offset:0
    ds_read_b128 v[68:71], v16 offset:1024
    ds_read_b128 v[72:75], v16 offset:2048
    ds_read_b128 v[76:79], v16 offset:3072
    ds_read_b64_tr_b16 v[96:97], v21 offset:0
    ds_read_b64_tr_b16 v[98:99], v21 offset:256
    ds_read_b64_tr_b16 v[100:101], v22 offset:0
    ds_read_b64_tr_b16 v[102:103], v22 offset:256
    ds_read_b64_tr_b16 v[104:105], v21 offset:2048
    ds_read_b64_tr_b16 v[106:107], v21 offset:2304
    ds_read_b64_tr_b16 v[108:109], v21 offset:6144
    ds_read_b64_tr_b16 v[110:111], v21 offset:6400
    ds_read_b64_tr_b16 v[112:113], v22 offset:6144
    ds_read_b64_tr_b16 v[114:115], v22 offset:6400
    ds_read_b64_tr_b16 v[116:117], v21 offset:8192
    ds_read_b64_tr_b16 v[118:119], v21 offset:8448
    v_mfma_f32_16x16x32_bf16 v[144:147], v[120:123], v[80:83], v[144:147]
    v_mfma_f32_16x16x32_bf16 v[148:151], v[124:127], v[80:83], v[148:151]
    v_mfma_f32_16x16x32_bf16 v[152:155], v[128:131], v[80:83], v[152:155]
    v_mfma_f32_16x16x32_bf16 v[156:159], v[132:135], v[80:83], v[156:159]
    v_mfma_f32_16x16x32_bf16 v[160:163], v[136:139], v[80:83], v[160:163]
    v_mfma_f32_16x16x32_bf16 v[164:167], v[140:143], v[80:83], v[164:167]
    v_mfma_f32_16x16x32_bf16 v[168:171], v[120:123], v[84:87], v[168:171]
    v_mfma_f32_16x16x32_bf16 v[172:175], v[124:127], v[84:87], v[172:175]
    v_mfma_f32_16x16x32_bf16 v[176:179], v[128:131], v[84:87], v[176:179]
    v_mfma_f32_16x16x32_bf16 v[180:183], v[132:135], v[84:87], v[180:183]
    v_mfma_f32_16x16x32_bf16 v[184:187], v[136:139], v[84:87], v[184:187]
    v_mfma_f32_16x16x32_bf16 v[188:191], v[140:143], v[84:87], v[188:191]
    v_mfma_f32_16x16x32_bf16 v[192:195], v[120:123], v[88:91], v[192:195]
    v_mfma_f32_16x16x32_bf16 v[196:199], v[124:127], v[88:91], v[196:199]
    v_mfma_f32_16x16x32_bf16 v[200:203], v[128:131], v[88:91], v[200:203]
    v_mfma_f32_16x16x32_bf16 v[204:207], v[132:135], v[88:91], v[204:207]
    v_mfma_f32_16x16x32_bf16 v[208:211], v[136:139], v[88:91], v[208:211]
    v_mfma_f32_16x16x32_bf16 v[212:215], v[140:143], v[88:91], v[212:215]
    v_mfma_f32_16x16x32_bf16 v[216:219], v[120:123], v[92:95], v[216:219]
    v_mfma_f32_16x16x32_bf16 v[220:223], v[124:127], v[92:95], v[220:223]
    v_mfma_f32_16x16x32_bf16 v[224:227], v[128:131], v[92:95], v[224:227]
    v_mfma_f32_16x16x32_bf16 v[228:231], v[132:135], v[92:95], v[228:231]
    v_mfma_f32_16x16x32_bf16 v[232:235], v[136:139], v[92:95], v[232:235]
    v_mfma_f32_16x16x32_bf16 v[236:239], v[140:143], v[92:95], v[236:239]
    s_waitcnt lgkmcnt(0)
    s_waitcnt vmcnt(3)
    s_barrier
    s_add_u32 m0, s38, 86016
    s_nop 0
    buffer_load_dwordx4 v18, s[8:11], s28 offen lds
    s_add_u32 m0, s38, 94208
    s_nop 0
    buffer_load_dwordx4 v18, s[8:11], s29 offen lds
    s_add_u32 m0, s38, 102400
    s_nop 0
    buffer_load_dwordx4 v19, s[52:55], s30 offen lds
    s_cmp_ge_u32 s20, 4
    s_cbranch_scc1 g1_skipg1au16
    s_add_u32 m0, s38, 110592
    s_nop 0
    buffer_load_dwordx4 v19, s[16:19], s31 offen lds
g1_skipg1au16:
    s_add_u32 s28, s28, 64
    s_add_u32 s29, s29, 64
    s_add_u32 s30, s30, s36
    s_add_u32 s31, s31, s36
    ds_read_b128 v[80:83], v16 offset:28672
    ds_read_b128 v[84:87], v16 offset:29696
    ds_read_b128 v[88:91], v16 offset:30720
    ds_read_b128 v[92:95], v16 offset:31744
    ds_read_b64_tr_b16 v[120:121], v21 offset:28672
    ds_read_b64_tr_b16 v[122:123], v21 offset:28928
    ds_read_b64_tr_b16 v[124:125], v22 offset:28672
    ds_read_b64_tr_b16 v[126:127], v22 offset:28928
    ds_read_b64_tr_b16 v[128:129], v21 offset:30720
    ds_read_b64_tr_b16 v[130:131], v21 offset:30976
    ds_read_b64_tr_b16 v[132:133], v21 offset:34816
    ds_read_b64_tr_b16 v[134:135], v21 offset:35072
    ds_read_b64_tr_b16 v[136:137], v22 offset:34816
    ds_read_b64_tr_b16 v[138:139], v22 offset:35072
    ds_read_b64_tr_b16 v[140:141], v21 offset:36864
    ds_read_b64_tr_b16 v[142:143], v21 offset:37120
    v_mfma_f32_16x16x32_bf16 v[144:147], v[96:99], v[64:67], v[144:147]
    v_mfma_f32_16x16x32_bf16 v[148:151], v[100:103], v[64:67], v[148:151]
    v_mfma_f32_16x16x32_bf16 v[152:155], v[104:107], v[64:67], v[152:155]
    v_mfma_f32_16x16x32_bf16 v[156:159], v[108:111], v[64:67], v[156:159]
    v_mfma_f32_16x16x32_bf16 v[160:163], v[112:115], v[64:67], v[160:163]
    v_mfma_f32_16x16x32_bf16 v[164:167], v[116:119], v[64:67], v[164:167]
    v_mfma_f32_16x16x32_bf16 v[168:171], v[96:99], v[68:71], v[168:171]
    v_mfma_f32_16x16x32_bf16 v[172:175], v[100:103], v[68:71], v[172:175]
    v_mfma_f32_16x16x32_bf16 v[176:179], v[104:107], v[68:71], v[176:179]
    v_mfma_f32_16x16x32_bf16 v[180:183], v[108:111], v[68:71], v[180:183]
    v_mfma_f32_16x16x32_bf16 v[184:187], v[112:115], v[68:71], v[184:187]
    v_mfma_f32_16x16x32_bf16 v[188:191], v[116:119], v[68:71], v[188:191]
    v_mfma_f32_16x16x32_bf16 v[192:195], v[96:99], v[72:75], v[192:195]
    v_mfma_f32_16x16x32_bf16 v[196:199], v[100:103], v[72:75], v[196:199]
    v_mfma_f32_16x16x32_bf16 v[200:203], v[104:107], v[72:75], v[200:203]
    v_mfma_f32_16x16x32_bf16 v[204:207], v[108:111], v[72:75], v[204:207]
    v_mfma_f32_16x16x32_bf16 v[208:211], v[112:115], v[72:75], v[208:211]
    v_mfma_f32_16x16x32_bf16 v[212:215], v[116:119], v[72:75], v[212:215]
    v_mfma_f32_16x16x32_bf16 v[216:219], v[96:99], v[76:79], v[216:219]
    v_mfma_f32_16x16x32_bf16 v[220:223], v[100:103], v[76:79], v[220:223]
    v_mfma_f32_16x16x32_bf16 v[224:227], v[104:107], v[76:79], v[224:227]
    v_mfma_f32_16x16x32_bf16 v[228:231], v[108:111], v[76:79], v[228:231]
    v_mfma_f32_16x16x32_bf16 v[232:235], v[112:115], v[76:79], v[232:235]
    v_mfma_f32_16x16x32_bf16 v[236:239], v[116:119], v[76:79], v[236:239]
    s_waitcnt lgkmcnt(0)
    s_waitcnt vmcnt(3)
    s_barrier
    ds_read_b128 v[64:67], v23 offset:0
    ds_read_b128 v[68:71], v23 offset:1024
    ds_read_b128 v[72:75], v23 offset:2048
    ds_read_b128 v[76:79], v23 offset:3072
    ds_read_b64_tr_b16 v[96:97], v29 offset:0
    ds_read_b64_tr_b16 v[98:99], v29 offset:256
    ds_read_b64_tr_b16 v[100:101], v30 offset:0
    ds_read_b64_tr_b16 v[102:103], v30 offset:256
    ds_read_b64_tr_b16 v[104:105], v29 offset:2048
    ds_read_b64_tr_b16 v[106:107], v29 offset:2304
    ds_read_b64_tr_b16 v[108:109], v29 offset:6144
    ds_read_b64_tr_b16 v[110:111], v29 offset:6400
    ds_read_b64_tr_b16 v[112:113], v30 offset:6144
    ds_read_b64_tr_b16 v[114:115], v30 offset:6400
    ds_read_b64_tr_b16 v[116:117], v29 offset:8192
    ds_read_b64_tr_b16 v[118:119], v29 offset:8448
    v_mfma_f32_16x16x32_bf16 v[144:147], v[120:123], v[80:83], v[144:147]
    v_mfma_f32_16x16x32_bf16 v[148:151], v[124:127], v[80:83], v[148:151]
    v_mfma_f32_16x16x32_bf16 v[152:155], v[128:131], v[80:83], v[152:155]
    v_mfma_f32_16x16x32_bf16 v[156:159], v[132:135], v[80:83], v[156:159]
    v_mfma_f32_16x16x32_bf16 v[160:163], v[136:139], v[80:83], v[160:163]
    v_mfma_f32_16x16x32_bf16 v[164:167], v[140:143], v[80:83], v[164:167]
    v_mfma_f32_16x16x32_bf16 v[168:171], v[120:123], v[84:87], v[168:171]
    v_mfma_f32_16x16x32_bf16 v[172:175], v[124:127], v[84:87], v[172:175]
    v_mfma_f32_16x16x32_bf16 v[176:179], v[128:131], v[84:87], v[176:179]
    v_mfma_f32_16x16x32_bf16 v[180:183], v[132:135], v[84:87], v[180:183]
    v_mfma_f32_16x16x32_bf16 v[184:187], v[136:139], v[84:87], v[184:187]
    v_mfma_f32_16x16x32_bf16 v[188:191], v[140:143], v[84:87], v[188:191]
    v_mfma_f32_16x16x32_bf16 v[192:195], v[120:123], v[88:91], v[192:195]
    v_mfma_f32_16x16x32_bf16 v[196:199], v[124:127], v[88:91], v[196:199]
    v_mfma_f32_16x16x32_bf16 v[200:203], v[128:131], v[88:91], v[200:203]
    v_mfma_f32_16x16x32_bf16 v[204:207], v[132:135], v[88:91], v[204:207]
    v_mfma_f32_16x16x32_bf16 v[208:211], v[136:139], v[88:91], v[208:211]
    v_mfma_f32_16x16x32_bf16 v[212:215], v[140:143], v[88:91], v[212:215]
    v_mfma_f32_16x16x32_bf16 v[216:219], v[120:123], v[92:95], v[216:219]
    v_mfma_f32_16x16x32_bf16 v[220:223], v[124:127], v[92:95], v[220:223]
    v_mfma_f32_16x16x32_bf16 v[224:227], v[128:131], v[92:95], v[224:227]
    v_mfma_f32_16x16x32_bf16 v[228:231], v[132:135], v[92:95], v[228:231]
    v_mfma_f32_16x16x32_bf16 v[232:235], v[136:139], v[92:95], v[232:235]
    v_mfma_f32_16x16x32_bf16 v[236:239], v[140:143], v[92:95], v[236:239]
    s_waitcnt lgkmcnt(0)
    s_waitcnt vmcnt(0)
    s_barrier
    ds_read_b128 v[80:83], v23 offset:28672
    ds_read_b128 v[84:87], v23 offset:29696
    ds_read_b128 v[88:91], v23 offset:30720
    ds_read_b128 v[92:95], v23 offset:31744
    ds_read_b64_tr_b16 v[120:121], v29 offset:28672
    ds_read_b64_tr_b16 v[122:123], v29 offset:28928
    ds_read_b64_tr_b16 v[124:125], v30 offset:28672
    ds_read_b64_tr_b16 v[126:127], v30 offset:28928
    ds_read_b64_tr_b16 v[128:129], v29 offset:30720
    ds_read_b64_tr_b16 v[130:131], v29 offset:30976
    ds_read_b64_tr_b16 v[132:133], v29 offset:34816
    ds_read_b64_tr_b16 v[134:135], v29 offset:35072
    ds_read_b64_tr_b16 v[136:137], v30 offset:34816
    ds_read_b64_tr_b16 v[138:139], v30 offset:35072
    ds_read_b64_tr_b16 v[140:141], v29 offset:36864
    ds_read_b64_tr_b16 v[142:143], v29 offset:37120
    v_mfma_f32_16x16x32_bf16 v[144:147], v[96:99], v[64:67], v[144:147]
    v_mfma_f32_16x16x32_bf16 v[148:151], v[100:103], v[64:67], v[148:151]
    v_mfma_f32_16x16x32_bf16 v[152:155], v[104:107], v[64:67], v[152:155]
    v_mfma_f32_16x16x32_bf16 v[156:159], v[108:111], v[64:67], v[156:159]
    v_mfma_f32_16x16x32_bf16 v[160:163], v[112:115], v[64:67], v[160:163]
    v_mfma_f32_16x16x32_bf16 v[164:167], v[116:119], v[64:67], v[164:167]
    v_mfma_f32_16x16x32_bf16 v[168:171], v[96:99], v[68:71], v[168:171]
    v_mfma_f32_16x16x32_bf16 v[172:175], v[100:103], v[68:71], v[172:175]
    v_mfma_f32_16x16x32_bf16 v[176:179], v[104:107], v[68:71], v[176:179]
    v_mfma_f32_16x16x32_bf16 v[180:183], v[108:111], v[68:71], v[180:183]
    v_mfma_f32_16x16x32_bf16 v[184:187], v[112:115], v[68:71], v[184:187]
    v_mfma_f32_16x16x32_bf16 v[188:191], v[116:119], v[68:71], v[188:191]
    v_mfma_f32_16x16x32_bf16 v[192:195], v[96:99], v[72:75], v[192:195]
    v_mfma_f32_16x16x32_bf16 v[196:199], v[100:103], v[72:75], v[196:199]
    v_mfma_f32_16x16x32_bf16 v[200:203], v[104:107], v[72:75], v[200:203]
    v_mfma_f32_16x16x32_bf16 v[204:207], v[108:111], v[72:75], v[204:207]
    v_mfma_f32_16x16x32_bf16 v[208:211], v[112:115], v[72:75], v[208:211]
    v_mfma_f32_16x16x32_bf16 v[212:215], v[116:119], v[72:75], v[212:215]
    v_mfma_f32_16x16x32_bf16 v[216:219], v[96:99], v[76:79], v[216:219]
    v_mfma_f32_16x16x32_bf16 v[220:223], v[100:103], v[76:79], v[220:223]
    v_mfma_f32_16x16x32_bf16 v[224:227], v[104:107], v[76:79], v[224:227]
    v_mfma_f32_16x16x32_bf16 v[228:231], v[108:111], v[76:79], v[228:231]
    v_mfma_f32_16x16x32_bf16 v[232:235], v[112:115], v[76:79], v[232:235]
    v_mfma_f32_16x16x32_bf16 v[236:239], v[116:119], v[76:79], v[236:239]
    s_waitcnt lgkmcnt(0)
    v_mfma_f32_16x16x32_bf16 v[144:147], v[120:123], v[80:83], v[144:147]
    v_mfma_f32_16x16x32_bf16 v[148:151], v[124:127], v[80:83], v[148:151]
    v_mfma_f32_16x16x32_bf16 v[152:155], v[128:131], v[80:83], v[152:155]
    v_mfma_f32_16x16x32_bf16 v[156:159], v[132:135], v[80:83], v[156:159]
    v_mfma_f32_16x16x32_bf16 v[160:163], v[136:139], v[80:83], v[160:163]
    v_mfma_f32_16x16x32_bf16 v[164:167], v[140:143], v[80:83], v[164:167]
    v_mfma_f32_16x16x32_bf16 v[168:171], v[120:123], v[84:87], v[168:171]
    v_mfma_f32_16x16x32_bf16 v[172:175], v[124:127], v[84:87], v[172:175]
    v_mfma_f32_16x16x32_bf16 v[176:179], v[128:131], v[84:87], v[176:179]
    v_mfma_f32_16x16x32_bf16 v[180:183], v[132:135], v[84:87], v[180:183]
    v_mfma_f32_16x16x32_bf16 v[184:187], v[136:139], v[84:87], v[184:187]
    v_mfma_f32_16x16x32_bf16 v[188:191], v[140:143], v[84:87], v[188:191]
    v_mfma_f32_16x16x32_bf16 v[192:195], v[120:123], v[88:91], v[192:195]
    v_mfma_f32_16x16x32_bf16 v[196:199], v[124:127], v[88:91], v[196:199]
    v_mfma_f32_16x16x32_bf16 v[200:203], v[128:131], v[88:91], v[200:203]
    v_mfma_f32_16x16x32_bf16 v[204:207], v[132:135], v[88:91], v[204:207]
    v_mfma_f32_16x16x32_bf16 v[208:211], v[136:139], v[88:91], v[208:211]
    v_mfma_f32_16x16x32_bf16 v[212:215], v[140:143], v[88:91], v[212:215]
    v_mfma_f32_16x16x32_bf16 v[216:219], v[120:123], v[92:95], v[216:219]
    v_mfma_f32_16x16x32_bf16 v[220:223], v[124:127], v[92:95], v[220:223]
    v_mfma_f32_16x16x32_bf16 v[224:227], v[128:131], v[92:95], v[224:227]
    v_mfma_f32_16x16x32_bf16 v[228:231], v[132:135], v[92:95], v[228:231]
    v_mfma_f32_16x16x32_bf16 v[232:235], v[136:139], v[92:95], v[232:235]
    v_mfma_f32_16x16x32_bf16 v[236:239], v[140:143], v[92:95], v[236:239]
    s_nop 15
    s_nop 3
    s_branch g1_epi
g1_wn1:
    s_add_u32 m0, s38, 0
    s_nop 0
    buffer_load_dwordx4 v18, s[8:11], s28 offen lds
    s_add_u32 m0, s38, 8192
    s_nop 0
    buffer_load_dwordx4 v18, s[8:11], s29 offen lds
    s_add_u32 m0, s38, 16384
    s_nop 0
    buffer_load_dwordx4 v19, s[52:55], s30 offen lds
    s_cmp_ge_u32 s20, 4
    s_cbranch_scc1 g1_skipg1bp0
    s_add_u32 m0, s38, 24576
    s_nop 0
    buffer_load_dwordx4 v19, s[16:19], s31 offen lds
g1_skipg1bp0:
    s_add_u32 s28, s28, 64
    s_add_u32 s29, s29, 64
    s_add_u32 s30, s30, s36
    s_add_u32 s31, s31, s36
    s_add_u32 m0, s38, 28672
    s_nop 0
    buffer_load_dwordx4 v18, s[8:11], s28 offen lds
    s_add_u32 m0, s38, 36864
    s_nop 0
    buffer_load_dwordx4 v18, s[8:11], s29 offen lds
    s_add_u32 m0, s38, 45056
    s_nop 0
    buffer_load_dwordx4 v19, s[52:55], s30 offen lds
    s_cmp_ge_u32 s20, 4
    s_cbranch_scc1 g1_skipg1bp1
    s_add_u32 m0, s38, 53248
    s_nop 0
    buffer_load_dwordx4 v19, s[16:19], s31 offen lds
g1_skipg1bp1:
    s_add_u32 s28, s28, 64
    s_add_u32 s29, s29, 64
    s_add_u32 s30, s30, s36
    s_add_u32 s31, s31, s36
    s_add_u32 m0, s38, 57344
    s_nop 0
    buffer_load_dwordx4 v18, s[8:11], s28 offen lds
    s_add_u32 m0, s38, 65536
    s_nop 0
    buffer_load_dwordx4 v18, s[8:11], s29 offen lds
    s_add_u32 m0, s38, 73728
    s_nop 0
    buffer_load_dwordx4 v19, s[52:55], s30 offen lds
    s_cmp_ge_u32 s20, 4
    s_cbranch_scc1 g1_skipg1bp2
    s_add_u32 m0, s38, 81920
    s_nop 0
    buffer_load_dwordx4 v19, s[16:19], s31 offen lds
g1_skipg1bp2:
    s_add_u32 s28, s28, 64
    s_add_u32 s29, s29, 64
    s_add_u32 s30, s30, s36
    s_add_u32 s31, s31, s36
    s_waitcnt vmcnt(6)
    s_barrier
    ds_read_b128 v[64:67], v16 offset:0
    ds_read_b128 v[68:71], v16 offset:1024
    ds_read_b128 v[72:75], v16 offset:2048
    ds_read_b128 v[76:79], v16 offset:3072
    ds_read_b64_tr_b16 v[96:97], v22 offset:2048
    ds_read_b64_tr_b16 v[98:99], v22 offset:2304
    ds_read_b64_tr_b16 v[100:101], v21 offset:4096
    ds_read_b64_tr_b16 v[102:103], v21 offset:4352
    ds_read_b64_tr_b16 v[104:105], v22 offset:4096
    ds_read_b64_tr_b16 v[106:107], v22 offset:4352
    ds_read_b64_tr_b16 v[108:109], v22 offset:8192
    ds_read_b64_tr_b16 v[110:111], v22 offset:8448
    ds_read_b64_tr_b16 v[112:113], v21 offset:10240
    ds_read_b64_tr_b16 v[114:115], v21 offset:10496
    ds_read_b64_tr_b16 v[116:117], v22 offset:10240
    ds_read_b64_tr_b16 v[118:119], v22 offset:10496
    s_waitcnt lgkmcnt(0)
    s_waitcnt vmcnt(3)
    s_barrier
    s_add_u32 m0, s38, 86016
    s_nop 0
    buffer_load_dwordx4 v18, s[8:11], s28 offen lds
    s_add_u32 m0, s38, 94208
    s_nop 0
    buffer_load_dwordx4 v18, s[8:11], s29 offen lds
    s_add_u32 m0, s38, 102400
    s_nop 0
    buffer_load_dwordx4 v19, s[52:55], s30 offen lds
    s_cmp_ge_u32 s20, 4
    s_cbranch_scc1 g1_skipg1bu0
    s_add_u32 m0, s38, 110592
    s_nop 0
    buffer_load_dwordx4 v19, s[16:19], s31 offen lds
g1_skipg1bu0:
    s_add_u32 s28, s28, 64
    s_add_u32 s29, s29, 64
    s_add_u32 s30, s30, s36
    s_add_u32 s31, s31, s36
    ds_read_b128 v[80:83], v16 offset:28672
    ds_read_b128 v[84:87], v16 offset:29696
    ds_read_b128 v[88:91], v16 offset:30720
    ds_read_b128 v[92:95], v16 offset:31744
    ds_read_b64_tr_b16 v[120:121], v22 offset:30720
    ds_read_b64_tr_b16 v[122:123], v22 offset:30976
    ds_read_b64_tr_b16 v[124:125], v21 offset:32768
    ds_read_b64_tr_b16 v[126:127], v21 offset:33024
    ds_read_b64_tr_b16 v[128:129], v22 offset:32768
    ds_read_b64_tr_b16 v[130:131], v22 offset:33024
    ds_read_b64_tr_b16 v[132:133], v22 offset:36864
    ds_read_b64_tr_b16 v[134:135], v22 offset:37120
    ds_read_b64_tr_b16 v[136:137], v21 offset:38912
    ds_read_b64_tr_b16 v[138:139], v21 offset:39168
    ds_read_b64_tr_b16 v[140:141], v22 offset:38912
    ds_read_b64_tr_b16 v[142:143], v22 offset:39168
    v_mfma_f32_16x16x32_bf16 v[144:147], v[96:99], v[64:67], v[144:147]
    v_mfma_f32_16x16x32_bf16 v[148:151], v[100:103], v[64:67], v[148:151]
    v_mfma_f32_16x16x32_bf16 v[152:155], v[104:107], v[64:67], v[152:155]
    v_mfma_f32_16x16x32_bf16 v[156:159], v[108:111], v[64:67], v[156:159]
    v_mfma_f32_16x16x32_bf16 v[160:163], v[112:115], v[64:67], v[160:163]
    v_mfma_f32_16x16x32_bf16 v[164:167], v[116:119], v[64:67], v[164:167]
    v_mfma_f32_16x16x32_bf16 v[168:171], v[96:99], v[68:71], v[168:171]
    v_mfma_f32_16x16x32_bf16 v[172:175], v[100:103], v[68:71], v[172:175]
    v_mfma_f32_16x16x32_bf16 v[176:179], v[104:107], v[68:71], v[176:179]
    v_mfma_f32_16x16x32_bf16 v[180:183], v[108:111], v[68:71], v[180:183]
    v_mfma_f32_16x16x32_bf16 v[184:187], v[112:115], v[68:71], v[184:187]
    v_mfma_f32_16x16x32_bf16 v[188:191], v[116:119], v[68:71], v[188:191]
    v_mfma_f32_16x16x32_bf16 v[192:195], v[96:99], v[72:75], v[192:195]
    v_mfma_f32_16x16x32_bf16 v[196:199], v[100:103], v[72:75], v[196:199]
    v_mfma_f32_16x16x32_bf16 v[200:203], v[104:107], v[72:75], v[200:203]
    v_mfma_f32_16x16x32_bf16 v[204:207], v[108:111], v[72:75], v[204:207]
    v_mfma_f32_16x16x32_bf16 v[208:211], v[112:115], v[72:75], v[208:211]
    v_mfma_f32_16x16x32_bf16 v[212:215], v[116:119], v[72:75], v[212:215]
    v_mfma_f32_16x16x32_bf16 v[216:219], v[96:99], v[76:79], v[216:219]
    v_mfma_f32_16x16x32_bf16 v[220:223], v[100:103], v[76:79], v[220:223]
    v_mfma_f32_16x16x32_bf16 v[224:227], v[104:107], v[76:79], v[224:227]
    v_mfma_f32_16x16x32_bf16 v[228:231], v[108:111], v[76:79], v[228:231]
    v_mfma_f32_16x16x32_bf16 v[232:235], v[112:115], v[76:79], v[232:235]
    v_mfma_f32_16x16x32_bf16 v[236:239], v[116:119], v[76:79], v[236:239]
    s_waitcnt lgkmcnt(0)
    s_waitcnt vmcnt(3)
    s_barrier
    s_add_u32 m0, s38, 0
    s_nop 0
    buffer_load_dwordx4 v18, s[8:11], s28 offen lds
    s_add_u32 m0, s38, 8192
    s_nop 0
    buffer_load_dwordx4 v18, s[8:11], s29 offen lds
    s_add_u32 m0, s38, 16384
    s_nop 0
    buffer_load_dwordx4 v19, s[52:55], s30 offen lds
    s_cmp_ge_u32 s20, 4
    s_cbranch_scc1 g1_skipg1bu1
    s_add_u32 m0, s38, 24576
    s_nop 0
    buffer_load_dwordx4 v19, s[16:19], s31 offen lds
g1_skipg1bu1:
    s_add_u32 s28, s28, 64
    s_add_u32 s29, s29, 64
    s_add_u32 s30, s30, s36
    s_add_u32 s31, s31, s36
    ds_read_b128 v[64:67], v23 offset:0
    ds_read_b128 v[68:71], v23 offset:1024
    ds_read_b128 v[72:75], v23 offset:2048
    ds_read_b128 v[76:79], v23 offset:3072
    ds_read_b64_tr_b16 v[96:97], v30 offset:2048
    ds_read_b64_tr_b16 v[98:99], v30 offset:2304
    ds_read_b64_tr_b16 v[100:101], v29 offset:4096
    ds_read_b64_tr_b16 v[102:103], v29 offset:4352
    ds_read_b64_tr_b16 v[104:105], v30 offset:4096
    ds_read_b64_tr_b16 v[106:107], v30 offset:4352
    ds_read_b64_tr_b16 v[108:109], v30 offset:8192
    ds_read_b64_tr_b16 v[110:111], v30 offset:8448
    ds_read_b64_tr_b16 v[112:113], v29 offset:10240
    ds_read_b64_tr_b16 v[114:115], v29 offset:10496
    ds_read_b64_tr_b16 v[116:117], v30 offset:10240
    ds_read_b64_tr_b16 v[118:119], v30 offset:10496
    v_mfma_f32_16x16x32_bf16 v[144:147], v[120:123], v[80:83], v[144:147]
    v_mfma_f32_16x16x32_bf16 v[148:151], v[124:127], v[80:83], v[148:151]
    v_mfma_f32_16x16x32_bf16 v[152:155], v[128:131], v[80:83], v[152:155]
    v_mfma_f32_16x16x32_bf16 v[156:159], v[132:135], v[80:83], v[156:159]
    v_mfma_f32_16x16x32_bf16 v[160:163], v[136:139], v[80:83], v[160:163]
    v_mfma_f32_16x16x32_bf16 v[164:167], v[140:143], v[80:83], v[164:167]
    v_mfma_f32_16x16x32_bf16 v[168:171], v[120:123], v[84:87], v[168:171]
    v_mfma_f32_16x16x32_bf16 v[172:175], v[124:127], v[84:87], v[172:175]
    v_mfma_f32_16x16x32_bf16 v[176:179], v[128:131], v[84:87], v[176:179]
    v_mfma_f32_16x16x32_bf16 v[180:183], v[132:135], v[84:87], v[180:183]
    v_mfma_f32_16x16x32_bf16 v[184:187], v[136:139], v[84:87], v[184:187]
    v_mfma_f32_16x16x32_bf16 v[188:191], v[140:143], v[84:87], v[188:191]
    v_mfma_f32_16x16x32_bf16 v[192:195], v[120:123], v[88:91], v[192:195]
    v_mfma_f32_16x16x32_bf16 v[196:199], v[124:127], v[88:91], v[196:199]
    v_mfma_f32_16x16x32_bf16 v[200:203], v[128:131], v[88:91], v[200:203]
    v_mfma_f32_16x16x32_bf16 v[204:207], v[132:135], v[88:91], v[204:207]
    v_mfma_f32_16x16x32_bf16 v[208:211], v[136:139], v[88:91], v[208:211]
    v_mfma_f32_16x16x32_bf16 v[212:215], v[140:143], v[88:91], v[212:215]
    v_mfma_f32_16x16x32_bf16 v[216:219], v[120:123], v[92:95], v[216:219]
    v_mfma_f32_16x16x32_bf16 v[220:223], v[124:127], v[92:95], v[220:223]
    v_mfma_f32_16x16x32_bf16 v[224:227], v[128:131], v[92:95], v[224:227]
    v_mfma_f32_16x16x32_bf16 v[228:231], v[132:135], v[92:95], v[228:231]
    v_mfma_f32_16x16x32_bf16 v[232:235], v[136:139], v[92:95], v[232:235]
    v_mfma_f32_16x16x32_bf16 v[236:239], v[140:143], v[92:95], v[236:239]
    s_waitcnt lgkmcnt(0)
    s_waitcnt vmcnt(3)
    s_barrier
    s_add_u32 m0, s38, 28672
    s_nop 0
    buffer_load_dwordx4 v18, s[8:11], s28 offen lds
    s_add_u32 m0, s38, 36864
    s_nop 0
    buffer_load_dwordx4 v18, s[8:11], s29 offen lds
    s_add_u32 m0, s38, 45056
    s_nop 0
    buffer_load_dwordx4 v19, s[52:55], s30 offen lds
    s_cmp_ge_u32 s20, 4
    s_cbranch_scc1 g1_skipg1bu2
    s_add_u32 m0, s38, 53248
    s_nop 0
    buffer_load_dwordx4 v19, s[16:19], s31 offen lds
g1_skipg1bu2:
    s_add_u32 s28, s28, 64
    s_add_u32 s29, s29, 64
    s_add_u32 s30, s30, s36
    s_add_u32 s31, s31, s36
    ds_read_b128 v[80:83], v23 offset:28672
    ds_read_b128 v[84:87], v23 offset:29696
    ds_read_b128 v[88:91], v23 offset:30720
    ds_read_b128 v[92:95], v23 offset:31744
    ds_read_b64_tr_b16 v[120:121], v30 offset:30720
    ds_read_b64_tr_b16 v[122:123], v30 offset:30976
    ds_read_b64_tr_b16 v[124:125], v29 offset:32768
    ds_read_b64_tr_b16 v[126:127], v29 offset:33024
    ds_read_b64_tr_b16 v[128:129], v30 offset:32768
    ds_read_b64_tr_b16 v[130:131], v30 offset:33024
    ds_read_b64_tr_b16 v[132:133], v30 offset:36864
    ds_read_b64_tr_b16 v[134:135], v30 offset:37120
    ds_read_b64_tr_b16 v[136:137], v29 offset:38912
    ds_read_b64_tr_b16 v[138:139], v29 offset:39168
    ds_read_b64_tr_b16 v[140:141], v30 offset:38912
    ds_read_b64_tr_b16 v[142:143], v30 offset:39168
    v_mfma_f32_16x16x32_bf16 v[144:147], v[96:99], v[64:67], v[144:147]
    v_mfma_f32_16x16x32_bf16 v[148:151], v[100:103], v[64:67], v[148:151]
    v_mfma_f32_16x16x32_bf16 v[152:155], v[104:107], v[64:67], v[152:155]
    v_mfma_f32_16x16x32_bf16 v[156:159], v[108:111], v[64:67], v[156:159]
    v_mfma_f32_16x16x32_bf16 v[160:163], v[112:115], v[64:67], v[160:163]
    v_mfma_f32_16x16x32_bf16 v[164:167], v[116:119], v[64:67], v[164:167]
    v_mfma_f32_16x16x32_bf16 v[168:171], v[96:99], v[68:71], v[168:171]
    v_mfma_f32_16x16x32_bf16 v[172:175], v[100:103], v[68:71], v[172:175]
    v_mfma_f32_16x16x32_bf16 v[176:179], v[104:107], v[68:71], v[176:179]
    v_mfma_f32_16x16x32_bf16 v[180:183], v[108:111], v[68:71], v[180:183]
    v_mfma_f32_16x16x32_bf16 v[184:187], v[112:115], v[68:71], v[184:187]
    v_mfma_f32_16x16x32_bf16 v[188:191], v[116:119], v[68:71], v[188:191]
    v_mfma_f32_16x16x32_bf16 v[192:195], v[96:99], v[72:75], v[192:195]
    v_mfma_f32_16x16x32_bf16 v[196:199], v[100:103], v[72:75], v[196:199]
    v_mfma_f32_16x16x32_bf16 v[200:203], v[104:107], v[72:75], v[200:203]
    v_mfma_f32_16x16x32_bf16 v[204:207], v[108:111], v[72:75], v[204:207]
    v_mfma_f32_16x16x32_bf16 v[208:211], v[112:115], v[72:75], v[208:211]
    v_mfma_f32_16x16x32_bf16 v[212:215], v[116:119], v[72:75], v[212:215]
    v_mfma_f32_16x16x32_bf16 v[216:219], v[96:99], v[76:79], v[216:219]
    v_mfma_f32_16x16x32_bf16 v[220:223], v[100:103], v[76:79], v[220:223]
    v_mfma_f32_16x16x32_bf16 v[224:227], v[104:107], v[76:79], v[224:227]
    v_mfma_f32_16x16x32_bf16 v[228:231], v[108:111], v[76:79], v[228:231]
    v_mfma_f32_16x16x32_bf16 v[232:235], v[112:115], v[76:79], v[232:235]
    v_mfma_f32_16x16x32_bf16 v[236:239], v[116:119], v[76:79], v[236:239]
    s_waitcnt lgkmcnt(0)
    s_waitcnt vmcnt(3)
    s_barrier
    s_add_u32 m0, s38, 57344
    s_nop 0
    buffer_load_dwordx4 v18, s[8:11], s28 offen lds
    s_add_u32 m0, s38, 65536
    s_nop 0
    buffer_load_dwordx4 v18, s[8:11], s29 offen lds
    s_add_u32 m0, s38, 73728
    s_nop 0
    buffer_load_dwordx4 v19, s[52:55], s30 offen lds
    s_cmp_ge_u32 s20, 4
    s_cbranch_scc1 g1_skipg1bu3
    s_add_u32 m0, s38, 81920
    s_nop 0
    buffer_load_dwordx4 v19, s[16:19], s31 offen lds
g1_skipg1bu3:
    s_add_u32 s28, s28, 64
    s_add_u32 s29, s29, 64
    s_add_u32 s30, s30, s36
    s_add_u32 s31, s31, s36
    ds_read_b128 v[64:67], v16 offset:0
    ds_read_b128 v[68:71], v16 offset:1024
    ds_read_b128 v[72:75], v16 offset:2048
    ds_read_b128 v[76:79], v16 offset:3072
    ds_read_b64_tr_b16 v[96:97], v22 offset:2048
    ds_read_b64_tr_b16 v[98:99], v22 offset:2304
    ds_read_b64_tr_b16 v[100:101], v21 offset:4096
    ds_read_b64_tr_b16 v[102:103], v21 offset:4352
    ds_read_b64_tr_b16 v[104:105], v22 offset:4096
    ds_read_b64_tr_b16 v[106:107], v22 offset:4352
    ds_read_b64_tr_b16 v[108:109], v22 offset:8192
    ds_read_b64_tr_b16 v[110:111], v22 offset:8448
    ds_read_b64_tr_b16 v[112:113], v21 offset:10240
    ds_read_b64_tr_b16 v[114:115], v21 offset:10496
    ds_read_b64_tr_b16 v[116:117], v22 offset:10240
    ds_read_b64_tr_b16 v[118:119], v22 offset:10496
    v_mfma_f32_16x16x32_bf16 v[144:147], v[120:123], v[80:83], v[144:147]
    v_mfma_f32_16x16x32_bf16 v[148:151], v[124:127], v[80:83], v[148:151]
    v_mfma_f32_16x16x32_bf16 v[152:155], v[128:131], v[80:83], v[152:155]
    v_mfma_f32_16x16x32_bf16 v[156:159], v[132:135], v[80:83], v[156:159]
    v_mfma_f32_16x16x32_bf16 v[160:163], v[136:139], v[80:83], v[160:163]
    v_mfma_f32_16x16x32_bf16 v[164:167], v[140:143], v[80:83], v[164:167]
    v_mfma_f32_16x16x32_bf16 v[168:171], v[120:123], v[84:87], v[168:171]
    v_mfma_f32_16x16x32_bf16 v[172:175], v[124:127], v[84:87], v[172:175]
    v_mfma_f32_16x16x32_bf16 v[176:179], v[128:131], v[84:87], v[176:179]
    v_mfma_f32_16x16x32_bf16 v[180:183], v[132:135], v[84:87], v[180:183]
    v_mfma_f32_16x16x32_bf16 v[184:187], v[136:139], v[84:87], v[184:187]
    v_mfma_f32_16x16x32_bf16 v[188:191], v[140:143], v[84:87], v[188:191]
    v_mfma_f32_16x16x32_bf16 v[192:195], v[120:123], v[88:91], v[192:195]
    v_mfma_f32_16x16x32_bf16 v[196:199], v[124:127], v[88:91], v[196:199]
    v_mfma_f32_16x16x32_bf16 v[200:203], v[128:131], v[88:91], v[200:203]
    v_mfma_f32_16x16x32_bf16 v[204:207], v[132:135], v[88:91], v[204:207]
    v_mfma_f32_16x16x32_bf16 v[208:211], v[136:139], v[88:91], v[208:211]
    v_mfma_f32_16x16x32_bf16 v[212:215], v[140:143], v[88:91], v[212:215]
    v_mfma_f32_16x16x32_bf16 v[216:219], v[120:123], v[92:95], v[216:219]
    v_mfma_f32_16x16x32_bf16 v[220:223], v[124:127], v[92:95], v[220:223]
    v_mfma_f32_16x16x32_bf16 v[224:227], v[128:131], v[92:95], v[224:227]
    v_mfma_f32_16x16x32_bf16 v[228:231], v[132:135], v[92:95], v[228:231]
    v_mfma_f32_16x16x32_bf16 v[232:235], v[136:139], v[92:95], v[232:235]
    v_mfma_f32_16x16x32_bf16 v[236:239], v[140:143], v[92:95], v[236:239]
    s_waitcnt lgkmcnt(0)
    s_waitcnt vmcnt(3)
    s_barrier
    s_add_u32 m0, s38, 86016
    s_nop 0
    buffer_load_dwordx4 v18, s[8:11], s28 offen lds
    s_add_u32 m0, s38, 94208
    s_nop 0
    buffer_load_dwordx4 v18, s[8:11], s29 offen lds
    s_add_u32 m0, s38, 102400
    s_nop 0
    buffer_load_dwordx4 v19, s[52:55], s30 offen lds
    s_cmp_ge_u32 s20, 4
    s_cbranch_scc1 g1_skipg1bu4
    s_add_u32 m0, s38, 110592
    s_nop 0
    buffer_load_dwordx4 v19, s[16:19], s31 offen lds
g1_skipg1bu4:
    s_add_u32 s28, s28, 64
    s_add_u32 s29, s29, 64
    s_add_u32 s30, s30, s36
    s_add_u32 s31, s31, s36
    ds_read_b128 v[80:83], v16 offset:28672
    ds_read_b128 v[84:87], v16 offset:29696
    ds_read_b128 v[88:91], v16 offset:30720
    ds_read_b128 v[92:95], v16 offset:31744
    ds_read_b64_tr_b16 v[120:121], v22 offset:30720
    ds_read_b64_tr_b16 v[122:123], v22 offset:30976
    ds_read_b64_tr_b16 v[124:125], v21 offset:32768
    ds_read_b64_tr_b16 v[126:127], v21 offset:33024
    ds_read_b64_tr_b16 v[128:129], v22 offset:32768
    ds_read_b64_tr_b16 v[130:131], v22 offset:33024
    ds_read_b64_tr_b16 v[132:133], v22 offset:36864
    ds_read_b64_tr_b16 v[134:135], v22 offset:37120
    ds_read_b64_tr_b16 v[136:137], v21 offset:38912
    ds_read_b64_tr_b16 v[138:139], v21 offset:39168
    ds_read_b64_tr_b16 v[140:141], v22 offset:38912
    ds_read_b64_tr_b16 v[142:143], v22 offset:39168
    v_mfma_f32_16x16x32_bf16 v[144:147], v[96:99], v[64:67], v[144:147]
    v_mfma_f32_16x16x32_bf16 v[148:151], v[100:103], v[64:67], v[148:151]
    v_mfma_f32_16x16x32_bf16 v[152:155], v[104:107], v[64:67], v[152:155]
    v_mfma_f32_16x16x32_bf16 v[156:159], v[108:111], v[64:67], v[156:159]
    v_mfma_f32_16x16x32_bf16 v[160:163], v[112:115], v[64:67], v[160:163]
    v_mfma_f32_16x16x32_bf16 v[164:167], v[116:119], v[64:67], v[164:167]
    v_mfma_f32_16x16x32_bf16 v[168:171], v[96:99], v[68:71], v[168:171]
    v_mfma_f32_16x16x32_bf16 v[172:175], v[100:103], v[68:71], v[172:175]
    v_mfma_f32_16x16x32_bf16 v[176:179], v[104:107], v[68:71], v[176:179]
    v_mfma_f32_16x16x32_bf16 v[180:183], v[108:111], v[68:71], v[180:183]
    v_mfma_f32_16x16x32_bf16 v[184:187], v[112:115], v[68:71], v[184:187]
    v_mfma_f32_16x16x32_bf16 v[188:191], v[116:119], v[68:71], v[188:191]
    v_mfma_f32_16x16x32_bf16 v[192:195], v[96:99], v[72:75], v[192:195]
    v_mfma_f32_16x16x32_bf16 v[196:199], v[100:103], v[72:75], v[196:199]
    v_mfma_f32_16x16x32_bf16 v[200:203], v[104:107], v[72:75], v[200:203]
    v_mfma_f32_16x16x32_bf16 v[204:207], v[108:111], v[72:75], v[204:207]
    v_mfma_f32_16x16x32_bf16 v[208:211], v[112:115], v[72:75], v[208:211]
    v_mfma_f32_16x16x32_bf16 v[212:215], v[116:119], v[72:75], v[212:215]
    v_mfma_f32_16x16x32_bf16 v[216:219], v[96:99], v[76:79], v[216:219]
    v_mfma_f32_16x16x32_bf16 v[220:223], v[100:103], v[76:79], v[220:223]
    v_mfma_f32_16x16x32_bf16 v[224:227], v[104:107], v[76:79], v[224:227]
    v_mfma_f32_16x16x32_bf16 v[228:231], v[108:111], v[76:79], v[228:231]
    v_mfma_f32_16x16x32_bf16 v[232:235], v[112:115], v[76:79], v[232:235]
    v_mfma_f32_16x16x32_bf16 v[236:239], v[116:119], v[76:79], v[236:239]
    s_waitcnt lgkmcnt(0)
    s_waitcnt vmcnt(3)
    s_barrier
    s_add_u32 m0, s38, 0
    s_nop 0
    buffer_load_dwordx4 v18, s[8:11], s28 offen lds
    s_add_u32 m0, s38, 8192
    s_nop 0
    buffer_load_dwordx4 v18, s[8:11], s29 offen lds
    s_add_u32 m0, s38, 16384
    s_nop 0
    buffer_load_dwordx4 v19, s[52:55], s30 offen lds
    s_cmp_ge_u32 s20, 4
    s_cbranch_scc1 g1_skipg1bu5
    s_add_u32 m0, s38, 24576
    s_nop 0
    buffer_load_dwordx4 v19, s[16:19], s31 offen lds
g1_skipg1bu5:
    s_add_u32 s28, s28, 64
    s_add_u32 s29, s29, 64
    s_add_u32 s30, s30, s36
    s_add_u32 s31, s31, s36
    ds_read_b128 v[64:67], v23 offset:0
    ds_read_b128 v[68:71], v23 offset:1024
    ds_read_b128 v[72:75], v23 offset:2048
    ds_read_b128 v[76:79], v23 offset:3072
    ds_read_b64_tr_b16 v[96:97], v30 offset:2048
    ds_read_b64_tr_b16 v[98:99], v30 offset:2304
    ds_read_b64_tr_b16 v[100:101], v29 offset:4096
    ds_read_b64_tr_b16 v[102:103], v29 offset:4352
    ds_read_b64_tr_b16 v[104:105], v30 offset:4096
    ds_read_b64_tr_b16 v[106:107], v30 offset:4352
    ds_read_b64_tr_b16 v[108:109], v30 offset:8192
    ds_read_b64_tr_b16 v[110:111], v30 offset:8448
    ds_read_b64_tr_b16 v[112:113], v29 offset:10240
    ds_read_b64_tr_b16 v[114:115], v29 offset:10496
    ds_read_b64_tr_b16 v[116:117], v30 offset:10240
    ds_read_b64_tr_b16 v[118:119], v30 offset:10496
    v_mfma_f32_16x16x32_bf16 v[144:147], v[120:123], v[80:83], v[144:147]
    v_mfma_f32_16x16x32_bf16 v[148:151], v[124:127], v[80:83], v[148:151]
    v_mfma_f32_16x16x32_bf16 v[152:155], v[128:131], v[80:83], v[152:155]
    v_mfma_f32_16x16x32_bf16 v[156:159], v[132:135], v[80:83], v[156:159]
    v_mfma_f32_16x16x32_bf16 v[160:163], v[136:139], v[80:83], v[160:163]
    v_mfma_f32_16x16x32_bf16 v[164:167], v[140:143], v[80:83], v[164:167]
    v_mfma_f32_16x16x32_bf16 v[168:171], v[120:123], v[84:87], v[168:171]
    v_mfma_f32_16x16x32_bf16 v[172:175], v[124:127], v[84:87], v[172:175]
    v_mfma_f32_16x16x32_bf16 v[176:179], v[128:131], v[84:87], v[176:179]
    v_mfma_f32_16x16x32_bf16 v[180:183], v[132:135], v[84:87], v[180:183]
    v_mfma_f32_16x16x32_bf16 v[184:187], v[136:139], v[84:87], v[184:187]
    v_mfma_f32_16x16x32_bf16 v[188:191], v[140:143], v[84:87], v[188:191]
    v_mfma_f32_16x16x32_bf16 v[192:195], v[120:123], v[88:91], v[192:195]
    v_mfma_f32_16x16x32_bf16 v[196:199], v[124:127], v[88:91], v[196:199]
    v_mfma_f32_16x16x32_bf16 v[200:203], v[128:131], v[88:91], v[200:203]
    v_mfma_f32_16x16x32_bf16 v[204:207], v[132:135], v[88:91], v[204:207]
    v_mfma_f32_16x16x32_bf16 v[208:211], v[136:139], v[88:91], v[208:211]
    v_mfma_f32_16x16x32_bf16 v[212:215], v[140:143], v[88:91], v[212:215]
    v_mfma_f32_16x16x32_bf16 v[216:219], v[120:123], v[92:95], v[216:219]
    v_mfma_f32_16x16x32_bf16 v[220:223], v[124:127], v[92:95], v[220:223]
    v_mfma_f32_16x16x32_bf16 v[224:227], v[128:131], v[92:95], v[224:227]
    v_mfma_f32_16x16x32_bf16 v[228:231], v[132:135], v[92:95], v[228:231]
    v_mfma_f32_16x16x32_bf16 v[232:235], v[136:139], v[92:95], v[232:235]
    v_mfma_f32_16x16x32_bf16 v[236:239], v[140:143], v[92:95], v[236:239]
    s_waitcnt lgkmcnt(0)
    s_waitcnt vmcnt(3)
    s_barrier
    s_add_u32 m0, s38, 28672
    s_nop 0
    buffer_load_dwordx4 v18, s[8:11], s28 offen lds
    s_add_u32 m0, s38, 36864
    s_nop 0
    buffer_load_dwordx4 v18, s[8:11], s29 offen lds
    s_add_u32 m0, s38, 45056
    s_nop 0
    buffer_load_dwordx4 v19, s[52:55], s30 offen lds
    s_cmp_ge_u32 s20, 4
    s_cbranch_scc1 g1_skipg1bu6
    s_add_u32 m0, s38, 53248
    s_nop 0
    buffer_load_dwordx4 v19, s[16:19], s31 offen lds
g1_skipg1bu6:
    s_add_u32 s28, s28, 64
    s_add_u32 s29, s29, 64
    s_add_u32 s30, s30, s36
    s_add_u32 s31, s31, s36
    ds_read_b128 v[80:83], v23 offset:28672
    ds_read_b128 v[84:87], v23 offset:29696
    ds_read_b128 v[88:91], v23 offset:30720
    ds_read_b128 v[92:95], v23 offset:31744
    ds_read_b64_tr_b16 v[120:121], v30 offset:30720
    ds_read_b64_tr_b16 v[122:123], v30 offset:30976
    ds_read_b64_tr_b16 v[124:125], v29 offset:32768
    ds_read_b64_tr_b16 v[126:127], v29 offset:33024
    ds_read_b64_tr_b16 v[128:129], v30 offset:32768
    ds_read_b64_tr_b16 v[130:131], v30 offset:33024
    ds_read_b64_tr_b16 v[132:133], v30 offset:36864
    ds_read_b64_tr_b16 v[134:135], v30 offset:37120
    ds_read_b64_tr_b16 v[136:137], v29 offset:38912
    ds_read_b64_tr_b16 v[138:139], v29 offset:39168
    ds_read_b64_tr_b16 v[140:141], v30 offset:38912
    ds_read_b64_tr_b16 v[142:143], v30 offset:39168
    v_mfma_f32_16x16x32_bf16 v[144:147], v[96:99], v[64:67], v[144:147]
    v_mfma_f32_16x16x32_bf16 v[148:151], v[100:103], v[64:67], v[148:151]
    v_mfma_f32_16x16x32_bf16 v[152:155], v[104:107], v[64:67], v[152:155]
    v_mfma_f32_16x16x32_bf16 v[156:159], v[108:111], v[64:67], v[156:159]
    v_mfma_f32_16x16x32_bf16 v[160:163], v[112:115], v[64:67], v[160:163]
    v_mfma_f32_16x16x32_bf16 v[164:167], v[116:119], v[64:67], v[164:167]
    v_mfma_f32_16x16x32_bf16 v[168:171], v[96:99], v[68:71], v[168:171]
    v_mfma_f32_16x16x32_bf16 v[172:175], v[100:103], v[68:71], v[172:175]
    v_mfma_f32_16x16x32_bf16 v[176:179], v[104:107], v[68:71], v[176:179]
    v_mfma_f32_16x16x32_bf16 v[180:183], v[108:111], v[68:71], v[180:183]
    v_mfma_f32_16x16x32_bf16 v[184:187], v[112:115], v[68:71], v[184:187]
    v_mfma_f32_16x16x32_bf16 v[188:191], v[116:119], v[68:71], v[188:191]
    v_mfma_f32_16x16x32_bf16 v[192:195], v[96:99], v[72:75], v[192:195]
    v_mfma_f32_16x16x32_bf16 v[196:199], v[100:103], v[72:75], v[196:199]
    v_mfma_f32_16x16x32_bf16 v[200:203], v[104:107], v[72:75], v[200:203]
    v_mfma_f32_16x16x32_bf16 v[204:207], v[108:111], v[72:75], v[204:207]
    v_mfma_f32_16x16x32_bf16 v[208:211], v[112:115], v[72:75], v[208:211]
    v_mfma_f32_16x16x32_bf16 v[212:215], v[116:119], v[72:75], v[212:215]
    v_mfma_f32_16x16x32_bf16 v[216:219], v[96:99], v[76:79], v[216:219]
    v_mfma_f32_16x16x32_bf16 v[220:223], v[100:103], v[76:79], v[220:223]
    v_mfma_f32_16x16x32_bf16 v[224:227], v[104:107], v[76:79], v[224:227]
    v_mfma_f32_16x16x32_bf16 v[228:231], v[108:111], v[76:79], v[228:231]
    v_mfma_f32_16x16x32_bf16 v[232:235], v[112:115], v[76:79], v[232:235]
    v_mfma_f32_16x16x32_bf16 v[236:239], v[116:119], v[76:79], v[236:239]
    s_waitcnt lgkmcnt(0)
    s_waitcnt vmcnt(3)
    s_barrier
    s_add_u32 m0, s38, 57344
    s_nop 0
    buffer_load_dwordx4 v18, s[8:11], s28 offen lds
    s_add_u32 m0, s38, 65536
    s_nop 0
    buffer_load_dwordx4 v18, s[8:11], s29 offen lds
    s_add_u32 m0, s38, 73728
    s_nop 0
    buffer_load_dwordx4 v19, s[52:55], s30 offen lds
    s_cmp_ge_u32 s20, 4
    s_cbranch_scc1 g1_skipg1bu7
    s_add_u32 m0, s38, 81920
    s_nop 0
    buffer_load_dwordx4 v19, s[16:19], s31 offen lds
g1_skipg1bu7:
    s_add_u32 s28, s28, 64
    s_add_u32 s29, s29, 64
    s_add_u32 s30, s30, s36
    s_add_u32 s31, s31, s36
    ds_read_b128 v[64:67], v16 offset:0
    ds_read_b128 v[68:71], v16 offset:1024
    ds_read_b128 v[72:75], v16 offset:2048
    ds_read_b128 v[76:79], v16 offset:3072
    ds_read_b64_tr_b16 v[96:97], v22 offset:2048
    ds_read_b64_tr_b16 v[98:99], v22 offset:2304
    ds_read_b64_tr_b16 v[100:101], v21 offset:4096
    ds_read_b64_tr_b16 v[102:103], v21 offset:4352
    ds_read_b64_tr_b16 v[104:105], v22 offset:4096
    ds_read_b64_tr_b16 v[106:107], v22 offset:4352
    ds_read_b64_tr_b16 v[108:109], v22 offset:8192
    ds_read_b64_tr_b16 v[110:111], v22 offset:8448
    ds_read_b64_tr_b16 v[112:113], v21 offset:10240
    ds_read_b64_tr_b16 v[114:115], v21 offset:10496
    ds_read_b64_tr_b16 v[116:117], v22 offset:10240
    ds_read_b64_tr_b16 v[118:119], v22 offset:10496
    v_mfma_f32_16x16x32_bf16 v[144:147], v[120:123], v[80:83], v[144:147]
    v_mfma_f32_16x16x32_bf16 v[148:151], v[124:127], v[80:83], v[148:151]
    v_mfma_f32_16x16x32_bf16 v[152:155], v[128:131], v[80:83], v[152:155]
    v_mfma_f32_16x16x32_bf16 v[156:159], v[132:135], v[80:83], v[156:159]
    v_mfma_f32_16x16x32_bf16 v[160:163], v[136:139], v[80:83], v[160:163]
    v_mfma_f32_16x16x32_bf16 v[164:167], v[140:143], v[80:83], v[164:167]
    v_mfma_f32_16x16x32_bf16 v[168:171], v[120:123], v[84:87], v[168:171]
    v_mfma_f32_16x16x32_bf16 v[172:175], v[124:127], v[84:87], v[172:175]
    v_mfma_f32_16x16x32_bf16 v[176:179], v[128:131], v[84:87], v[176:179]
    v_mfma_f32_16x16x32_bf16 v[180:183], v[132:135], v[84:87], v[180:183]
    v_mfma_f32_16x16x32_bf16 v[184:187], v[136:139], v[84:87], v[184:187]
    v_mfma_f32_16x16x32_bf16 v[188:191], v[140:143], v[84:87], v[188:191]
    v_mfma_f32_16x16x32_bf16 v[192:195], v[120:123], v[88:91], v[192:195]
    v_mfma_f32_16x16x32_bf16 v[196:199], v[124:127], v[88:91], v[196:199]
    v_mfma_f32_16x16x32_bf16 v[200:203], v[128:131], v[88:91], v[200:203]
    v_mfma_f32_16x16x32_bf16 v[204:207], v[132:135], v[88:91], v[204:207]
    v_mfma_f32_16x16x32_bf16 v[208:211], v[136:139], v[88:91], v[208:211]
    v_mfma_f32_16x16x32_bf16 v[212:215], v[140:143], v[88:91], v[212:215]
    v_mfma_f32_16x16x32_bf16 v[216:219], v[120:123], v[92:95], v[216:219]
    v_mfma_f32_16x16x32_bf16 v[220:223], v[124:127], v[92:95], v[220:223]
    v_mfma_f32_16x16x32_bf16 v[224:227], v[128:131], v[92:95], v[224:227]
    v_mfma_f32_16x16x32_bf16 v[228:231], v[132:135], v[92:95], v[228:231]
    v_mfma_f32_16x16x32_bf16 v[232:235], v[136:139], v[92:95], v[232:235]
    v_mfma_f32_16x16x32_bf16 v[236:239], v[140:143], v[92:95], v[236:239]
    s_waitcnt lgkmcnt(0)
    s_waitcnt vmcnt(3)
    s_barrier
    s_add_u32 m0, s38, 86016
    s_nop 0
    buffer_load_dwordx4 v18, s[8:11], s28 offen lds
    s_add_u32 m0, s38, 94208
    s_nop 0
    buffer_load_dwordx4 v18, s[8:11], s29 offen lds
    s_add_u32 m0, s38, 102400
    s_nop 0
    buffer_load_dwordx4 v19, s[52:55], s30 offen lds
    s_cmp_ge_u32 s20, 4
    s_cbranch_scc1 g1_skipg1bu8
    s_add_u32 m0, s38, 110592
    s_nop 0
    buffer_load_dwordx4 v19, s[16:19], s31 offen lds
g1_skipg1bu8:
    s_add_u32 s28, s28, 64
    s_add_u32 s29, s29, 64
    s_add_u32 s30, s30, s36
    s_add_u32 s31, s31, s36
    ds_read_b128 v[80:83], v16 offset:28672
    ds_read_b128 v[84:87], v16 offset:29696
    ds_read_b128 v[88:91], v16 offset:30720
    ds_read_b128 v[92:95], v16 offset:31744
    ds_read_b64_tr_b16 v[120:121], v22 offset:30720
    ds_read_b64_tr_b16 v[122:123], v22 offset:30976
    ds_read_b64_tr_b16 v[124:125], v21 offset:32768
    ds_read_b64_tr_b16 v[126:127], v21 offset:33024
    ds_read_b64_tr_b16 v[128:129], v22 offset:32768
    ds_read_b64_tr_b16 v[130:131], v22 offset:33024
    ds_read_b64_tr_b16 v[132:133], v22 offset:36864
    ds_read_b64_tr_b16 v[134:135], v22 offset:37120
    ds_read_b64_tr_b16 v[136:137], v21 offset:38912
    ds_read_b64_tr_b16 v[138:139], v21 offset:39168
    ds_read_b64_tr_b16 v[140:141], v22 offset:38912
    ds_read_b64_tr_b16 v[142:143], v22 offset:39168
    v_mfma_f32_16x16x32_bf16 v[144:147], v[96:99], v[64:67], v[144:147]
    v_mfma_f32_16x16x32_bf16 v[148:151], v[100:103], v[64:67], v[148:151]
    v_mfma_f32_16x16x32_bf16 v[152:155], v[104:107], v[64:67], v[152:155]
    v_mfma_f32_16x16x32_bf16 v[156:159], v[108:111], v[64:67], v[156:159]
    v_mfma_f32_16x16x32_bf16 v[160:163], v[112:115], v[64:67], v[160:163]
    v_mfma_f32_16x16x32_bf16 v[164:167], v[116:119], v[64:67], v[164:167]
    v_mfma_f32_16x16x32_bf16 v[168:171], v[96:99], v[68:71], v[168:171]
    v_mfma_f32_16x16x32_bf16 v[172:175], v[100:103], v[68:71], v[172:175]
    v_mfma_f32_16x16x32_bf16 v[176:179], v[104:107], v[68:71], v[176:179]
    v_mfma_f32_16x16x32_bf16 v[180:183], v[108:111], v[68:71], v[180:183]
    v_mfma_f32_16x16x32_bf16 v[184:187], v[112:115], v[68:71], v[184:187]
    v_mfma_f32_16x16x32_bf16 v[188:191], v[116:119], v[68:71], v[188:191]
    v_mfma_f32_16x16x32_bf16 v[192:195], v[96:99], v[72:75], v[192:195]
    v_mfma_f32_16x16x32_bf16 v[196:199], v[100:103], v[72:75], v[196:199]
    v_mfma_f32_16x16x32_bf16 v[200:203], v[104:107], v[72:75], v[200:203]
    v_mfma_f32_16x16x32_bf16 v[204:207], v[108:111], v[72:75], v[204:207]
    v_mfma_f32_16x16x32_bf16 v[208:211], v[112:115], v[72:75], v[208:211]
    v_mfma_f32_16x16x32_bf16 v[212:215], v[116:119], v[72:75], v[212:215]
    v_mfma_f32_16x16x32_bf16 v[216:219], v[96:99], v[76:79], v[216:219]
    v_mfma_f32_16x16x32_bf16 v[220:223], v[100:103], v[76:79], v[220:223]
    v_mfma_f32_16x16x32_bf16 v[224:227], v[104:107], v[76:79], v[224:227]
    v_mfma_f32_16x16x32_bf16 v[228:231], v[108:111], v[76:79], v[228:231]
    v_mfma_f32_16x16x32_bf16 v[232:235], v[112:115], v[76:79], v[232:235]
    v_mfma_f32_16x16x32_bf16 v[236:239], v[116:119], v[76:79], v[236:239]
    s_waitcnt lgkmcnt(0)
    s_waitcnt vmcnt(3)
    s_barrier
    s_add_u32 m0, s38, 0
    s_nop 0
    buffer_load_dwordx4 v18, s[8:11], s28 offen lds
    s_add_u32 m0, s38, 8192
    s_nop 0
    buffer_load_dwordx4 v18, s[8:11], s29 offen lds
    s_add_u32 m0, s38, 16384
    s_nop 0
    buffer_load_dwordx4 v19, s[52:55], s30 offen lds
    s_cmp_ge_u32 s20, 4
    s_cbranch_scc1 g1_skipg1bu9
    s_add_u32 m0, s38, 24576
    s_nop 0
    buffer_load_dwordx4 v19, s[16:19], s31 offen lds
g1_skipg1bu9:
    s_add_u32 s28, s28, 64
    s_add_u32 s29, s29, 64
    s_add_u32 s30, s30, s36
    s_add_u32 s31, s31, s36
    ds_read_b128 v[64:67], v23 offset:0
    ds_read_b128 v[68:71], v23 offset:1024
    ds_read_b128 v[72:75], v23 offset:2048
    ds_read_b128 v[76:79], v23 offset:3072
    ds_read_b64_tr_b16 v[96:97], v30 offset:2048
    ds_read_b64_tr_b16 v[98:99], v30 offset:2304
    ds_read_b64_tr_b16 v[100:101], v29 offset:4096
    ds_read_b64_tr_b16 v[102:103], v29 offset:4352
    ds_read_b64_tr_b16 v[104:105], v30 offset:4096
    ds_read_b64_tr_b16 v[106:107], v30 offset:4352
    ds_read_b64_tr_b16 v[108:109], v30 offset:8192
    ds_read_b64_tr_b16 v[110:111], v30 offset:8448
    ds_read_b64_tr_b16 v[112:113], v29 offset:10240
    ds_read_b64_tr_b16 v[114:115], v29 offset:10496
    ds_read_b64_tr_b16 v[116:117], v30 offset:10240
    ds_read_b64_tr_b16 v[118:119], v30 offset:10496
    v_mfma_f32_16x16x32_bf16 v[144:147], v[120:123], v[80:83], v[144:147]
    v_mfma_f32_16x16x32_bf16 v[148:151], v[124:127], v[80:83], v[148:151]
    v_mfma_f32_16x16x32_bf16 v[152:155], v[128:131], v[80:83], v[152:155]
    v_mfma_f32_16x16x32_bf16 v[156:159], v[132:135], v[80:83], v[156:159]
    v_mfma_f32_16x16x32_bf16 v[160:163], v[136:139], v[80:83], v[160:163]
    v_mfma_f32_16x16x32_bf16 v[164:167], v[140:143], v[80:83], v[164:167]
    v_mfma_f32_16x16x32_bf16 v[168:171], v[120:123], v[84:87], v[168:171]
    v_mfma_f32_16x16x32_bf16 v[172:175], v[124:127], v[84:87], v[172:175]
    v_mfma_f32_16x16x32_bf16 v[176:179], v[128:131], v[84:87], v[176:179]
    v_mfma_f32_16x16x32_bf16 v[180:183], v[132:135], v[84:87], v[180:183]
    v_mfma_f32_16x16x32_bf16 v[184:187], v[136:139], v[84:87], v[184:187]
    v_mfma_f32_16x16x32_bf16 v[188:191], v[140:143], v[84:87], v[188:191]
    v_mfma_f32_16x16x32_bf16 v[192:195], v[120:123], v[88:91], v[192:195]
    v_mfma_f32_16x16x32_bf16 v[196:199], v[124:127], v[88:91], v[196:199]
    v_mfma_f32_16x16x32_bf16 v[200:203], v[128:131], v[88:91], v[200:203]
    v_mfma_f32_16x16x32_bf16 v[204:207], v[132:135], v[88:91], v[204:207]
    v_mfma_f32_16x16x32_bf16 v[208:211], v[136:139], v[88:91], v[208:211]
    v_mfma_f32_16x16x32_bf16 v[212:215], v[140:143], v[88:91], v[212:215]
    v_mfma_f32_16x16x32_bf16 v[216:219], v[120:123], v[92:95], v[216:219]
    v_mfma_f32_16x16x32_bf16 v[220:223], v[124:127], v[92:95], v[220:223]
    v_mfma_f32_16x16x32_bf16 v[224:227], v[128:131], v[92:95], v[224:227]
    v_mfma_f32_16x16x32_bf16 v[228:231], v[132:135], v[92:95], v[228:231]
    v_mfma_f32_16x16x32_bf16 v[232:235], v[136:139], v[92:95], v[232:235]
    v_mfma_f32_16x16x32_bf16 v[236:239], v[140:143], v[92:95], v[236:239]
    s_waitcnt lgkmcnt(0)
    s_waitcnt vmcnt(3)
    s_barrier
    s_add_u32 m0, s38, 28672
    s_nop 0
    buffer_load_dwordx4 v18, s[8:11], s28 offen lds
    s_add_u32 m0, s38, 36864
    s_nop 0
    buffer_load_dwordx4 v18, s[8:11], s29 offen lds
    s_add_u32 m0, s38, 45056
    s_nop 0
    buffer_load_dwordx4 v19, s[52:55], s30 offen lds
    s_cmp_ge_u32 s20, 4
    s_cbranch_scc1 g1_skipg1bu10
    s_add_u32 m0, s38, 53248
    s_nop 0
    buffer_load_dwordx4 v19, s[16:19], s31 offen lds
g1_skipg1bu10:
    s_add_u32 s28, s28, 64
    s_add_u32 s29, s29, 64
    s_add_u32 s30, s30, s36
    s_add_u32 s31, s31, s36
    ds_read_b128 v[80:83], v23 offset:28672
    ds_read_b128 v[84:87], v23 offset:29696
    ds_read_b128 v[88:91], v23 offset:30720
    ds_read_b128 v[92:95], v23 offset:31744
    ds_read_b64_tr_b16 v[120:121], v30 offset:30720
    ds_read_b64_tr_b16 v[122:123], v30 offset:30976
    ds_read_b64_tr_b16 v[124:125], v29 offset:32768
    ds_read_b64_tr_b16 v[126:127], v29 offset:33024
    ds_read_b64_tr_b16 v[128:129], v30 offset:32768
    ds_read_b64_tr_b16 v[130:131], v30 offset:33024
    ds_read_b64_tr_b16 v[132:133], v30 offset:36864
    ds_read_b64_tr_b16 v[134:135], v30 offset:37120
    ds_read_b64_tr_b16 v[136:137], v29 offset:38912
    ds_read_b64_tr_b16 v[138:139], v29 offset:39168
    ds_read_b64_tr_b16 v[140:141], v30 offset:38912
    ds_read_b64_tr_b16 v[142:143], v30 offset:39168
    v_mfma_f32_16x16x32_bf16 v[144:147], v[96:99], v[64:67], v[144:147]
    v_mfma_f32_16x16x32_bf16 v[148:151], v[100:103], v[64:67], v[148:151]
    v_mfma_f32_16x16x32_bf16 v[152:155], v[104:107], v[64:67], v[152:155]
    v_mfma_f32_16x16x32_bf16 v[156:159], v[108:111], v[64:67], v[156:159]
    v_mfma_f32_16x16x32_bf16 v[160:163], v[112:115], v[64:67], v[160:163]
    v_mfma_f32_16x16x32_bf16 v[164:167], v[116:119], v[64:67], v[164:167]
    v_mfma_f32_16x16x32_bf16 v[168:171], v[96:99], v[68:71], v[168:171]
    v_mfma_f32_16x16x32_bf16 v[172:175], v[100:103], v[68:71], v[172:175]
    v_mfma_f32_16x16x32_bf16 v[176:179], v[104:107], v[68:71], v[176:179]
    v_mfma_f32_16x16x32_bf16 v[180:183], v[108:111], v[68:71], v[180:183]
    v_mfma_f32_16x16x32_bf16 v[184:187], v[112:115], v[68:71], v[184:187]
    v_mfma_f32_16x16x32_bf16 v[188:191], v[116:119], v[68:71], v[188:191]
    v_mfma_f32_16x16x32_bf16 v[192:195], v[96:99], v[72:75], v[192:195]
    v_mfma_f32_16x16x32_bf16 v[196:199], v[100:103], v[72:75], v[196:199]
    v_mfma_f32_16x16x32_bf16 v[200:203], v[104:107], v[72:75], v[200:203]
    v_mfma_f32_16x16x32_bf16 v[204:207], v[108:111], v[72:75], v[204:207]
    v_mfma_f32_16x16x32_bf16 v[208:211], v[112:115], v[72:75], v[208:211]
    v_mfma_f32_16x16x32_bf16 v[212:215], v[116:119], v[72:75], v[212:215]
    v_mfma_f32_16x16x32_bf16 v[216:219], v[96:99], v[76:79], v[216:219]
    v_mfma_f32_16x16x32_bf16 v[220:223], v[100:103], v[76:79], v[220:223]
    v_mfma_f32_16x16x32_bf16 v[224:227], v[104:107], v[76:79], v[224:227]
    v_mfma_f32_16x16x32_bf16 v[228:231], v[108:111], v[76:79], v[228:231]
    v_mfma_f32_16x16x32_bf16 v[232:235], v[112:115], v[76:79], v[232:235]
    v_mfma_f32_16x16x32_bf16 v[236:239], v[116:119], v[76:79], v[236:239]
    s_waitcnt lgkmcnt(0)
    s_waitcnt vmcnt(3)
    s_barrier
    s_add_u32 m0, s38, 57344
    s_nop 0
    buffer_load_dwordx4 v18, s[8:11], s28 offen lds
    s_add_u32 m0, s38, 65536
    s_nop 0
    buffer_load_dwordx4 v18, s[8:11], s29 offen lds
    s_add_u32 m0, s38, 73728
    s_nop 0
    buffer_load_dwordx4 v19, s[52:55], s30 offen lds
    s_cmp_ge_u32 s20, 4
    s_cbranch_scc1 g1_skipg1bu11
    s_add_u32 m0, s38, 81920
    s_nop 0
    buffer_load_dwordx4 v19, s[16:19], s31 offen lds
g1_skipg1bu11:
    s_add_u32 s28, s28, 64
    s_add_u32 s29, s29, 64
    s_add_u32 s30, s30, s36
    s_add_u32 s31, s31, s36
    ds_read_b128 v[64:67], v16 offset:0
    ds_read_b128 v[68:71], v16 offset:1024
    ds_read_b128 v[72:75], v16 offset:2048
    ds_read_b128 v[76:79], v16 offset:3072
    ds_read_b64_tr_b16 v[96:97], v22 offset:2048
    ds_read_b64_tr_b16 v[98:99], v22 offset:2304
    ds_read_b64_tr_b16 v[100:101], v21 offset:4096
    ds_read_b64_tr_b16 v[102:103], v21 offset:4352
    ds_read_b64_tr_b16 v[104:105], v22 offset:4096
    ds_read_b64_tr_b16 v[106:107], v22 offset:4352
    ds_read_b64_tr_b16 v[108:109], v22 offset:8192
    ds_read_b64_tr_b16 v[110:111], v22 offset:8448
    ds_read_b64_tr_b16 v[112:113], v21 offset:10240
    ds_read_b64_tr_b16 v[114:115], v21 offset:10496
    ds_read_b64_tr_b16 v[116:117], v22 offset:10240
    ds_read_b64_tr_b16 v[118:119], v22 offset:10496
    v_mfma_f32_16x16x32_bf16 v[144:147], v[120:123], v[80:83], v[144:147]
    v_mfma_f32_16x16x32_bf16 v[148:151], v[124:127], v[80:83], v[148:151]
    v_mfma_f32_16x16x32_bf16 v[152:155], v[128:131], v[80:83], v[152:155]
    v_mfma_f32_16x16x32_bf16 v[156:159], v[132:135], v[80:83], v[156:159]
    v_mfma_f32_16x16x32_bf16 v[160:163], v[136:139], v[80:83], v[160:163]
    v_mfma_f32_16x16x32_bf16 v[164:167], v[140:143], v[80:83], v[164:167]
    v_mfma_f32_16x16x32_bf16 v[168:171], v[120:123], v[84:87], v[168:171]
    v_mfma_f32_16x16x32_bf16 v[172:175], v[124:127], v[84:87], v[172:175]
    v_mfma_f32_16x16x32_bf16 v[176:179], v[128:131], v[84:87], v[176:179]
    v_mfma_f32_16x16x32_bf16 v[180:183], v[132:135], v[84:87], v[180:183]
    v_mfma_f32_16x16x32_bf16 v[184:187], v[136:139], v[84:87], v[184:187]
    v_mfma_f32_16x16x32_bf16 v[188:191], v[140:143], v[84:87], v[188:191]
    v_mfma_f32_16x16x32_bf16 v[192:195], v[120:123], v[88:91], v[192:195]
    v_mfma_f32_16x16x32_bf16 v[196:199], v[124:127], v[88:91], v[196:199]
    v_mfma_f32_16x16x32_bf16 v[200:203], v[128:131], v[88:91], v[200:203]
    v_mfma_f32_16x16x32_bf16 v[204:207], v[132:135], v[88:91], v[204:207]
    v_mfma_f32_16x16x32_bf16 v[208:211], v[136:139], v[88:91], v[208:211]
    v_mfma_f32_16x16x32_bf16 v[212:215], v[140:143], v[88:91], v[212:215]
    v_mfma_f32_16x16x32_bf16 v[216:219], v[120:123], v[92:95], v[216:219]
    v_mfma_f32_16x16x32_bf16 v[220:223], v[124:127], v[92:95], v[220:223]
    v_mfma_f32_16x16x32_bf16 v[224:227], v[128:131], v[92:95], v[224:227]
    v_mfma_f32_16x16x32_bf16 v[228:231], v[132:135], v[92:95], v[228:231]
    v_mfma_f32_16x16x32_bf16 v[232:235], v[136:139], v[92:95], v[232:235]
    v_mfma_f32_16x16x32_bf16 v[236:239], v[140:143], v[92:95], v[236:239]
    s_waitcnt lgkmcnt(0)
    s_waitcnt vmcnt(3)
    s_barrier
    s_add_u32 m0, s38, 86016
    s_nop 0
    buffer_load_dwordx4 v18, s[8:11], s28 offen lds
    s_add_u32 m0, s38, 94208
    s_nop 0
    buffer_load_dwordx4 v18, s[8:11], s29 offen lds
    s_add_u32 m0, s38, 102400
    s_nop 0
    buffer_load_dwordx4 v19, s[52:55], s30 offen lds
    s_cmp_ge_u32 s20, 4
    s_cbranch_scc1 g1_skipg1bu12
    s_add_u32 m0, s38, 110592
    s_nop 0
    buffer_load_dwordx4 v19, s[16:19], s31 offen lds
g1_skipg1bu12:
    s_add_u32 s28, s28, 64
    s_add_u32 s29, s29, 64
    s_add_u32 s30, s30, s36
    s_add_u32 s31, s31, s36
    ds_read_b128 v[80:83], v16 offset:28672
    ds_read_b128 v[84:87], v16 offset:29696
    ds_read_b128 v[88:91], v16 offset:30720
    ds_read_b128 v[92:95], v16 offset:31744
    ds_read_b64_tr_b16 v[120:121], v22 offset:30720
    ds_read_b64_tr_b16 v[122:123], v22 offset:30976
    ds_read_b64_tr_b16 v[124:125], v21 offset:32768
    ds_read_b64_tr_b16 v[126:127], v21 offset:33024
    ds_read_b64_tr_b16 v[128:129], v22 offset:32768
    ds_read_b64_tr_b16 v[130:131], v22 offset:33024
    ds_read_b64_tr_b16 v[132:133], v22 offset:36864
    ds_read_b64_tr_b16 v[134:135], v22 offset:37120
    ds_read_b64_tr_b16 v[136:137], v21 offset:38912
    ds_read_b64_tr_b16 v[138:139], v21 offset:39168
    ds_read_b64_tr_b16 v[140:141], v22 offset:38912
    ds_read_b64_tr_b16 v[142:143], v22 offset:39168
    v_mfma_f32_16x16x32_bf16 v[144:147], v[96:99], v[64:67], v[144:147]
    v_mfma_f32_16x16x32_bf16 v[148:151], v[100:103], v[64:67], v[148:151]
    v_mfma_f32_16x16x32_bf16 v[152:155], v[104:107], v[64:67], v[152:155]
    v_mfma_f32_16x16x32_bf16 v[156:159], v[108:111], v[64:67], v[156:159]
    v_mfma_f32_16x16x32_bf16 v[160:163], v[112:115], v[64:67], v[160:163]
    v_mfma_f32_16x16x32_bf16 v[164:167], v[116:119], v[64:67], v[164:167]
    v_mfma_f32_16x16x32_bf16 v[168:171], v[96:99], v[68:71], v[168:171]
    v_mfma_f32_16x16x32_bf16 v[172:175], v[100:103], v[68:71], v[172:175]
    v_mfma_f32_16x16x32_bf16 v[176:179], v[104:107], v[68:71], v[176:179]
    v_mfma_f32_16x16x32_bf16 v[180:183], v[108:111], v[68:71], v[180:183]
    v_mfma_f32_16x16x32_bf16 v[184:187], v[112:115], v[68:71], v[184:187]
    v_mfma_f32_16x16x32_bf16 v[188:191], v[116:119], v[68:71], v[188:191]
    v_mfma_f32_16x16x32_bf16 v[192:195], v[96:99], v[72:75], v[192:195]
    v_mfma_f32_16x16x32_bf16 v[196:199], v[100:103], v[72:75], v[196:199]
    v_mfma_f32_16x16x32_bf16 v[200:203], v[104:107], v[72:75], v[200:203]
    v_mfma_f32_16x16x32_bf16 v[204:207], v[108:111], v[72:75], v[204:207]
    v_mfma_f32_16x16x32_bf16 v[208:211], v[112:115], v[72:75], v[208:211]
    v_mfma_f32_16x16x32_bf16 v[212:215], v[116:119], v[72:75], v[212:215]
    v_mfma_f32_16x16x32_bf16 v[216:219], v[96:99], v[76:79], v[216:219]
    v_mfma_f32_16x16x32_bf16 v[220:223], v[100:103], v[76:79], v[220:223]
    v_mfma_f32_16x16x32_bf16 v[224:227], v[104:107], v[76:79], v[224:227]
    v_mfma_f32_16x16x32_bf16 v[228:231], v[108:111], v[76:79], v[228:231]
    v_mfma_f32_16x16x32_bf16 v[232:235], v[112:115], v[76:79], v[232:235]
    v_mfma_f32_16x16x32_bf16 v[236:239], v[116:119], v[76:79], v[236:239]
    s_waitcnt lgkmcnt(0)
    s_waitcnt vmcnt(3)
    s_barrier
    s_add_u32 m0, s38, 0
    s_nop 0
    buffer_load_dwordx4 v18, s[8:11], s28 offen lds
    s_add_u32 m0, s38, 8192
    s_nop 0
    buffer_load_dwordx4 v18, s[8:11], s29 offen lds
    s_add_u32 m0, s38, 16384
    s_nop 0
    buffer_load_dwordx4 v19, s[52:55], s30 offen lds
    s_cmp_ge_u32 s20, 4
    s_cbranch_scc1 g1_skipg1bu13
    s_add_u32 m0, s38, 24576
    s_nop 0
    buffer_load_dwordx4 v19, s[16:19], s31 offen lds
g1_skipg1bu13:
    s_add_u32 s28, s28, 64
    s_add_u32 s29, s29, 64
    s_add_u32 s30, s30, s36
    s_add_u32 s31, s31, s36
    ds_read_b128 v[64:67], v23 offset:0
    ds_read_b128 v[68:71], v23 offset:1024
    ds_read_b128 v[72:75], v23 offset:2048
    ds_read_b128 v[76:79], v23 offset:3072
    ds_read_b64_tr_b16 v[96:97], v30 offset:2048
    ds_read_b64_tr_b16 v[98:99], v30 offset:2304
    ds_read_b64_tr_b16 v[100:101], v29 offset:4096
    ds_read_b64_tr_b16 v[102:103], v29 offset:4352
    ds_read_b64_tr_b16 v[104:105], v30 offset:4096
    ds_read_b64_tr_b16 v[106:107], v30 offset:4352
    ds_read_b64_tr_b16 v[108:109], v30 offset:8192
    ds_read_b64_tr_b16 v[110:111], v30 offset:8448
    ds_read_b64_tr_b16 v[112:113], v29 offset:10240
    ds_read_b64_tr_b16 v[114:115], v29 offset:10496
    ds_read_b64_tr_b16 v[116:117], v30 offset:10240
    ds_read_b64_tr_b16 v[118:119], v30 offset:10496
    v_mfma_f32_16x16x32_bf16 v[144:147], v[120:123], v[80:83], v[144:147]
    v_mfma_f32_16x16x32_bf16 v[148:151], v[124:127], v[80:83], v[148:151]
    v_mfma_f32_16x16x32_bf16 v[152:155], v[128:131], v[80:83], v[152:155]
    v_mfma_f32_16x16x32_bf16 v[156:159], v[132:135], v[80:83], v[156:159]
    v_mfma_f32_16x16x32_bf16 v[160:163], v[136:139], v[80:83], v[160:163]
    v_mfma_f32_16x16x32_bf16 v[164:167], v[140:143], v[80:83], v[164:167]
    v_mfma_f32_16x16x32_bf16 v[168:171], v[120:123], v[84:87], v[168:171]
    v_mfma_f32_16x16x32_bf16 v[172:175], v[124:127], v[84:87], v[172:175]
    v_mfma_f32_16x16x32_bf16 v[176:179], v[128:131], v[84:87], v[176:179]
    v_mfma_f32_16x16x32_bf16 v[180:183], v[132:135], v[84:87], v[180:183]
    v_mfma_f32_16x16x32_bf16 v[184:187], v[136:139], v[84:87], v[184:187]
    v_mfma_f32_16x16x32_bf16 v[188:191], v[140:143], v[84:87], v[188:191]
    v_mfma_f32_16x16x32_bf16 v[192:195], v[120:123], v[88:91], v[192:195]
    v_mfma_f32_16x16x32_bf16 v[196:199], v[124:127], v[88:91], v[196:199]
    v_mfma_f32_16x16x32_bf16 v[200:203], v[128:131], v[88:91], v[200:203]
    v_mfma_f32_16x16x32_bf16 v[204:207], v[132:135], v[88:91], v[204:207]
    v_mfma_f32_16x16x32_bf16 v[208:211], v[136:139], v[88:91], v[208:211]
    v_mfma_f32_16x16x32_bf16 v[212:215], v[140:143], v[88:91], v[212:215]
    v_mfma_f32_16x16x32_bf16 v[216:219], v[120:123], v[92:95], v[216:219]
    v_mfma_f32_16x16x32_bf16 v[220:223], v[124:127], v[92:95], v[220:223]
    v_mfma_f32_16x16x32_bf16 v[224:227], v[128:131], v[92:95], v[224:227]
    v_mfma_f32_16x16x32_bf16 v[228:231], v[132:135], v[92:95], v[228:231]
    v_mfma_f32_16x16x32_bf16 v[232:235], v[136:139], v[92:95], v[232:235]
    v_mfma_f32_16x16x32_bf16 v[236:239], v[140:143], v[92:95], v[236:239]
    s_waitcnt lgkmcnt(0)
    s_waitcnt vmcnt(3)
    s_barrier
    s_add_u32 m0, s38, 28672
    s_nop 0
    buffer_load_dwordx4 v18, s[8:11], s28 offen lds
    s_add_u32 m0, s38, 36864
    s_nop 0
    buffer_load_dwordx4 v18, s[8:11], s29 offen lds
    s_add_u32 m0, s38, 45056
    s_nop 0
    buffer_load_dwordx4 v19, s[52:55], s30 offen lds
    s_cmp_ge_u32 s20, 4
    s_cbranch_scc1 g1_skipg1bu14
    s_add_u32 m0, s38, 53248
    s_nop 0
    buffer_load_dwordx4 v19, s[16:19], s31 offen lds
g1_skipg1bu14:
    s_add_u32 s28, s28, 64
    s_add_u32 s29, s29, 64
    s_add_u32 s30, s30, s36
    s_add_u32 s31, s31, s36
    ds_read_b128 v[80:83], v23 offset:28672
    ds_read_b128 v[84:87], v23 offset:29696
    ds_read_b128 v[88:91], v23 offset:30720
    ds_read_b128 v[92:95], v23 offset:31744
    ds_read_b64_tr_b16 v[120:121], v30 offset:30720
    ds_read_b64_tr_b16 v[122:123], v30 offset:30976
    ds_read_b64_tr_b16 v[124:125], v29 offset:32768
    ds_read_b64_tr_b16 v[126:127], v29 offset:33024
    ds_read_b64_tr_b16 v[128:129], v30 offset:32768
    ds_read_b64_tr_b16 v[130:131], v30 offset:33024
    ds_read_b64_tr_b16 v[132:133], v30 offset:36864
    ds_read_b64_tr_b16 v[134:135], v30 offset:37120
    ds_read_b64_tr_b16 v[136:137], v29 offset:38912
    ds_read_b64_tr_b16 v[138:139], v29 offset:39168
    ds_read_b64_tr_b16 v[140:141], v30 offset:38912
    ds_read_b64_tr_b16 v[142:143], v30 offset:39168
    v_mfma_f32_16x16x32_bf16 v[144:147], v[96:99], v[64:67], v[144:147]
    v_mfma_f32_16x16x32_bf16 v[148:151], v[100:103], v[64:67], v[148:151]
    v_mfma_f32_16x16x32_bf16 v[152:155], v[104:107], v[64:67], v[152:155]
    v_mfma_f32_16x16x32_bf16 v[156:159], v[108:111], v[64:67], v[156:159]
    v_mfma_f32_16x16x32_bf16 v[160:163], v[112:115], v[64:67], v[160:163]
    v_mfma_f32_16x16x32_bf16 v[164:167], v[116:119], v[64:67], v[164:167]
    v_mfma_f32_16x16x32_bf16 v[168:171], v[96:99], v[68:71], v[168:171]
    v_mfma_f32_16x16x32_bf16 v[172:175], v[100:103], v[68:71], v[172:175]
    v_mfma_f32_16x16x32_bf16 v[176:179], v[104:107], v[68:71], v[176:179]
    v_mfma_f32_16x16x32_bf16 v[180:183], v[108:111], v[68:71], v[180:183]
    v_mfma_f32_16x16x32_bf16 v[184:187], v[112:115], v[68:71], v[184:187]
    v_mfma_f32_16x16x32_bf16 v[188:191], v[116:119], v[68:71], v[188:191]
    v_mfma_f32_16x16x32_bf16 v[192:195], v[96:99], v[72:75], v[192:195]
    v_mfma_f32_16x16x32_bf16 v[196:199], v[100:103], v[72:75], v[196:199]
    v_mfma_f32_16x16x32_bf16 v[200:203], v[104:107], v[72:75], v[200:203]
    v_mfma_f32_16x16x32_bf16 v[204:207], v[108:111], v[72:75], v[204:207]
    v_mfma_f32_16x16x32_bf16 v[208:211], v[112:115], v[72:75], v[208:211]
    v_mfma_f32_16x16x32_bf16 v[212:215], v[116:119], v[72:75], v[212:215]
    v_mfma_f32_16x16x32_bf16 v[216:219], v[96:99], v[76:79], v[216:219]
    v_mfma_f32_16x16x32_bf16 v[220:223], v[100:103], v[76:79], v[220:223]
    v_mfma_f32_16x16x32_bf16 v[224:227], v[104:107], v[76:79], v[224:227]
    v_mfma_f32_16x16x32_bf16 v[228:231], v[108:111], v[76:79], v[228:231]
    v_mfma_f32_16x16x32_bf16 v[232:235], v[112:115], v[76:79], v[232:235]
    v_mfma_f32_16x16x32_bf16 v[236:239], v[116:119], v[76:79], v[236:239]
    s_waitcnt lgkmcnt(0)
    s_waitcnt vmcnt(3)
    s_barrier
    s_add_u32 m0, s38, 57344
    s_nop 0
    buffer_load_dwordx4 v18, s[8:11], s28 offen lds
    s_add_u32 m0, s38, 65536
    s_nop 0
    buffer_load_dwordx4 v18, s[8:11], s29 offen lds
    s_add_u32 m0, s38, 73728
    s_nop 0
    buffer_load_dwordx4 v19, s[52:55], s30 offen lds
    s_cmp_ge_u32 s20, 4
    s_cbranch_scc1 g1_skipg1bu15
    s_add_u32 m0, s38, 81920
    s_nop 0
    buffer_load_dwordx4 v19, s[16:19], s31 offen lds
g1_skipg1bu15:
    s_add_u32 s28, s28, 64
    s_add_u32 s29, s29, 64
    s_add_u32 s30, s30, s36
    s_add_u32 s31, s31, s36
    ds_read_b128 v[64:67], v16 offset:0
    ds_read_b128 v[68:71], v16 offset:1024
    ds_read_b128 v[72:75], v16 offset:2048
    ds_read_b128 v[76:79], v16 offset:3072
    ds_read_b64_tr_b16 v[96:97], v22 offset:2048
    ds_read_b64_tr_b16 v[98:99], v22 offset:2304
    ds_read_b64_tr_b16 v[100:101], v21 offset:4096
    ds_read_b64_tr_b16 v[102:103], v21 offset:4352
    ds_read_b64_tr_b16 v[104:105], v22 offset:4096
    ds_read_b64_tr_b16 v[106:107], v22 offset:4352
    ds_read_b64_tr_b16 v[108:109], v22 offset:8192
    ds_read_b64_tr_b16 v[110:111], v22 offset:8448
    ds_read_b64_tr_b16 v[112:113], v21 offset:10240
    ds_read_b64_tr_b16 v[114:115], v21 offset:10496
    ds_read_b64_tr_b16 v[116:117], v22 offset:10240
    ds_read_b64_tr_b16 v[118:119], v22 offset:10496
    v_mfma_f32_16x16x32_bf16 v[144:147], v[120:123], v[80:83], v[144:147]
    v_mfma_f32_16x16x32_bf16 v[148:151], v[124:127], v[80:83], v[148:151]
    v_mfma_f32_16x16x32_bf16 v[152:155], v[128:131], v[80:83], v[152:155]
    v_mfma_f32_16x16x32_bf16 v[156:159], v[132:135], v[80:83], v[156:159]
    v_mfma_f32_16x16x32_bf16 v[160:163], v[136:139], v[80:83], v[160:163]
    v_mfma_f32_16x16x32_bf16 v[164:167], v[140:143], v[80:83], v[164:167]
    v_mfma_f32_16x16x32_bf16 v[168:171], v[120:123], v[84:87], v[168:171]
    v_mfma_f32_16x16x32_bf16 v[172:175], v[124:127], v[84:87], v[172:175]
    v_mfma_f32_16x16x32_bf16 v[176:179], v[128:131], v[84:87], v[176:179]
    v_mfma_f32_16x16x32_bf16 v[180:183], v[132:135], v[84:87], v[180:183]
    v_mfma_f32_16x16x32_bf16 v[184:187], v[136:139], v[84:87], v[184:187]
    v_mfma_f32_16x16x32_bf16 v[188:191], v[140:143], v[84:87], v[188:191]
    v_mfma_f32_16x16x32_bf16 v[192:195], v[120:123], v[88:91], v[192:195]
    v_mfma_f32_16x16x32_bf16 v[196:199], v[124:127], v[88:91], v[196:199]
    v_mfma_f32_16x16x32_bf16 v[200:203], v[128:131], v[88:91], v[200:203]
    v_mfma_f32_16x16x32_bf16 v[204:207], v[132:135], v[88:91], v[204:207]
    v_mfma_f32_16x16x32_bf16 v[208:211], v[136:139], v[88:91], v[208:211]
    v_mfma_f32_16x16x32_bf16 v[212:215], v[140:143], v[88:91], v[212:215]
    v_mfma_f32_16x16x32_bf16 v[216:219], v[120:123], v[92:95], v[216:219]
    v_mfma_f32_16x16x32_bf16 v[220:223], v[124:127], v[92:95], v[220:223]
    v_mfma_f32_16x16x32_bf16 v[224:227], v[128:131], v[92:95], v[224:227]
    v_mfma_f32_16x16x32_bf16 v[228:231], v[132:135], v[92:95], v[228:231]
    v_mfma_f32_16x16x32_bf16 v[232:235], v[136:139], v[92:95], v[232:235]
    v_mfma_f32_16x16x32_bf16 v[236:239], v[140:143], v[92:95], v[236:239]
    s_waitcnt lgkmcnt(0)
    s_waitcnt vmcnt(3)
    s_barrier
    s_add_u32 m0, s38, 86016
    s_nop 0
    buffer_load_dwordx4 v18, s[8:11], s28 offen lds
    s_add_u32 m0, s38, 94208
    s_nop 0
    buffer_load_dwordx4 v18, s[8:11], s29 offen lds
    s_add_u32 m0, s38, 102400
    s_nop 0
    buffer_load_dwordx4 v19, s[52:55], s30 offen lds
    s_cmp_ge_u32 s20, 4
    s_cbranch_scc1 g1_skipg1bu16
    s_add_u32 m0, s38, 110592
    s_nop 0
    buffer_load_dwordx4 v19, s[16:19], s31 offen lds
g1_skipg1bu16:
    s_add_u32 s28, s28, 64
    s_add_u32 s29, s29, 64
    s_add_u32 s30, s30, s36
    s_add_u32 s31, s31, s36
    ds_read_b128 v[80:83], v16 offset:28672
    ds_read_b128 v[84:87], v16 offset:29696
    ds_read_b128 v[88:91], v16 offset:30720
    ds_read_b128 v[92:95], v16 offset:31744
    ds_read_b64_tr_b16 v[120:121], v22 offset:30720
    ds_read_b64_tr_b16 v[122:123], v22 offset:30976
    ds_read_b64_tr_b16 v[124:125], v21 offset:32768
    ds_read_b64_tr_b16 v[126:127], v21 offset:33024
    ds_read_b64_tr_b16 v[128:129], v22 offset:32768
    ds_read_b64_tr_b16 v[130:131], v22 offset:33024
    ds_read_b64_tr_b16 v[132:133], v22 offset:36864
    ds_read_b64_tr_b16 v[134:135], v22 offset:37120
    ds_read_b64_tr_b16 v[136:137], v21 offset:38912
    ds_read_b64_tr_b16 v[138:139], v21 offset:39168
    ds_read_b64_tr_b16 v[140:141], v22 offset:38912
    ds_read_b64_tr_b16 v[142:143], v22 offset:39168
    v_mfma_f32_16x16x32_bf16 v[144:147], v[96:99], v[64:67], v[144:147]
    v_mfma_f32_16x16x32_bf16 v[148:151], v[100:103], v[64:67], v[148:151]
    v_mfma_f32_16x16x32_bf16 v[152:155], v[104:107], v[64:67], v[152:155]
    v_mfma_f32_16x16x32_bf16 v[156:159], v[108:111], v[64:67], v[156:159]
    v_mfma_f32_16x16x32_bf16 v[160:163], v[112:115], v[64:67], v[160:163]
    v_mfma_f32_16x16x32_bf16 v[164:167], v[116:119], v[64:67], v[164:167]
    v_mfma_f32_16x16x32_bf16 v[168:171], v[96:99], v[68:71], v[168:171]
    v_mfma_f32_16x16x32_bf16 v[172:175], v[100:103], v[68:71], v[172:175]
    v_mfma_f32_16x16x32_bf16 v[176:179], v[104:107], v[68:71], v[176:179]
    v_mfma_f32_16x16x32_bf16 v[180:183], v[108:111], v[68:71], v[180:183]
    v_mfma_f32_16x16x32_bf16 v[184:187], v[112:115], v[68:71], v[184:187]
    v_mfma_f32_16x16x32_bf16 v[188:191], v[116:119], v[68:71], v[188:191]
    v_mfma_f32_16x16x32_bf16 v[192:195], v[96:99], v[72:75], v[192:195]
    v_mfma_f32_16x16x32_bf16 v[196:199], v[100:103], v[72:75], v[196:199]
    v_mfma_f32_16x16x32_bf16 v[200:203], v[104:107], v[72:75], v[200:203]
    v_mfma_f32_16x16x32_bf16 v[204:207], v[108:111], v[72:75], v[204:207]
    v_mfma_f32_16x16x32_bf16 v[208:211], v[112:115], v[72:75], v[208:211]
    v_mfma_f32_16x16x32_bf16 v[212:215], v[116:119], v[72:75], v[212:215]
    v_mfma_f32_16x16x32_bf16 v[216:219], v[96:99], v[76:79], v[216:219]
    v_mfma_f32_16x16x32_bf16 v[220:223], v[100:103], v[76:79], v[220:223]
    v_mfma_f32_16x16x32_bf16 v[224:227], v[104:107], v[76:79], v[224:227]
    v_mfma_f32_16x16x32_bf16 v[228:231], v[108:111], v[76:79], v[228:231]
    v_mfma_f32_16x16x32_bf16 v[232:235], v[112:115], v[76:79], v[232:235]
    v_mfma_f32_16x16x32_bf16 v[236:239], v[116:119], v[76:79], v[236:239]
    s_waitcnt lgkmcnt(0)
    s_waitcnt vmcnt(3)
    s_barrier
    ds_read_b128 v[64:67], v23 offset:0
    ds_read_b128 v[68:71], v23 offset:1024
    ds_read_b128 v[72:75], v23 offset:2048
    ds_read_b128 v[76:79], v23 offset:3072
    ds_read_b64_tr_b16 v[96:97], v30 offset:2048
    ds_read_b64_tr_b16 v[98:99], v30 offset:2304
    ds_read_b64_tr_b16 v[100:101], v29 offset:4096
    ds_read_b64_tr_b16 v[102:103], v29 offset:4352
    ds_read_b64_tr_b16 v[104:105], v30 offset:4096
    ds_read_b64_tr_b16 v[106:107], v30 offset:4352
    ds_read_b64_tr_b16 v[108:109], v30 offset:8192
    ds_read_b64_tr_b16 v[110:111], v30 offset:8448
    ds_read_b64_tr_b16 v[112:113], v29 offset:10240
    ds_read_b64_tr_b16 v[114:115], v29 offset:10496
    ds_read_b64_tr_b16 v[116:117], v30 offset:10240
    ds_read_b64_tr_b16 v[118:119], v30 offset:10496
    v_mfma_f32_16x16x32_bf16 v[144:147], v[120:123], v[80:83], v[144:147]
    v_mfma_f32_16x16x32_bf16 v[148:151], v[124:127], v[80:83], v[148:151]
    v_mfma_f32_16x16x32_bf16 v[152:155], v[128:131], v[80:83], v[152:155]
    v_mfma_f32_16x16x32_bf16 v[156:159], v[132:135], v[80:83], v[156:159]
    v_mfma_f32_16x16x32_bf16 v[160:163], v[136:139], v[80:83], v[160:163]
    v_mfma_f32_16x16x32_bf16 v[164:167], v[140:143], v[80:83], v[164:167]
    v_mfma_f32_16x16x32_bf16 v[168:171], v[120:123], v[84:87], v[168:171]
    v_mfma_f32_16x16x32_bf16 v[172:175], v[124:127], v[84:87], v[172:175]
    v_mfma_f32_16x16x32_bf16 v[176:179], v[128:131], v[84:87], v[176:179]
    v_mfma_f32_16x16x32_bf16 v[180:183], v[132:135], v[84:87], v[180:183]
    v_mfma_f32_16x16x32_bf16 v[184:187], v[136:139], v[84:87], v[184:187]
    v_mfma_f32_16x16x32_bf16 v[188:191], v[140:143], v[84:87], v[188:191]
    v_mfma_f32_16x16x32_bf16 v[192:195], v[120:123], v[88:91], v[192:195]
    v_mfma_f32_16x16x32_bf16 v[196:199], v[124:127], v[88:91], v[196:199]
    v_mfma_f32_16x16x32_bf16 v[200:203], v[128:131], v[88:91], v[200:203]
    v_mfma_f32_16x16x32_bf16 v[204:207], v[132:135], v[88:91], v[204:207]
    v_mfma_f32_16x16x32_bf16 v[208:211], v[136:139], v[88:91], v[208:211]
    v_mfma_f32_16x16x32_bf16 v[212:215], v[140:143], v[88:91], v[212:215]
    v_mfma_f32_16x16x32_bf16 v[216:219], v[120:123], v[92:95], v[216:219]
    v_mfma_f32_16x16x32_bf16 v[220:223], v[124:127], v[92:95], v[220:223]
    v_mfma_f32_16x16x32_bf16 v[224:227], v[128:131], v[92:95], v[224:227]
    v_mfma_f32_16x16x32_bf16 v[228:231], v[132:135], v[92:95], v[228:231]
    v_mfma_f32_16x16x32_bf16 v[232:235], v[136:139], v[92:95], v[232:235]
    v_mfma_f32_16x16x32_bf16 v[236:239], v[140:143], v[92:95], v[236:239]
    s_waitcnt lgkmcnt(0)
    s_waitcnt vmcnt(0)
    s_barrier
    ds_read_b128 v[80:83], v23 offset:28672
    ds_read_b128 v[84:87], v23 offset:29696
    ds_read_b128 v[88:91], v23 offset:30720
    ds_read_b128 v[92:95], v23 offset:31744
    ds_read_b64_tr_b16 v[120:121], v30 offset:30720
    ds_read_b64_tr_b16 v[122:123], v30 offset:30976
    ds_read_b64_tr_b16 v[124:125], v29 offset:32768
    ds_read_b64_tr_b16 v[126:127], v29 offset:33024
    ds_read_b64_tr_b16 v[128:129], v30 offset:32768
    ds_read_b64_tr_b16 v[130:131], v30 offset:33024
    ds_read_b64_tr_b16 v[132:133], v30 offset:36864
    ds_read_b64_tr_b16 v[134:135], v30 offset:37120
    ds_read_b64_tr_b16 v[136:137], v29 offset:38912
    ds_read_b64_tr_b16 v[138:139], v29 offset:39168
    ds_read_b64_tr_b16 v[140:141], v30 offset:38912
    ds_read_b64_tr_b16 v[142:143], v30 offset:39168
    v_mfma_f32_16x16x32_bf16 v[144:147], v[96:99], v[64:67], v[144:147]
    v_mfma_f32_16x16x32_bf16 v[148:151], v[100:103], v[64:67], v[148:151]
    v_mfma_f32_16x16x32_bf16 v[152:155], v[104:107], v[64:67], v[152:155]
    v_mfma_f32_16x16x32_bf16 v[156:159], v[108:111], v[64:67], v[156:159]
    v_mfma_f32_16x16x32_bf16 v[160:163], v[112:115], v[64:67], v[160:163]
    v_mfma_f32_16x16x32_bf16 v[164:167], v[116:119], v[64:67], v[164:167]
    v_mfma_f32_16x16x32_bf16 v[168:171], v[96:99], v[68:71], v[168:171]
    v_mfma_f32_16x16x32_bf16 v[172:175], v[100:103], v[68:71], v[172:175]
    v_mfma_f32_16x16x32_bf16 v[176:179], v[104:107], v[68:71], v[176:179]
    v_mfma_f32_16x16x32_bf16 v[180:183], v[108:111], v[68:71], v[180:183]
    v_mfma_f32_16x16x32_bf16 v[184:187], v[112:115], v[68:71], v[184:187]
    v_mfma_f32_16x16x32_bf16 v[188:191], v[116:119], v[68:71], v[188:191]
    v_mfma_f32_16x16x32_bf16 v[192:195], v[96:99], v[72:75], v[192:195]
    v_mfma_f32_16x16x32_bf16 v[196:199], v[100:103], v[72:75], v[196:199]
    v_mfma_f32_16x16x32_bf16 v[200:203], v[104:107], v[72:75], v[200:203]
    v_mfma_f32_16x16x32_bf16 v[204:207], v[108:111], v[72:75], v[204:207]
    v_mfma_f32_16x16x32_bf16 v[208:211], v[112:115], v[72:75], v[208:211]
    v_mfma_f32_16x16x32_bf16 v[212:215], v[116:119], v[72:75], v[212:215]
    v_mfma_f32_16x16x32_bf16 v[216:219], v[96:99], v[76:79], v[216:219]
    v_mfma_f32_16x16x32_bf16 v[220:223], v[100:103], v[76:79], v[220:223]
    v_mfma_f32_16x16x32_bf16 v[224:227], v[104:107], v[76:79], v[224:227]
    v_mfma_f32_16x16x32_bf16 v[228:231], v[108:111], v[76:79], v[228:231]
    v_mfma_f32_16x16x32_bf16 v[232:235], v[112:115], v[76:79], v[232:235]
    v_mfma_f32_16x16x32_bf16 v[236:239], v[116:119], v[76:79], v[236:239]
    s_waitcnt lgkmcnt(0)
    v_mfma_f32_16x16x32_bf16 v[144:147], v[120:123], v[80:83], v[144:147]
    v_mfma_f32_16x16x32_bf16 v[148:151], v[124:127], v[80:83], v[148:151]
    v_mfma_f32_16x16x32_bf16 v[152:155], v[128:131], v[80:83], v[152:155]
    v_mfma_f32_16x16x32_bf16 v[156:159], v[132:135], v[80:83], v[156:159]
    v_mfma_f32_16x16x32_bf16 v[160:163], v[136:139], v[80:83], v[160:163]
    v_mfma_f32_16x16x32_bf16 v[164:167], v[140:143], v[80:83], v[164:167]
    v_mfma_f32_16x16x32_bf16 v[168:171], v[120:123], v[84:87], v[168:171]
    v_mfma_f32_16x16x32_bf16 v[172:175], v[124:127], v[84:87], v[172:175]
    v_mfma_f32_16x16x32_bf16 v[176:179], v[128:131], v[84:87], v[176:179]
    v_mfma_f32_16x16x32_bf16 v[180:183], v[132:135], v[84:87], v[180:183]
    v_mfma_f32_16x16x32_bf16 v[184:187], v[136:139], v[84:87], v[184:187]
    v_mfma_f32_16x16x32_bf16 v[188:191], v[140:143], v[84:87], v[188:191]
    v_mfma_f32_16x16x32_bf16 v[192:195], v[120:123], v[88:91], v[192:195]
    v_mfma_f32_16x16x32_bf16 v[196:199], v[124:127], v[88:91], v[196:199]
    v_mfma_f32_16x16x32_bf16 v[200:203], v[128:131], v[88:91], v[200:203]
    v_mfma_f32_16x16x32_bf16 v[204:207], v[132:135], v[88:91], v[204:207]
    v_mfma_f32_16x16x32_bf16 v[208:211], v[136:139], v[88:91], v[208:211]
    v_mfma_f32_16x16x32_bf16 v[212:215], v[140:143], v[88:91], v[212:215]
    v_mfma_f32_16x16x32_bf16 v[216:219], v[120:123], v[92:95], v[216:219]
    v_mfma_f32_16x16x32_bf16 v[220:223], v[124:127], v[92:95], v[220:223]
    v_mfma_f32_16x16x32_bf16 v[224:227], v[128:131], v[92:95], v[224:227]
    v_mfma_f32_16x16x32_bf16 v[228:231], v[132:135], v[92:95], v[228:231]
    v_mfma_f32_16x16x32_bf16 v[232:235], v[136:139], v[92:95], v[232:235]
    v_mfma_f32_16x16x32_bf16 v[236:239], v[140:143], v[92:95], v[236:239]
    s_nop 15
    s_nop 3
g1_epi:
    s_cmp_eq_u32 s45, 2
    s_cbranch_scc1 g1_epi_ffn
    s_mul_i32 s3, s4, 192
    s_mul_i32 s6, s22, 48
    s_add_u32 s3, s3, s6
    v_lshrrev_b32 v1, 4, v20
    v_lshlrev_b32 v1, 2, v1
    v_add_u32 v1, s3, v1
    v_and_b32 v2, 15, v20
    s_lshl_b32 s6, s21, 6
    s_add_u32 s6, s6, s23
    v_add_u32 v2, s6, v2
    s_movk_i32 s7, 3277
    s_movk_i32 s48, 20
    s_mov_b32 s60, 3145728
    s_mov_b32 s61, 11534336
    s_mov_b32 s47, 0x3ea52bf4
    v_add_u32 v3, 0, v1
    v_cmp_le_u32 vcc, 640, v3
    s_nop 1
    v_cndmask_b32 v4, 0, 1, vcc
    v_cmp_le_u32 vcc, 1280, v3
    s_nop 1
    v_cndmask_b32 v5, 0, 1, vcc
    v_add_u32 v4, v4, v5
    s_movk_i32 s3, 640
    v_mul_lo_u32 v6, v4, s3
    v_sub_u32 v3, v3, v6
    v_mul_lo_u32 v6, v3, s7
    v_lshrrev_b32 v6, 16, v6
    v_mul_lo_u32 v7, v6, s48
    v_sub_u32 v7, v3, v7
    v_lshlrev_b32 v8, 22, v4
    v_lshl_add_u32 v8, v6, 17, v8
    v_lshl_add_u32 v8, v7, 1, v8
    v_lshl_add_u32 v9, v6, 5, v7
    v_lshlrev_b32 v9, 12, v9
    v_cmp_eq_u32 vcc, 0, v4
    v_mov_b32 v10, 1.0
    v_mov_b32 v11, s47
    v_cndmask_b32 v10, v10, v11, vcc
    v_cmp_eq_u32 s[56:57], 0, v5
    s_nop 3
    v_mul_f32 v12, v10, v144
    v_mul_f32 v13, v10, v145
    v_mul_f32 v14, v10, v146
    v_mul_f32 v15, v10, v147
    v_cvt_pk_bf16_f32 v24, v12, v13
    v_cvt_pk_bf16_f32 v25, v14, v15
    v_add_u32 v26, 0, v2
    v_lshl_add_u32 v27, v26, 6, v8
    s_mov_b64 s[58:59], exec
    s_and_b64 exec, exec, s[56:57]
    buffer_store_dwordx2 v[24:25], v27, s[8:11], s60 offen
    s_andn2_b64 exec, s[58:59], s[56:57]
    v_and_b32 v27, 0xfffffff3, v26
    v_bfe_u32 v28, v26, 2, 1
    v_lshl_or_b32 v27, v28, 3, v27
    v_bfe_u32 v28, v26, 3, 1
    v_lshl_or_b32 v27, v28, 2, v27
    v_lshl_add_u32 v27, v27, 1, v9
    buffer_store_short v24, v27, s[8:11], s61 offen
    v_add_u32 v28, 4096, v27
    buffer_store_short_d16_hi v24, v28, s[8:11], s61 offen
    v_add_u32 v27, 8192, v27
    buffer_store_short v25, v27, s[8:11], s61 offen
    v_add_u32 v28, 8192, v28
    buffer_store_short_d16_hi v25, v28, s[8:11], s61 offen
    s_mov_b64 exec, s[58:59]
    v_mul_f32 v12, v10, v168
    v_mul_f32 v13, v10, v169
    v_mul_f32 v14, v10, v170
    v_mul_f32 v15, v10, v171
    v_cvt_pk_bf16_f32 v24, v12, v13
    v_cvt_pk_bf16_f32 v25, v14, v15
    v_add_u32 v26, 16, v2
    v_lshl_add_u32 v27, v26, 6, v8
    s_mov_b64 s[58:59], exec
    s_and_b64 exec, exec, s[56:57]
    buffer_store_dwordx2 v[24:25], v27, s[8:11], s60 offen
    s_andn2_b64 exec, s[58:59], s[56:57]
    v_and_b32 v27, 0xfffffff3, v26
    v_bfe_u32 v28, v26, 2, 1
    v_lshl_or_b32 v27, v28, 3, v27
    v_bfe_u32 v28, v26, 3, 1
    v_lshl_or_b32 v27, v28, 2, v27
    v_lshl_add_u32 v27, v27, 1, v9
    buffer_store_short v24, v27, s[8:11], s61 offen
    v_add_u32 v28, 4096, v27
    buffer_store_short_d16_hi v24, v28, s[8:11], s61 offen
    v_add_u32 v27, 8192, v27
    buffer_store_short v25, v27, s[8:11], s61 offen
    v_add_u32 v28, 8192, v28
    buffer_store_short_d16_hi v25, v28, s[8:11], s61 offen
    s_mov_b64 exec, s[58:59]
    v_mul_f32 v12, v10, v192
    v_mul_f32 v13, v10, v193
    v_mul_f32 v14, v10, v194
    v_mul_f32 v15, v10, v195
    v_cvt_pk_bf16_f32 v24, v12, v13
    v_cvt_pk_bf16_f32 v25, v14, v15
    v_add_u32 v26, 32, v2
    v_lshl_add_u32 v27, v26, 6, v8
    s_mov_b64 s[58:59], exec
    s_and_b64 exec, exec, s[56:57]
    buffer_store_dwordx2 v[24:25], v27, s[8:11], s60 offen
    s_andn2_b64 exec, s[58:59], s[56:57]
    v_and_b32 v27, 0xfffffff3, v26
    v_bfe_u32 v28, v26, 2, 1
    v_lshl_or_b32 v27, v28, 3, v27
    v_bfe_u32 v28, v26, 3, 1
    v_lshl_or_b32 v27, v28, 2, v27
    v_lshl_add_u32 v27, v27, 1, v9
    buffer_store_short v24, v27, s[8:11], s61 offen
    v_add_u32 v28, 4096, v27
    buffer_store_short_d16_hi v24, v28, s[8:11], s61 offen
    v_add_u32 v27, 8192, v27
    buffer_store_short v25, v27, s[8:11], s61 offen
    v_add_u32 v28, 8192, v28
    buffer_store_short_d16_hi v25, v28, s[8:11], s61 offen
    s_mov_b64 exec, s[58:59]
    v_mul_f32 v12, v10, v216
    v_mul_f32 v13, v10, v217
    v_mul_f32 v14, v10, v218
    v_mul_f32 v15, v10, v219
    v_cvt_pk_bf16_f32 v24, v12, v13
    v_cvt_pk_bf16_f32 v25, v14, v15
    v_add_u32 v26, 48, v2
    v_lshl_add_u32 v27, v26, 6, v8
    s_mov_b64 s[58:59], exec
    s_and_b64 exec, exec, s[56:57]
    buffer_store_dwordx2 v[24:25], v27, s[8:11], s60 offen
    s_andn2_b64 exec, s[58:59], s[56:57]
    v_and_b32 v27, 0xfffffff3, v26
    v_bfe_u32 v28, v26, 2, 1
    v_lshl_or_b32 v27, v28, 3, v27
    v_bfe_u32 v28, v26, 3, 1
    v_lshl_or_b32 v27, v28, 2, v27
    v_lshl_add_u32 v27, v27, 1, v9
    buffer_store_short v24, v27, s[8:11], s61 offen
    v_add_u32 v28, 4096, v27
    buffer_store_short_d16_hi v24, v28, s[8:11], s61 offen
    v_add_u32 v27, 8192, v27
    buffer_store_short v25, v27, s[8:11], s61 offen
    v_add_u32 v28, 8192, v28
    buffer_store_short_d16_hi v25, v28, s[8:11], s61 offen
    s_mov_b64 exec, s[58:59]
    v_add_u32 v3, 16, v1
    v_cmp_le_u32 vcc, 640, v3
    s_nop 1
    v_cndmask_b32 v4, 0, 1, vcc
    v_cmp_le_u32 vcc, 1280, v3
    s_nop 1
    v_cndmask_b32 v5, 0, 1, vcc
    v_add_u32 v4, v4, v5
    s_movk_i32 s3, 640
    v_mul_lo_u32 v6, v4, s3
    v_sub_u32 v3, v3, v6
    v_mul_lo_u32 v6, v3, s7
    v_lshrrev_b32 v6, 16, v6
    v_mul_lo_u32 v7, v6, s48
    v_sub_u32 v7, v3, v7
    v_lshlrev_b32 v8, 22, v4
    v_lshl_add_u32 v8, v6, 17, v8
    v_lshl_add_u32 v8, v7, 1, v8
    v_lshl_add_u32 v9, v6, 5, v7
    v_lshlrev_b32 v9, 12, v9
    v_cmp_eq_u32 vcc, 0, v4
    v_mov_b32 v10, 1.0
    v_mov_b32 v11, s47
    v_cndmask_b32 v10, v10, v11, vcc
    v_cmp_eq_u32 s[56:57], 0, v5
    s_nop 3
    v_mul_f32 v12, v10, v148
    v_mul_f32 v13, v10, v149
    v_mul_f32 v14, v10, v150
    v_mul_f32 v15, v10, v151
    v_cvt_pk_bf16_f32 v24, v12, v13
    v_cvt_pk_bf16_f32 v25, v14, v15
    v_add_u32 v26, 0, v2
    v_lshl_add_u32 v27, v26, 6, v8
    s_mov_b64 s[58:59], exec
    s_and_b64 exec, exec, s[56:57]
    buffer_store_dwordx2 v[24:25], v27, s[8:11], s60 offen
    s_andn2_b64 exec, s[58:59], s[56:57]
    v_and_b32 v27, 0xfffffff3, v26
    v_bfe_u32 v28, v26, 2, 1
    v_lshl_or_b32 v27, v28, 3, v27
    v_bfe_u32 v28, v26, 3, 1
    v_lshl_or_b32 v27, v28, 2, v27
    v_lshl_add_u32 v27, v27, 1, v9
    buffer_store_short v24, v27, s[8:11], s61 offen
    v_add_u32 v28, 4096, v27
    buffer_store_short_d16_hi v24, v28, s[8:11], s61 offen
    v_add_u32 v27, 8192, v27
    buffer_store_short v25, v27, s[8:11], s61 offen
    v_add_u32 v28, 8192, v28
    buffer_store_short_d16_hi v25, v28, s[8:11], s61 offen
    s_mov_b64 exec, s[58:59]
    v_mul_f32 v12, v10, v172
    v_mul_f32 v13, v10, v173
    v_mul_f32 v14, v10, v174
    v_mul_f32 v15, v10, v175
    v_cvt_pk_bf16_f32 v24, v12, v13
    v_cvt_pk_bf16_f32 v25, v14, v15
    v_add_u32 v26, 16, v2
    v_lshl_add_u32 v27, v26, 6, v8
    s_mov_b64 s[58:59], exec
    s_and_b64 exec, exec, s[56:57]
    buffer_store_dwordx2 v[24:25], v27, s[8:11], s60 offen
    s_andn2_b64 exec, s[58:59], s[56:57]
    v_and_b32 v27, 0xfffffff3, v26
    v_bfe_u32 v28, v26, 2, 1
    v_lshl_or_b32 v27, v28, 3, v27
    v_bfe_u32 v28, v26, 3, 1
    v_lshl_or_b32 v27, v28, 2, v27
    v_lshl_add_u32 v27, v27, 1, v9
    buffer_store_short v24, v27, s[8:11], s61 offen
    v_add_u32 v28, 4096, v27
    buffer_store_short_d16_hi v24, v28, s[8:11], s61 offen
    v_add_u32 v27, 8192, v27
    buffer_store_short v25, v27, s[8:11], s61 offen
    v_add_u32 v28, 8192, v28
    buffer_store_short_d16_hi v25, v28, s[8:11], s61 offen
    s_mov_b64 exec, s[58:59]
    v_mul_f32 v12, v10, v196
    v_mul_f32 v13, v10, v197
    v_mul_f32 v14, v10, v198
    v_mul_f32 v15, v10, v199
    v_cvt_pk_bf16_f32 v24, v12, v13
    v_cvt_pk_bf16_f32 v25, v14, v15
    v_add_u32 v26, 32, v2
    v_lshl_add_u32 v27, v26, 6, v8
    s_mov_b64 s[58:59], exec
    s_and_b64 exec, exec, s[56:57]
    buffer_store_dwordx2 v[24:25], v27, s[8:11], s60 offen
    s_andn2_b64 exec, s[58:59], s[56:57]
    v_and_b32 v27, 0xfffffff3, v26
    v_bfe_u32 v28, v26, 2, 1
    v_lshl_or_b32 v27, v28, 3, v27
    v_bfe_u32 v28, v26, 3, 1
    v_lshl_or_b32 v27, v28, 2, v27
    v_lshl_add_u32 v27, v27, 1, v9
    buffer_store_short v24, v27, s[8:11], s61 offen
    v_add_u32 v28, 4096, v27
    buffer_store_short_d16_hi v24, v28, s[8:11], s61 offen
    v_add_u32 v27, 8192, v27
    buffer_store_short v25, v27, s[8:11], s61 offen
    v_add_u32 v28, 8192, v28
    buffer_store_short_d16_hi v25, v28, s[8:11], s61 offen
    s_mov_b64 exec, s[58:59]
    v_mul_f32 v12, v10, v220
    v_mul_f32 v13, v10, v221
    v_mul_f32 v14, v10, v222
    v_mul_f32 v15, v10, v223
    v_cvt_pk_bf16_f32 v24, v12, v13
    v_cvt_pk_bf16_f32 v25, v14, v15
    v_add_u32 v26, 48, v2
    v_lshl_add_u32 v27, v26, 6, v8
    s_mov_b64 s[58:59], exec
    s_and_b64 exec, exec, s[56:57]
    buffer_store_dwordx2 v[24:25], v27, s[8:11], s60 offen
    s_andn2_b64 exec, s[58:59], s[56:57]
    v_and_b32 v27, 0xfffffff3, v26
    v_bfe_u32 v28, v26, 2, 1
    v_lshl_or_b32 v27, v28, 3, v27
    v_bfe_u32 v28, v26, 3, 1
    v_lshl_or_b32 v27, v28, 2, v27
    v_lshl_add_u32 v27, v27, 1, v9
    buffer_store_short v24, v27, s[8:11], s61 offen
    v_add_u32 v28, 4096, v27
    buffer_store_short_d16_hi v24, v28, s[8:11], s61 offen
    v_add_u32 v27, 8192, v27
    buffer_store_short v25, v27, s[8:11], s61 offen
    v_add_u32 v28, 8192, v28
    buffer_store_short_d16_hi v25, v28, s[8:11], s61 offen
    s_mov_b64 exec, s[58:59]
    v_add_u32 v3, 32, v1
    v_cmp_le_u32 vcc, 640, v3
    s_nop 1
    v_cndmask_b32 v4, 0, 1, vcc
    v_cmp_le_u32 vcc, 1280, v3
    s_nop 1
    v_cndmask_b32 v5, 0, 1, vcc
    v_add_u32 v4, v4, v5
    s_movk_i32 s3, 640
    v_mul_lo_u32 v6, v4, s3
    v_sub_u32 v3, v3, v6
    v_mul_lo_u32 v6, v3, s7
    v_lshrrev_b32 v6, 16, v6
    v_mul_lo_u32 v7, v6, s48
    v_sub_u32 v7, v3, v7
    v_lshlrev_b32 v8, 22, v4
    v_lshl_add_u32 v8, v6, 17, v8
    v_lshl_add_u32 v8, v7, 1, v8
    v_lshl_add_u32 v9, v6, 5, v7
    v_lshlrev_b32 v9, 12, v9
    v_cmp_eq_u32 vcc, 0, v4
    v_mov_b32 v10, 1.0
    v_mov_b32 v11, s47
    v_cndmask_b32 v10, v10, v11, vcc
    v_cmp_eq_u32 s[56:57], 0, v5
    s_nop 3
    v_mul_f32 v12, v10, v152
    v_mul_f32 v13, v10, v153
    v_mul_f32 v14, v10, v154
    v_mul_f32 v15, v10, v155
    v_cvt_pk_bf16_f32 v24, v12, v13
    v_cvt_pk_bf16_f32 v25, v14, v15
    v_add_u32 v26, 0, v2
    v_lshl_add_u32 v27, v26, 6, v8
    s_mov_b64 s[58:59], exec
    s_and_b64 exec, exec, s[56:57]
    buffer_store_dwordx2 v[24:25], v27, s[8:11], s60 offen
    s_andn2_b64 exec, s[58:59], s[56:57]
    v_and_b32 v27, 0xfffffff3, v26
    v_bfe_u32 v28, v26, 2, 1
    v_lshl_or_b32 v27, v28, 3, v27
    v_bfe_u32 v28, v26, 3, 1
    v_lshl_or_b32 v27, v28, 2, v27
    v_lshl_add_u32 v27, v27, 1, v9
    buffer_store_short v24, v27, s[8:11], s61 offen
    v_add_u32 v28, 4096, v27
    buffer_store_short_d16_hi v24, v28, s[8:11], s61 offen
    v_add_u32 v27, 8192, v27
    buffer_store_short v25, v27, s[8:11], s61 offen
    v_add_u32 v28, 8192, v28
    buffer_store_short_d16_hi v25, v28, s[8:11], s61 offen
    s_mov_b64 exec, s[58:59]
    v_mul_f32 v12, v10, v176
    v_mul_f32 v13, v10, v177
    v_mul_f32 v14, v10, v178
    v_mul_f32 v15, v10, v179
    v_cvt_pk_bf16_f32 v24, v12, v13
    v_cvt_pk_bf16_f32 v25, v14, v15
    v_add_u32 v26, 16, v2
    v_lshl_add_u32 v27, v26, 6, v8
    s_mov_b64 s[58:59], exec
    s_and_b64 exec, exec, s[56:57]
    buffer_store_dwordx2 v[24:25], v27, s[8:11], s60 offen
    s_andn2_b64 exec, s[58:59], s[56:57]
    v_and_b32 v27, 0xfffffff3, v26
    v_bfe_u32 v28, v26, 2, 1
    v_lshl_or_b32 v27, v28, 3, v27
    v_bfe_u32 v28, v26, 3, 1
    v_lshl_or_b32 v27, v28, 2, v27
    v_lshl_add_u32 v27, v27, 1, v9
    buffer_store_short v24, v27, s[8:11], s61 offen
    v_add_u32 v28, 4096, v27
    buffer_store_short_d16_hi v24, v28, s[8:11], s61 offen
    v_add_u32 v27, 8192, v27
    buffer_store_short v25, v27, s[8:11], s61 offen
    v_add_u32 v28, 8192, v28
    buffer_store_short_d16_hi v25, v28, s[8:11], s61 offen
    s_mov_b64 exec, s[58:59]
    v_mul_f32 v12, v10, v200
    v_mul_f32 v13, v10, v201
    v_mul_f32 v14, v10, v202
    v_mul_f32 v15, v10, v203
    v_cvt_pk_bf16_f32 v24, v12, v13
    v_cvt_pk_bf16_f32 v25, v14, v15
    v_add_u32 v26, 32, v2
    v_lshl_add_u32 v27, v26, 6, v8
    s_mov_b64 s[58:59], exec
    s_and_b64 exec, exec, s[56:57]
    buffer_store_dwordx2 v[24:25], v27, s[8:11], s60 offen
    s_andn2_b64 exec, s[58:59], s[56:57]
    v_and_b32 v27, 0xfffffff3, v26
    v_bfe_u32 v28, v26, 2, 1
    v_lshl_or_b32 v27, v28, 3, v27
    v_bfe_u32 v28, v26, 3, 1
    v_lshl_or_b32 v27, v28, 2, v27
    v_lshl_add_u32 v27, v27, 1, v9
    buffer_store_short v24, v27, s[8:11], s61 offen
    v_add_u32 v28, 4096, v27
    buffer_store_short_d16_hi v24, v28, s[8:11], s61 offen
    v_add_u32 v27, 8192, v27
    buffer_store_short v25, v27, s[8:11], s61 offen
    v_add_u32 v28, 8192, v28
    buffer_store_short_d16_hi v25, v28, s[8:11], s61 offen
    s_mov_b64 exec, s[58:59]
    v_mul_f32 v12, v10, v224
    v_mul_f32 v13, v10, v225
    v_mul_f32 v14, v10, v226
    v_mul_f32 v15, v10, v227
    v_cvt_pk_bf16_f32 v24, v12, v13
    v_cvt_pk_bf16_f32 v25, v14, v15
    v_add_u32 v26, 48, v2
    v_lshl_add_u32 v27, v26, 6, v8
    s_mov_b64 s[58:59], exec
    s_and_b64 exec, exec, s[56:57]
    buffer_store_dwordx2 v[24:25], v27, s[8:11], s60 offen
    s_andn2_b64 exec, s[58:59], s[56:57]
    v_and_b32 v27, 0xfffffff3, v26
    v_bfe_u32 v28, v26, 2, 1
    v_lshl_or_b32 v27, v28, 3, v27
    v_bfe_u32 v28, v26, 3, 1
    v_lshl_or_b32 v27, v28, 2, v27
    v_lshl_add_u32 v27, v27, 1, v9
    buffer_store_short v24, v27, s[8:11], s61 offen
    v_add_u32 v28, 4096, v27
    buffer_store_short_d16_hi v24, v28, s[8:11], s61 offen
    v_add_u32 v27, 8192, v27
    buffer_store_short v25, v27, s[8:11], s61 offen
    v_add_u32 v28, 8192, v28
    buffer_store_short_d16_hi v25, v28, s[8:11], s61 offen
    s_mov_b64 exec, s[58:59]
    v_add_u32 v3, 96, v1
    v_cmp_le_u32 vcc, 640, v3
    s_nop 1
    v_cndmask_b32 v4, 0, 1, vcc
    v_cmp_le_u32 vcc, 1280, v3
    s_nop 1
    v_cndmask_b32 v5, 0, 1, vcc
    v_add_u32 v4, v4, v5
    s_movk_i32 s3, 640
    v_mul_lo_u32 v6, v4, s3
    v_sub_u32 v3, v3, v6
    v_mul_lo_u32 v6, v3, s7
    v_lshrrev_b32 v6, 16, v6
    v_mul_lo_u32 v7, v6, s48
    v_sub_u32 v7, v3, v7
    v_lshlrev_b32 v8, 22, v4
    v_lshl_add_u32 v8, v6, 17, v8
    v_lshl_add_u32 v8, v7, 1, v8
    v_lshl_add_u32 v9, v6, 5, v7
    v_lshlrev_b32 v9, 12, v9
    v_cmp_eq_u32 vcc, 0, v4
    v_mov_b32 v10, 1.0
    v_mov_b32 v11, s47
    v_cndmask_b32 v10, v10, v11, vcc
    v_cmp_eq_u32 s[56:57], 0, v5
    s_nop 3
    v_mul_f32 v12, v10, v156
    v_mul_f32 v13, v10, v157
    v_mul_f32 v14, v10, v158
    v_mul_f32 v15, v10, v159
    v_cvt_pk_bf16_f32 v24, v12, v13
    v_cvt_pk_bf16_f32 v25, v14, v15
    v_add_u32 v26, 0, v2
    v_lshl_add_u32 v27, v26, 6, v8
    s_mov_b64 s[58:59], exec
    s_and_b64 exec, exec, s[56:57]
    buffer_store_dwordx2 v[24:25], v27, s[8:11], s60 offen
    s_andn2_b64 exec, s[58:59], s[56:57]
    v_and_b32 v27, 0xfffffff3, v26
    v_bfe_u32 v28, v26, 2, 1
    v_lshl_or_b32 v27, v28, 3, v27
    v_bfe_u32 v28, v26, 3, 1
    v_lshl_or_b32 v27, v28, 2, v27
    v_lshl_add_u32 v27, v27, 1, v9
    buffer_store_short v24, v27, s[8:11], s61 offen
    v_add_u32 v28, 4096, v27
    buffer_store_short_d16_hi v24, v28, s[8:11], s61 offen
    v_add_u32 v27, 8192, v27
    buffer_store_short v25, v27, s[8:11], s61 offen
    v_add_u32 v28, 8192, v28
    buffer_store_short_d16_hi v25, v28, s[8:11], s61 offen
    s_mov_b64 exec, s[58:59]
    v_mul_f32 v12, v10, v180
    v_mul_f32 v13, v10, v181
    v_mul_f32 v14, v10, v182
    v_mul_f32 v15, v10, v183
    v_cvt_pk_bf16_f32 v24, v12, v13
    v_cvt_pk_bf16_f32 v25, v14, v15
    v_add_u32 v26, 16, v2
    v_lshl_add_u32 v27, v26, 6, v8
    s_mov_b64 s[58:59], exec
    s_and_b64 exec, exec, s[56:57]
    buffer_store_dwordx2 v[24:25], v27, s[8:11], s60 offen
    s_andn2_b64 exec, s[58:59], s[56:57]
    v_and_b32 v27, 0xfffffff3, v26
    v_bfe_u32 v28, v26, 2, 1
    v_lshl_or_b32 v27, v28, 3, v27
    v_bfe_u32 v28, v26, 3, 1
    v_lshl_or_b32 v27, v28, 2, v27
    v_lshl_add_u32 v27, v27, 1, v9
    buffer_store_short v24, v27, s[8:11], s61 offen
    v_add_u32 v28, 4096, v27
    buffer_store_short_d16_hi v24, v28, s[8:11], s61 offen
    v_add_u32 v27, 8192, v27
    buffer_store_short v25, v27, s[8:11], s61 offen
    v_add_u32 v28, 8192, v28
    buffer_store_short_d16_hi v25, v28, s[8:11], s61 offen
    s_mov_b64 exec, s[58:59]
    v_mul_f32 v12, v10, v204
    v_mul_f32 v13, v10, v205
    v_mul_f32 v14, v10, v206
    v_mul_f32 v15, v10, v207
    v_cvt_pk_bf16_f32 v24, v12, v13
    v_cvt_pk_bf16_f32 v25, v14, v15
    v_add_u32 v26, 32, v2
    v_lshl_add_u32 v27, v26, 6, v8
    s_mov_b64 s[58:59], exec
    s_and_b64 exec, exec, s[56:57]
    buffer_store_dwordx2 v[24:25], v27, s[8:11], s60 offen
    s_andn2_b64 exec, s[58:59], s[56:57]
    v_and_b32 v27, 0xfffffff3, v26
    v_bfe_u32 v28, v26, 2, 1
    v_lshl_or_b32 v27, v28, 3, v27
    v_bfe_u32 v28, v26, 3, 1
    v_lshl_or_b32 v27, v28, 2, v27
    v_lshl_add_u32 v27, v27, 1, v9
    buffer_store_short v24, v27, s[8:11], s61 offen
    v_add_u32 v28, 4096, v27
    buffer_store_short_d16_hi v24, v28, s[8:11], s61 offen
    v_add_u32 v27, 8192, v27
    buffer_store_short v25, v27, s[8:11], s61 offen
    v_add_u32 v28, 8192, v28
    buffer_store_short_d16_hi v25, v28, s[8:11], s61 offen
    s_mov_b64 exec, s[58:59]
    v_mul_f32 v12, v10, v228
    v_mul_f32 v13, v10, v229
    v_mul_f32 v14, v10, v230
    v_mul_f32 v15, v10, v231
    v_cvt_pk_bf16_f32 v24, v12, v13
    v_cvt_pk_bf16_f32 v25, v14, v15
    v_add_u32 v26, 48, v2
    v_lshl_add_u32 v27, v26, 6, v8
    s_mov_b64 s[58:59], exec
    s_and_b64 exec, exec, s[56:57]
    buffer_store_dwordx2 v[24:25], v27, s[8:11], s60 offen
    s_andn2_b64 exec, s[58:59], s[56:57]
    v_and_b32 v27, 0xfffffff3, v26
    v_bfe_u32 v28, v26, 2, 1
    v_lshl_or_b32 v27, v28, 3, v27
    v_bfe_u32 v28, v26, 3, 1
    v_lshl_or_b32 v27, v28, 2, v27
    v_lshl_add_u32 v27, v27, 1, v9
    buffer_store_short v24, v27, s[8:11], s61 offen
    v_add_u32 v28, 4096, v27
    buffer_store_short_d16_hi v24, v28, s[8:11], s61 offen
    v_add_u32 v27, 8192, v27
    buffer_store_short v25, v27, s[8:11], s61 offen
    v_add_u32 v28, 8192, v28
    buffer_store_short_d16_hi v25, v28, s[8:11], s61 offen
    s_mov_b64 exec, s[58:59]
    v_add_u32 v3, 112, v1
    v_cmp_le_u32 vcc, 640, v3
    s_nop 1
    v_cndmask_b32 v4, 0, 1, vcc
    v_cmp_le_u32 vcc, 1280, v3
    s_nop 1
    v_cndmask_b32 v5, 0, 1, vcc
    v_add_u32 v4, v4, v5
    s_movk_i32 s3, 640
    v_mul_lo_u32 v6, v4, s3
    v_sub_u32 v3, v3, v6
    v_mul_lo_u32 v6, v3, s7
    v_lshrrev_b32 v6, 16, v6
    v_mul_lo_u32 v7, v6, s48
    v_sub_u32 v7, v3, v7
    v_lshlrev_b32 v8, 22, v4
    v_lshl_add_u32 v8, v6, 17, v8
    v_lshl_add_u32 v8, v7, 1, v8
    v_lshl_add_u32 v9, v6, 5, v7
    v_lshlrev_b32 v9, 12, v9
    v_cmp_eq_u32 vcc, 0, v4
    v_mov_b32 v10, 1.0
    v_mov_b32 v11, s47
    v_cndmask_b32 v10, v10, v11, vcc
    v_cmp_eq_u32 s[56:57], 0, v5
    s_nop 3
    v_mul_f32 v12, v10, v160
    v_mul_f32 v13, v10, v161
    v_mul_f32 v14, v10, v162
    v_mul_f32 v15, v10, v163
    v_cvt_pk_bf16_f32 v24, v12, v13
    v_cvt_pk_bf16_f32 v25, v14, v15
    v_add_u32 v26, 0, v2
    v_lshl_add_u32 v27, v26, 6, v8
    s_mov_b64 s[58:59], exec
    s_and_b64 exec, exec, s[56:57]
    buffer_store_dwordx2 v[24:25], v27, s[8:11], s60 offen
    s_andn2_b64 exec, s[58:59], s[56:57]
    v_and_b32 v27, 0xfffffff3, v26
    v_bfe_u32 v28, v26, 2, 1
    v_lshl_or_b32 v27, v28, 3, v27
    v_bfe_u32 v28, v26, 3, 1
    v_lshl_or_b32 v27, v28, 2, v27
    v_lshl_add_u32 v27, v27, 1, v9
    buffer_store_short v24, v27, s[8:11], s61 offen
    v_add_u32 v28, 4096, v27
    buffer_store_short_d16_hi v24, v28, s[8:11], s61 offen
    v_add_u32 v27, 8192, v27
    buffer_store_short v25, v27, s[8:11], s61 offen
    v_add_u32 v28, 8192, v28
    buffer_store_short_d16_hi v25, v28, s[8:11], s61 offen
    s_mov_b64 exec, s[58:59]
    v_mul_f32 v12, v10, v184
    v_mul_f32 v13, v10, v185
    v_mul_f32 v14, v10, v186
    v_mul_f32 v15, v10, v187
    v_cvt_pk_bf16_f32 v24, v12, v13
    v_cvt_pk_bf16_f32 v25, v14, v15
    v_add_u32 v26, 16, v2
    v_lshl_add_u32 v27, v26, 6, v8
    s_mov_b64 s[58:59], exec
    s_and_b64 exec, exec, s[56:57]
    buffer_store_dwordx2 v[24:25], v27, s[8:11], s60 offen
    s_andn2_b64 exec, s[58:59], s[56:57]
    v_and_b32 v27, 0xfffffff3, v26
    v_bfe_u32 v28, v26, 2, 1
    v_lshl_or_b32 v27, v28, 3, v27
    v_bfe_u32 v28, v26, 3, 1
    v_lshl_or_b32 v27, v28, 2, v27
    v_lshl_add_u32 v27, v27, 1, v9
    buffer_store_short v24, v27, s[8:11], s61 offen
    v_add_u32 v28, 4096, v27
    buffer_store_short_d16_hi v24, v28, s[8:11], s61 offen
    v_add_u32 v27, 8192, v27
    buffer_store_short v25, v27, s[8:11], s61 offen
    v_add_u32 v28, 8192, v28
    buffer_store_short_d16_hi v25, v28, s[8:11], s61 offen
    s_mov_b64 exec, s[58:59]
    v_mul_f32 v12, v10, v208
    v_mul_f32 v13, v10, v209
    v_mul_f32 v14, v10, v210
    v_mul_f32 v15, v10, v211
    v_cvt_pk_bf16_f32 v24, v12, v13
    v_cvt_pk_bf16_f32 v25, v14, v15
    v_add_u32 v26, 32, v2
    v_lshl_add_u32 v27, v26, 6, v8
    s_mov_b64 s[58:59], exec
    s_and_b64 exec, exec, s[56:57]
    buffer_store_dwordx2 v[24:25], v27, s[8:11], s60 offen
    s_andn2_b64 exec, s[58:59], s[56:57]
    v_and_b32 v27, 0xfffffff3, v26
    v_bfe_u32 v28, v26, 2, 1
    v_lshl_or_b32 v27, v28, 3, v27
    v_bfe_u32 v28, v26, 3, 1
    v_lshl_or_b32 v27, v28, 2, v27
    v_lshl_add_u32 v27, v27, 1, v9
    buffer_store_short v24, v27, s[8:11], s61 offen
    v_add_u32 v28, 4096, v27
    buffer_store_short_d16_hi v24, v28, s[8:11], s61 offen
    v_add_u32 v27, 8192, v27
    buffer_store_short v25, v27, s[8:11], s61 offen
    v_add_u32 v28, 8192, v28
    buffer_store_short_d16_hi v25, v28, s[8:11], s61 offen
    s_mov_b64 exec, s[58:59]
    v_mul_f32 v12, v10, v232
    v_mul_f32 v13, v10, v233
    v_mul_f32 v14, v10, v234
    v_mul_f32 v15, v10, v235
    v_cvt_pk_bf16_f32 v24, v12, v13
    v_cvt_pk_bf16_f32 v25, v14, v15
    v_add_u32 v26, 48, v2
    v_lshl_add_u32 v27, v26, 6, v8
    s_mov_b64 s[58:59], exec
    s_and_b64 exec, exec, s[56:57]
    buffer_store_dwordx2 v[24:25], v27, s[8:11], s60 offen
    s_andn2_b64 exec, s[58:59], s[56:57]
    v_and_b32 v27, 0xfffffff3, v26
    v_bfe_u32 v28, v26, 2, 1
    v_lshl_or_b32 v27, v28, 3, v27
    v_bfe_u32 v28, v26, 3, 1
    v_lshl_or_b32 v27, v28, 2, v27
    v_lshl_add_u32 v27, v27, 1, v9
    buffer_store_short v24, v27, s[8:11], s61 offen
    v_add_u32 v28, 4096, v27
    buffer_store_short_d16_hi v24, v28, s[8:11], s61 offen
    v_add_u32 v27, 8192, v27
    buffer_store_short v25, v27, s[8:11], s61 offen
    v_add_u32 v28, 8192, v28
    buffer_store_short_d16_hi v25, v28, s[8:11], s61 offen
    s_mov_b64 exec, s[58:59]
    v_add_u32 v3, 128, v1
    v_cmp_le_u32 vcc, 640, v3
    s_nop 1
    v_cndmask_b32 v4, 0, 1, vcc
    v_cmp_le_u32 vcc, 1280, v3
    s_nop 1
    v_cndmask_b32 v5, 0, 1, vcc
    v_add_u32 v4, v4, v5
    s_movk_i32 s3, 640
    v_mul_lo_u32 v6, v4, s3
    v_sub_u32 v3, v3, v6
    v_mul_lo_u32 v6, v3, s7
    v_lshrrev_b32 v6, 16, v6
    v_mul_lo_u32 v7, v6, s48
    v_sub_u32 v7, v3, v7
    v_lshlrev_b32 v8, 22, v4
    v_lshl_add_u32 v8, v6, 17, v8
    v_lshl_add_u32 v8, v7, 1, v8
    v_lshl_add_u32 v9, v6, 5, v7
    v_lshlrev_b32 v9, 12, v9
    v_cmp_eq_u32 vcc, 0, v4
    v_mov_b32 v10, 1.0
    v_mov_b32 v11, s47
    v_cndmask_b32 v10, v10, v11, vcc
    v_cmp_eq_u32 s[56:57], 0, v5
    s_nop 3
    v_mul_f32 v12, v10, v164
    v_mul_f32 v13, v10, v165
    v_mul_f32 v14, v10, v166
    v_mul_f32 v15, v10, v167
    v_cvt_pk_bf16_f32 v24, v12, v13
    v_cvt_pk_bf16_f32 v25, v14, v15
    v_add_u32 v26, 0, v2
    v_lshl_add_u32 v27, v26, 6, v8
    s_mov_b64 s[58:59], exec
    s_and_b64 exec, exec, s[56:57]
    buffer_store_dwordx2 v[24:25], v27, s[8:11], s60 offen
    s_andn2_b64 exec, s[58:59], s[56:57]
    v_and_b32 v27, 0xfffffff3, v26
    v_bfe_u32 v28, v26, 2, 1
    v_lshl_or_b32 v27, v28, 3, v27
    v_bfe_u32 v28, v26, 3, 1
    v_lshl_or_b32 v27, v28, 2, v27
    v_lshl_add_u32 v27, v27, 1, v9
    buffer_store_short v24, v27, s[8:11], s61 offen
    v_add_u32 v28, 4096, v27
    buffer_store_short_d16_hi v24, v28, s[8:11], s61 offen
    v_add_u32 v27, 8192, v27
    buffer_store_short v25, v27, s[8:11], s61 offen
    v_add_u32 v28, 8192, v28
    buffer_store_short_d16_hi v25, v28, s[8:11], s61 offen
    s_mov_b64 exec, s[58:59]
    v_mul_f32 v12, v10, v188
    v_mul_f32 v13, v10, v189
    v_mul_f32 v14, v10, v190
    v_mul_f32 v15, v10, v191
    v_cvt_pk_bf16_f32 v24, v12, v13
    v_cvt_pk_bf16_f32 v25, v14, v15
    v_add_u32 v26, 16, v2
    v_lshl_add_u32 v27, v26, 6, v8
    s_mov_b64 s[58:59], exec
    s_and_b64 exec, exec, s[56:57]
    buffer_store_dwordx2 v[24:25], v27, s[8:11], s60 offen
    s_andn2_b64 exec, s[58:59], s[56:57]
    v_and_b32 v27, 0xfffffff3, v26
    v_bfe_u32 v28, v26, 2, 1
    v_lshl_or_b32 v27, v28, 3, v27
    v_bfe_u32 v28, v26, 3, 1
    v_lshl_or_b32 v27, v28, 2, v27
    v_lshl_add_u32 v27, v27, 1, v9
    buffer_store_short v24, v27, s[8:11], s61 offen
    v_add_u32 v28, 4096, v27
    buffer_store_short_d16_hi v24, v28, s[8:11], s61 offen
    v_add_u32 v27, 8192, v27
    buffer_store_short v25, v27, s[8:11], s61 offen
    v_add_u32 v28, 8192, v28
    buffer_store_short_d16_hi v25, v28, s[8:11], s61 offen
    s_mov_b64 exec, s[58:59]
    v_mul_f32 v12, v10, v212
    v_mul_f32 v13, v10, v213
    v_mul_f32 v14, v10, v214
    v_mul_f32 v15, v10, v215
    v_cvt_pk_bf16_f32 v24, v12, v13
    v_cvt_pk_bf16_f32 v25, v14, v15
    v_add_u32 v26, 32, v2
    v_lshl_add_u32 v27, v26, 6, v8
    s_mov_b64 s[58:59], exec
    s_and_b64 exec, exec, s[56:57]
    buffer_store_dwordx2 v[24:25], v27, s[8:11], s60 offen
    s_andn2_b64 exec, s[58:59], s[56:57]
    v_and_b32 v27, 0xfffffff3, v26
    v_bfe_u32 v28, v26, 2, 1
    v_lshl_or_b32 v27, v28, 3, v27
    v_bfe_u32 v28, v26, 3, 1
    v_lshl_or_b32 v27, v28, 2, v27
    v_lshl_add_u32 v27, v27, 1, v9
    buffer_store_short v24, v27, s[8:11], s61 offen
    v_add_u32 v28, 4096, v27
    buffer_store_short_d16_hi v24, v28, s[8:11], s61 offen
    v_add_u32 v27, 8192, v27
    buffer_store_short v25, v27, s[8:11], s61 offen
    v_add_u32 v28, 8192, v28
    buffer_store_short_d16_hi v25, v28, s[8:11], s61 offen
    s_mov_b64 exec, s[58:59]
    v_mul_f32 v12, v10, v236
    v_mul_f32 v13, v10, v237
    v_mul_f32 v14, v10, v238
    v_mul_f32 v15, v10, v239
    v_cvt_pk_bf16_f32 v24, v12, v13
    v_cvt_pk_bf16_f32 v25, v14, v15
    v_add_u32 v26, 48, v2
    v_lshl_add_u32 v27, v26, 6, v8
    s_mov_b64 s[58:59], exec
    s_and_b64 exec, exec, s[56:57]
    buffer_store_dwordx2 v[24:25], v27, s[8:11], s60 offen
    s_andn2_b64 exec, s[58:59], s[56:57]
    v_and_b32 v27, 0xfffffff3, v26
    v_bfe_u32 v28, v26, 2, 1
    v_lshl_or_b32 v27, v28, 3, v27
    v_bfe_u32 v28, v26, 3, 1
    v_lshl_or_b32 v27, v28, 2, v27
    v_lshl_add_u32 v27, v27, 1, v9
    buffer_store_short v24, v27, s[8:11], s61 offen
    v_add_u32 v28, 4096, v27
    buffer_store_short_d16_hi v24, v28, s[8:11], s61 offen
    v_add_u32 v27, 8192, v27
    buffer_store_short v25, v27, s[8:11], s61 offen
    v_add_u32 v28, 8192, v28
    buffer_store_short_d16_hi v25, v28, s[8:11], s61 offen
    s_mov_b64 exec, s[58:59]
    s_branch g1_end2
g1_epi_ffn:
    v_and_b32 v2, 15, v20
    s_lshl_b32 s6, s21, 6
    s_add_u32 s6, s6, s23
    v_add_u32 v2, s6, v2
    s_movk_i32 s7, 3456
    v_mul_lo_u32 v2, v2, s7
    v_lshrrev_b32 v1, 4, v20
    v_lshlrev_b32 v1, 3, v1
    v_add_u32 v2, v2, v1
    s_mul_i32 s3, s4, 192
    s_mul_i32 s6, s22, 96
    s_add_u32 s3, s3, s6
    s_add_u32 s3, s3, 15728640
    s_mov_b32 s46, 0x3d372713
    s_mov_b32 s47, 0xc0135761
    v_cvt_pk_bf16_f32 v3, v144, v144
    v_lshlrev_b32 v3, 16, v3
    v_mul_f32 v4, v3, v3
    v_mul_f32 v4, s46, v4
    v_fma_f32 v4, v4, v3, v3
    v_mul_f32 v4, s47, v4
    v_exp_f32 v4, v4
    s_nop 0
    v_add_f32 v4, 1.0, v4
    v_rcp_f32 v4, v4
    s_nop 0
    v_mul_f32 v4, v4, v3
    v_cvt_pk_bf16_f32 v4, v4, v4
    v_lshlrev_b32 v4, 16, v4
    v_cvt_pk_bf16_f32 v5, v156, v156
    v_lshlrev_b32 v5, 16, v5
    v_mul_f32 v6, v4, v5
    v_cvt_pk_bf16_f32 v3, v145, v145
    v_lshlrev_b32 v3, 16, v3
    v_mul_f32 v4, v3, v3
    v_mul_f32 v4, s46, v4
    v_fma_f32 v4, v4, v3, v3
    v_mul_f32 v4, s47, v4
    v_exp_f32 v4, v4
    s_nop 0
    v_add_f32 v4, 1.0, v4
    v_rcp_f32 v4, v4
    s_nop 0
    v_mul_f32 v4, v4, v3
    v_cvt_pk_bf16_f32 v4, v4, v4
    v_lshlrev_b32 v4, 16, v4
    v_cvt_pk_bf16_f32 v5, v157, v157
    v_lshlrev_b32 v5, 16, v5
    v_mul_f32 v7, v4, v5
    v_cvt_pk_bf16_f32 v3, v146, v146
    v_lshlrev_b32 v3, 16, v3
    v_mul_f32 v4, v3, v3
    v_mul_f32 v4, s46, v4
    v_fma_f32 v4, v4, v3, v3
    v_mul_f32 v4, s47, v4
    v_exp_f32 v4, v4
    s_nop 0
    v_add_f32 v4, 1.0, v4
    v_rcp_f32 v4, v4
    s_nop 0
    v_mul_f32 v4, v4, v3
    v_cvt_pk_bf16_f32 v4, v4, v4
    v_lshlrev_b32 v4, 16, v4
    v_cvt_pk_bf16_f32 v5, v158, v158
    v_lshlrev_b32 v5, 16, v5
    v_mul_f32 v8, v4, v5
    v_cvt_pk_bf16_f32 v3, v147, v147
    v_lshlrev_b32 v3, 16, v3
    v_mul_f32 v4, v3, v3
    v_mul_f32 v4, s46, v4
    v_fma_f32 v4, v4, v3, v3
    v_mul_f32 v4, s47, v4
    v_exp_f32 v4, v4
    s_nop 0
    v_add_f32 v4, 1.0, v4
    v_rcp_f32 v4, v4
    s_nop 0
    v_mul_f32 v4, v4, v3
    v_cvt_pk_bf16_f32 v4, v4, v4
    v_lshlrev_b32 v4, 16, v4
    v_cvt_pk_bf16_f32 v5, v159, v159
    v_lshlrev_b32 v5, 16, v5
    v_mul_f32 v9, v4, v5
    v_cvt_pk_bf16_f32 v10, v6, v7
    v_cvt_pk_bf16_f32 v11, v8, v9
    buffer_store_dwordx2 v[10:11], v2, s[8:11], s3 offen offset:0
    v_cvt_pk_bf16_f32 v3, v148, v148
    v_lshlrev_b32 v3, 16, v3
    v_mul_f32 v4, v3, v3
    v_mul_f32 v4, s46, v4
    v_fma_f32 v4, v4, v3, v3
    v_mul_f32 v4, s47, v4
    v_exp_f32 v4, v4
    s_nop 0
    v_add_f32 v4, 1.0, v4
    v_rcp_f32 v4, v4
    s_nop 0
    v_mul_f32 v4, v4, v3
    v_cvt_pk_bf16_f32 v4, v4, v4
    v_lshlrev_b32 v4, 16, v4
    v_cvt_pk_bf16_f32 v5, v160, v160
    v_lshlrev_b32 v5, 16, v5
    v_mul_f32 v6, v4, v5
    v_cvt_pk_bf16_f32 v3, v149, v149
    v_lshlrev_b32 v3, 16, v3
    v_mul_f32 v4, v3, v3
    v_mul_f32 v4, s46, v4
    v_fma_f32 v4, v4, v3, v3
    v_mul_f32 v4, s47, v4
    v_exp_f32 v4, v4
    s_nop 0
    v_add_f32 v4, 1.0, v4
    v_rcp_f32 v4, v4
    s_nop 0
    v_mul_f32 v4, v4, v3
    v_cvt_pk_bf16_f32 v4, v4, v4
    v_lshlrev_b32 v4, 16, v4
    v_cvt_pk_bf16_f32 v5, v161, v161
    v_lshlrev_b32 v5, 16, v5
    v_mul_f32 v7, v4, v5
    v_cvt_pk_bf16_f32 v3, v150, v150
    v_lshlrev_b32 v3, 16, v3
    v_mul_f32 v4, v3, v3
    v_mul_f32 v4, s46, v4
    v_fma_f32 v4, v4, v3, v3
    v_mul_f32 v4, s47, v4
    v_exp_f32 v4, v4
    s_nop 0
    v_add_f32 v4, 1.0, v4
    v_rcp_f32 v4, v4
    s_nop 0
    v_mul_f32 v4, v4, v3
    v_cvt_pk_bf16_f32 v4, v4, v4
    v_lshlrev_b32 v4, 16, v4
    v_cvt_pk_bf16_f32 v5, v162, v162
    v_lshlrev_b32 v5, 16, v5
    v_mul_f32 v8, v4, v5
    v_cvt_pk_bf16_f32 v3, v151, v151
    v_lshlrev_b32 v3, 16, v3
    v_mul_f32 v4, v3, v3
    v_mul_f32 v4, s46, v4
    v_fma_f32 v4, v4, v3, v3
    v_mul_f32 v4, s47, v4
    v_exp_f32 v4, v4
    s_nop 0
    v_add_f32 v4, 1.0, v4
    v_rcp_f32 v4, v4
    s_nop 0
    v_mul_f32 v4, v4, v3
    v_cvt_pk_bf16_f32 v4, v4, v4
    v_lshlrev_b32 v4, 16, v4
    v_cvt_pk_bf16_f32 v5, v163, v163
    v_lshlrev_b32 v5, 16, v5
    v_mul_f32 v9, v4, v5
    v_cvt_pk_bf16_f32 v12, v6, v7
    v_cvt_pk_bf16_f32 v13, v8, v9
    buffer_store_dwordx2 v[12:13], v2, s[8:11], s3 offen offset:32
    v_cvt_pk_bf16_f32 v3, v152, v152
    v_lshlrev_b32 v3, 16, v3
    v_mul_f32 v4, v3, v3
    v_mul_f32 v4, s46, v4
    v_fma_f32 v4, v4, v3, v3
    v_mul_f32 v4, s47, v4
    v_exp_f32 v4, v4
    s_nop 0
    v_add_f32 v4, 1.0, v4
    v_rcp_f32 v4, v4
    s_nop 0
    v_mul_f32 v4, v4, v3
    v_cvt_pk_bf16_f32 v4, v4, v4
    v_lshlrev_b32 v4, 16, v4
    v_cvt_pk_bf16_f32 v5, v164, v164
    v_lshlrev_b32 v5, 16, v5
    v_mul_f32 v6, v4, v5
    v_cvt_pk_bf16_f32 v3, v153, v153
    v_lshlrev_b32 v3, 16, v3
    v_mul_f32 v4, v3, v3
    v_mul_f32 v4, s46, v4
    v_fma_f32 v4, v4, v3, v3
    v_mul_f32 v4, s47, v4
    v_exp_f32 v4, v4
    s_nop 0
    v_add_f32 v4, 1.0, v4
    v_rcp_f32 v4, v4
    s_nop 0
    v_mul_f32 v4, v4, v3
    v_cvt_pk_bf16_f32 v4, v4, v4
    v_lshlrev_b32 v4, 16, v4
    v_cvt_pk_bf16_f32 v5, v165, v165
    v_lshlrev_b32 v5, 16, v5
    v_mul_f32 v7, v4, v5
    v_cvt_pk_bf16_f32 v3, v154, v154
    v_lshlrev_b32 v3, 16, v3
    v_mul_f32 v4, v3, v3
    v_mul_f32 v4, s46, v4
    v_fma_f32 v4, v4, v3, v3
    v_mul_f32 v4, s47, v4
    v_exp_f32 v4, v4
    s_nop 0
    v_add_f32 v4, 1.0, v4
    v_rcp_f32 v4, v4
    s_nop 0
    v_mul_f32 v4, v4, v3
    v_cvt_pk_bf16_f32 v4, v4, v4
    v_lshlrev_b32 v4, 16, v4
    v_cvt_pk_bf16_f32 v5, v166, v166
    v_lshlrev_b32 v5, 16, v5
    v_mul_f32 v8, v4, v5
    v_cvt_pk_bf16_f32 v3, v155, v155
    v_lshlrev_b32 v3, 16, v3
    v_mul_f32 v4, v3, v3
    v_mul_f32 v4, s46, v4
    v_fma_f32 v4, v4, v3, v3
    v_mul_f32 v4, s47, v4
    v_exp_f32 v4, v4
    s_nop 0
    v_add_f32 v4, 1.0, v4
    v_rcp_f32 v4, v4
    s_nop 0
    v_mul_f32 v4, v4, v3
    v_cvt_pk_bf16_f32 v4, v4, v4
    v_lshlrev_b32 v4, 16, v4
    v_cvt_pk_bf16_f32 v5, v167, v167
    v_lshlrev_b32 v5, 16, v5
    v_mul_f32 v9, v4, v5
    v_cvt_pk_bf16_f32 v10, v6, v7
    v_cvt_pk_bf16_f32 v11, v8, v9
    buffer_store_dwordx2 v[10:11], v2, s[8:11], s3 offen offset:64
    v_add_u32 v2, 55296, v2
    v_cvt_pk_bf16_f32 v3, v168, v168
    v_lshlrev_b32 v3, 16, v3
    v_mul_f32 v4, v3, v3
    v_mul_f32 v4, s46, v4
    v_fma_f32 v4, v4, v3, v3
    v_mul_f32 v4, s47, v4
    v_exp_f32 v4, v4
    s_nop 0
    v_add_f32 v4, 1.0, v4
    v_rcp_f32 v4, v4
    s_nop 0
    v_mul_f32 v4, v4, v3
    v_cvt_pk_bf16_f32 v4, v4, v4
    v_lshlrev_b32 v4, 16, v4
    v_cvt_pk_bf16_f32 v5, v180, v180
    v_lshlrev_b32 v5, 16, v5
    v_mul_f32 v6, v4, v5
    v_cvt_pk_bf16_f32 v3, v169, v169
    v_lshlrev_b32 v3, 16, v3
    v_mul_f32 v4, v3, v3
    v_mul_f32 v4, s46, v4
    v_fma_f32 v4, v4, v3, v3
    v_mul_f32 v4, s47, v4
    v_exp_f32 v4, v4
    s_nop 0
    v_add_f32 v4, 1.0, v4
    v_rcp_f32 v4, v4
    s_nop 0
    v_mul_f32 v4, v4, v3
    v_cvt_pk_bf16_f32 v4, v4, v4
    v_lshlrev_b32 v4, 16, v4
    v_cvt_pk_bf16_f32 v5, v181, v181
    v_lshlrev_b32 v5, 16, v5
    v_mul_f32 v7, v4, v5
    v_cvt_pk_bf16_f32 v3, v170, v170
    v_lshlrev_b32 v3, 16, v3
    v_mul_f32 v4, v3, v3
    v_mul_f32 v4, s46, v4
    v_fma_f32 v4, v4, v3, v3
    v_mul_f32 v4, s47, v4
    v_exp_f32 v4, v4
    s_nop 0
    v_add_f32 v4, 1.0, v4
    v_rcp_f32 v4, v4
    s_nop 0
    v_mul_f32 v4, v4, v3
    v_cvt_pk_bf16_f32 v4, v4, v4
    v_lshlrev_b32 v4, 16, v4
    v_cvt_pk_bf16_f32 v5, v182, v182
    v_lshlrev_b32 v5, 16, v5
    v_mul_f32 v8, v4, v5
    v_cvt_pk_bf16_f32 v3, v171, v171
    v_lshlrev_b32 v3, 16, v3
    v_mul_f32 v4, v3, v3
    v_mul_f32 v4, s46, v4
    v_fma_f32 v4, v4, v3, v3
    v_mul_f32 v4, s47, v4
    v_exp_f32 v4, v4
    s_nop 0
    v_add_f32 v4, 1.0, v4
    v_rcp_f32 v4, v4
    s_nop 0
    v_mul_f32 v4, v4, v3
    v_cvt_pk_bf16_f32 v4, v4, v4
    v_lshlrev_b32 v4, 16, v4
    v_cvt_pk_bf16_f32 v5, v183, v183
    v_lshlrev_b32 v5, 16, v5
    v_mul_f32 v9, v4, v5
    v_cvt_pk_bf16_f32 v10, v6, v7
    v_cvt_pk_bf16_f32 v11, v8, v9
    buffer_store_dwordx2 v[10:11], v2, s[8:11], s3 offen offset:0
    v_cvt_pk_bf16_f32 v3, v172, v172
    v_lshlrev_b32 v3, 16, v3
    v_mul_f32 v4, v3, v3
    v_mul_f32 v4, s46, v4
    v_fma_f32 v4, v4, v3, v3
    v_mul_f32 v4, s47, v4
    v_exp_f32 v4, v4
    s_nop 0
    v_add_f32 v4, 1.0, v4
    v_rcp_f32 v4, v4
    s_nop 0
    v_mul_f32 v4, v4, v3
    v_cvt_pk_bf16_f32 v4, v4, v4
    v_lshlrev_b32 v4, 16, v4
    v_cvt_pk_bf16_f32 v5, v184, v184
    v_lshlrev_b32 v5, 16, v5
    v_mul_f32 v6, v4, v5
    v_cvt_pk_bf16_f32 v3, v173, v173
    v_lshlrev_b32 v3, 16, v3
    v_mul_f32 v4, v3, v3
    v_mul_f32 v4, s46, v4
    v_fma_f32 v4, v4, v3, v3
    v_mul_f32 v4, s47, v4
    v_exp_f32 v4, v4
    s_nop 0
    v_add_f32 v4, 1.0, v4
    v_rcp_f32 v4, v4
    s_nop 0
    v_mul_f32 v4, v4, v3
    v_cvt_pk_bf16_f32 v4, v4, v4
    v_lshlrev_b32 v4, 16, v4
    v_cvt_pk_bf16_f32 v5, v185, v185
    v_lshlrev_b32 v5, 16, v5
    v_mul_f32 v7, v4, v5
    v_cvt_pk_bf16_f32 v3, v174, v174
    v_lshlrev_b32 v3, 16, v3
    v_mul_f32 v4, v3, v3
    v_mul_f32 v4, s46, v4
    v_fma_f32 v4, v4, v3, v3
    v_mul_f32 v4, s47, v4
    v_exp_f32 v4, v4
    s_nop 0
    v_add_f32 v4, 1.0, v4
    v_rcp_f32 v4, v4
    s_nop 0
    v_mul_f32 v4, v4, v3
    v_cvt_pk_bf16_f32 v4, v4, v4
    v_lshlrev_b32 v4, 16, v4
    v_cvt_pk_bf16_f32 v5, v186, v186
    v_lshlrev_b32 v5, 16, v5
    v_mul_f32 v8, v4, v5
    v_cvt_pk_bf16_f32 v3, v175, v175
    v_lshlrev_b32 v3, 16, v3
    v_mul_f32 v4, v3, v3
    v_mul_f32 v4, s46, v4
    v_fma_f32 v4, v4, v3, v3
    v_mul_f32 v4, s47, v4
    v_exp_f32 v4, v4
    s_nop 0
    v_add_f32 v4, 1.0, v4
    v_rcp_f32 v4, v4
    s_nop 0
    v_mul_f32 v4, v4, v3
    v_cvt_pk_bf16_f32 v4, v4, v4
    v_lshlrev_b32 v4, 16, v4
    v_cvt_pk_bf16_f32 v5, v187, v187
    v_lshlrev_b32 v5, 16, v5
    v_mul_f32 v9, v4, v5
    v_cvt_pk_bf16_f32 v12, v6, v7
    v_cvt_pk_bf16_f32 v13, v8, v9
    buffer_store_dwordx2 v[12:13], v2, s[8:11], s3 offen offset:32
    v_cvt_pk_bf16_f32 v3, v176, v176
    v_lshlrev_b32 v3, 16, v3
    v_mul_f32 v4, v3, v3
    v_mul_f32 v4, s46, v4
    v_fma_f32 v4, v4, v3, v3
    v_mul_f32 v4, s47, v4
    v_exp_f32 v4, v4
    s_nop 0
    v_add_f32 v4, 1.0, v4
    v_rcp_f32 v4, v4
    s_nop 0
    v_mul_f32 v4, v4, v3
    v_cvt_pk_bf16_f32 v4, v4, v4
    v_lshlrev_b32 v4, 16, v4
    v_cvt_pk_bf16_f32 v5, v188, v188
    v_lshlrev_b32 v5, 16, v5
    v_mul_f32 v6, v4, v5
    v_cvt_pk_bf16_f32 v3, v177, v177
    v_lshlrev_b32 v3, 16, v3
    v_mul_f32 v4, v3, v3
    v_mul_f32 v4, s46, v4
    v_fma_f32 v4, v4, v3, v3
    v_mul_f32 v4, s47, v4
    v_exp_f32 v4, v4
    s_nop 0
    v_add_f32 v4, 1.0, v4
    v_rcp_f32 v4, v4
    s_nop 0
    v_mul_f32 v4, v4, v3
    v_cvt_pk_bf16_f32 v4, v4, v4
    v_lshlrev_b32 v4, 16, v4
    v_cvt_pk_bf16_f32 v5, v189, v189
    v_lshlrev_b32 v5, 16, v5
    v_mul_f32 v7, v4, v5
    v_cvt_pk_bf16_f32 v3, v178, v178
    v_lshlrev_b32 v3, 16, v3
    v_mul_f32 v4, v3, v3
    v_mul_f32 v4, s46, v4
    v_fma_f32 v4, v4, v3, v3
    v_mul_f32 v4, s47, v4
    v_exp_f32 v4, v4
    s_nop 0
    v_add_f32 v4, 1.0, v4
    v_rcp_f32 v4, v4
    s_nop 0
    v_mul_f32 v4, v4, v3
    v_cvt_pk_bf16_f32 v4, v4, v4
    v_lshlrev_b32 v4, 16, v4
    v_cvt_pk_bf16_f32 v5, v190, v190
    v_lshlrev_b32 v5, 16, v5
    v_mul_f32 v8, v4, v5
    v_cvt_pk_bf16_f32 v3, v179, v179
    v_lshlrev_b32 v3, 16, v3
    v_mul_f32 v4, v3, v3
    v_mul_f32 v4, s46, v4
    v_fma_f32 v4, v4, v3, v3
    v_mul_f32 v4, s47, v4
    v_exp_f32 v4, v4
    s_nop 0
    v_add_f32 v4, 1.0, v4
    v_rcp_f32 v4, v4
    s_nop 0
    v_mul_f32 v4, v4, v3
    v_cvt_pk_bf16_f32 v4, v4, v4
    v_lshlrev_b32 v4, 16, v4
    v_cvt_pk_bf16_f32 v5, v191, v191
    v_lshlrev_b32 v5, 16, v5
    v_mul_f32 v9, v4, v5
    v_cvt_pk_bf16_f32 v10, v6, v7
    v_cvt_pk_bf16_f32 v11, v8, v9
    buffer_store_dwordx2 v[10:11], v2, s[8:11], s3 offen offset:64
    v_add_u32 v2, 55296, v2
    v_cvt_pk_bf16_f32 v3, v192, v192
    v_lshlrev_b32 v3, 16, v3
    v_mul_f32 v4, v3, v3
    v_mul_f32 v4, s46, v4
    v_fma_f32 v4, v4, v3, v3
    v_mul_f32 v4, s47, v4
    v_exp_f32 v4, v4
    s_nop 0
    v_add_f32 v4, 1.0, v4
    v_rcp_f32 v4, v4
    s_nop 0
    v_mul_f32 v4, v4, v3
    v_cvt_pk_bf16_f32 v4, v4, v4
    v_lshlrev_b32 v4, 16, v4
    v_cvt_pk_bf16_f32 v5, v204, v204
    v_lshlrev_b32 v5, 16, v5
    v_mul_f32 v6, v4, v5
    v_cvt_pk_bf16_f32 v3, v193, v193
    v_lshlrev_b32 v3, 16, v3
    v_mul_f32 v4, v3, v3
    v_mul_f32 v4, s46, v4
    v_fma_f32 v4, v4, v3, v3
    v_mul_f32 v4, s47, v4
    v_exp_f32 v4, v4
    s_nop 0
    v_add_f32 v4, 1.0, v4
    v_rcp_f32 v4, v4
    s_nop 0
    v_mul_f32 v4, v4, v3
    v_cvt_pk_bf16_f32 v4, v4, v4
    v_lshlrev_b32 v4, 16, v4
    v_cvt_pk_bf16_f32 v5, v205, v205
    v_lshlrev_b32 v5, 16, v5
    v_mul_f32 v7, v4, v5
    v_cvt_pk_bf16_f32 v3, v194, v194
    v_lshlrev_b32 v3, 16, v3
    v_mul_f32 v4, v3, v3
    v_mul_f32 v4, s46, v4
    v_fma_f32 v4, v4, v3, v3
    v_mul_f32 v4, s47, v4
    v_exp_f32 v4, v4
    s_nop 0
    v_add_f32 v4, 1.0, v4
    v_rcp_f32 v4, v4
    s_nop 0
    v_mul_f32 v4, v4, v3
    v_cvt_pk_bf16_f32 v4, v4, v4
    v_lshlrev_b32 v4, 16, v4
    v_cvt_pk_bf16_f32 v5, v206, v206
    v_lshlrev_b32 v5, 16, v5
    v_mul_f32 v8, v4, v5
    v_cvt_pk_bf16_f32 v3, v195, v195
    v_lshlrev_b32 v3, 16, v3
    v_mul_f32 v4, v3, v3
    v_mul_f32 v4, s46, v4
    v_fma_f32 v4, v4, v3, v3
    v_mul_f32 v4, s47, v4
    v_exp_f32 v4, v4
    s_nop 0
    v_add_f32 v4, 1.0, v4
    v_rcp_f32 v4, v4
    s_nop 0
    v_mul_f32 v4, v4, v3
    v_cvt_pk_bf16_f32 v4, v4, v4
    v_lshlrev_b32 v4, 16, v4
    v_cvt_pk_bf16_f32 v5, v207, v207
    v_lshlrev_b32 v5, 16, v5
    v_mul_f32 v9, v4, v5
    v_cvt_pk_bf16_f32 v10, v6, v7
    v_cvt_pk_bf16_f32 v11, v8, v9
    buffer_store_dwordx2 v[10:11], v2, s[8:11], s3 offen offset:0
    v_cvt_pk_bf16_f32 v3, v196, v196
    v_lshlrev_b32 v3, 16, v3
    v_mul_f32 v4, v3, v3
    v_mul_f32 v4, s46, v4
    v_fma_f32 v4, v4, v3, v3
    v_mul_f32 v4, s47, v4
    v_exp_f32 v4, v4
    s_nop 0
    v_add_f32 v4, 1.0, v4
    v_rcp_f32 v4, v4
    s_nop 0
    v_mul_f32 v4, v4, v3
    v_cvt_pk_bf16_f32 v4, v4, v4
    v_lshlrev_b32 v4, 16, v4
    v_cvt_pk_bf16_f32 v5, v208, v208
    v_lshlrev_b32 v5, 16, v5
    v_mul_f32 v6, v4, v5
    v_cvt_pk_bf16_f32 v3, v197, v197
    v_lshlrev_b32 v3, 16, v3
    v_mul_f32 v4, v3, v3
    v_mul_f32 v4, s46, v4
    v_fma_f32 v4, v4, v3, v3
    v_mul_f32 v4, s47, v4
    v_exp_f32 v4, v4
    s_nop 0
    v_add_f32 v4, 1.0, v4
    v_rcp_f32 v4, v4
    s_nop 0
    v_mul_f32 v4, v4, v3
    v_cvt_pk_bf16_f32 v4, v4, v4
    v_lshlrev_b32 v4, 16, v4
    v_cvt_pk_bf16_f32 v5, v209, v209
    v_lshlrev_b32 v5, 16, v5
    v_mul_f32 v7, v4, v5
    v_cvt_pk_bf16_f32 v3, v198, v198
    v_lshlrev_b32 v3, 16, v3
    v_mul_f32 v4, v3, v3
    v_mul_f32 v4, s46, v4
    v_fma_f32 v4, v4, v3, v3
    v_mul_f32 v4, s47, v4
    v_exp_f32 v4, v4
    s_nop 0
    v_add_f32 v4, 1.0, v4
    v_rcp_f32 v4, v4
    s_nop 0
    v_mul_f32 v4, v4, v3
    v_cvt_pk_bf16_f32 v4, v4, v4
    v_lshlrev_b32 v4, 16, v4
    v_cvt_pk_bf16_f32 v5, v210, v210
    v_lshlrev_b32 v5, 16, v5
    v_mul_f32 v8, v4, v5
    v_cvt_pk_bf16_f32 v3, v199, v199
    v_lshlrev_b32 v3, 16, v3
    v_mul_f32 v4, v3, v3
    v_mul_f32 v4, s46, v4
    v_fma_f32 v4, v4, v3, v3
    v_mul_f32 v4, s47, v4
    v_exp_f32 v4, v4
    s_nop 0
    v_add_f32 v4, 1.0, v4
    v_rcp_f32 v4, v4
    s_nop 0
    v_mul_f32 v4, v4, v3
    v_cvt_pk_bf16_f32 v4, v4, v4
    v_lshlrev_b32 v4, 16, v4
    v_cvt_pk_bf16_f32 v5, v211, v211
    v_lshlrev_b32 v5, 16, v5
    v_mul_f32 v9, v4, v5
    v_cvt_pk_bf16_f32 v12, v6, v7
    v_cvt_pk_bf16_f32 v13, v8, v9
    buffer_store_dwordx2 v[12:13], v2, s[8:11], s3 offen offset:32
    v_cvt_pk_bf16_f32 v3, v200, v200
    v_lshlrev_b32 v3, 16, v3
    v_mul_f32 v4, v3, v3
    v_mul_f32 v4, s46, v4
    v_fma_f32 v4, v4, v3, v3
    v_mul_f32 v4, s47, v4
    v_exp_f32 v4, v4
    s_nop 0
    v_add_f32 v4, 1.0, v4
    v_rcp_f32 v4, v4
    s_nop 0
    v_mul_f32 v4, v4, v3
    v_cvt_pk_bf16_f32 v4, v4, v4
    v_lshlrev_b32 v4, 16, v4
    v_cvt_pk_bf16_f32 v5, v212, v212
    v_lshlrev_b32 v5, 16, v5
    v_mul_f32 v6, v4, v5
    v_cvt_pk_bf16_f32 v3, v201, v201
    v_lshlrev_b32 v3, 16, v3
    v_mul_f32 v4, v3, v3
    v_mul_f32 v4, s46, v4
    v_fma_f32 v4, v4, v3, v3
    v_mul_f32 v4, s47, v4
    v_exp_f32 v4, v4
    s_nop 0
    v_add_f32 v4, 1.0, v4
    v_rcp_f32 v4, v4
    s_nop 0
    v_mul_f32 v4, v4, v3
    v_cvt_pk_bf16_f32 v4, v4, v4
    v_lshlrev_b32 v4, 16, v4
    v_cvt_pk_bf16_f32 v5, v213, v213
    v_lshlrev_b32 v5, 16, v5
    v_mul_f32 v7, v4, v5
    v_cvt_pk_bf16_f32 v3, v202, v202
    v_lshlrev_b32 v3, 16, v3
    v_mul_f32 v4, v3, v3
    v_mul_f32 v4, s46, v4
    v_fma_f32 v4, v4, v3, v3
    v_mul_f32 v4, s47, v4
    v_exp_f32 v4, v4
    s_nop 0
    v_add_f32 v4, 1.0, v4
    v_rcp_f32 v4, v4
    s_nop 0
    v_mul_f32 v4, v4, v3
    v_cvt_pk_bf16_f32 v4, v4, v4
    v_lshlrev_b32 v4, 16, v4
    v_cvt_pk_bf16_f32 v5, v214, v214
    v_lshlrev_b32 v5, 16, v5
    v_mul_f32 v8, v4, v5
    v_cvt_pk_bf16_f32 v3, v203, v203
    v_lshlrev_b32 v3, 16, v3
    v_mul_f32 v4, v3, v3
    v_mul_f32 v4, s46, v4
    v_fma_f32 v4, v4, v3, v3
    v_mul_f32 v4, s47, v4
    v_exp_f32 v4, v4
    s_nop 0
    v_add_f32 v4, 1.0, v4
    v_rcp_f32 v4, v4
    s_nop 0
    v_mul_f32 v4, v4, v3
    v_cvt_pk_bf16_f32 v4, v4, v4
    v_lshlrev_b32 v4, 16, v4
    v_cvt_pk_bf16_f32 v5, v215, v215
    v_lshlrev_b32 v5, 16, v5
    v_mul_f32 v9, v4, v5
    v_cvt_pk_bf16_f32 v10, v6, v7
    v_cvt_pk_bf16_f32 v11, v8, v9
    buffer_store_dwordx2 v[10:11], v2, s[8:11], s3 offen offset:64
    v_add_u32 v2, 55296, v2
    v_cvt_pk_bf16_f32 v3, v216, v216
    v_lshlrev_b32 v3, 16, v3
    v_mul_f32 v4, v3, v3
    v_mul_f32 v4, s46, v4
    v_fma_f32 v4, v4, v3, v3
    v_mul_f32 v4, s47, v4
    v_exp_f32 v4, v4
    s_nop 0
    v_add_f32 v4, 1.0, v4
    v_rcp_f32 v4, v4
    s_nop 0
    v_mul_f32 v4, v4, v3
    v_cvt_pk_bf16_f32 v4, v4, v4
    v_lshlrev_b32 v4, 16, v4
    v_cvt_pk_bf16_f32 v5, v228, v228
    v_lshlrev_b32 v5, 16, v5
    v_mul_f32 v6, v4, v5
    v_cvt_pk_bf16_f32 v3, v217, v217
    v_lshlrev_b32 v3, 16, v3
    v_mul_f32 v4, v3, v3
    v_mul_f32 v4, s46, v4
    v_fma_f32 v4, v4, v3, v3
    v_mul_f32 v4, s47, v4
    v_exp_f32 v4, v4
    s_nop 0
    v_add_f32 v4, 1.0, v4
    v_rcp_f32 v4, v4
    s_nop 0
    v_mul_f32 v4, v4, v3
    v_cvt_pk_bf16_f32 v4, v4, v4
    v_lshlrev_b32 v4, 16, v4
    v_cvt_pk_bf16_f32 v5, v229, v229
    v_lshlrev_b32 v5, 16, v5
    v_mul_f32 v7, v4, v5
    v_cvt_pk_bf16_f32 v3, v218, v218
    v_lshlrev_b32 v3, 16, v3
    v_mul_f32 v4, v3, v3
    v_mul_f32 v4, s46, v4
    v_fma_f32 v4, v4, v3, v3
    v_mul_f32 v4, s47, v4
    v_exp_f32 v4, v4
    s_nop 0
    v_add_f32 v4, 1.0, v4
    v_rcp_f32 v4, v4
    s_nop 0
    v_mul_f32 v4, v4, v3
    v_cvt_pk_bf16_f32 v4, v4, v4
    v_lshlrev_b32 v4, 16, v4
    v_cvt_pk_bf16_f32 v5, v230, v230
    v_lshlrev_b32 v5, 16, v5
    v_mul_f32 v8, v4, v5
    v_cvt_pk_bf16_f32 v3, v219, v219
    v_lshlrev_b32 v3, 16, v3
    v_mul_f32 v4, v3, v3
    v_mul_f32 v4, s46, v4
    v_fma_f32 v4, v4, v3, v3
    v_mul_f32 v4, s47, v4
    v_exp_f32 v4, v4
    s_nop 0
    v_add_f32 v4, 1.0, v4
    v_rcp_f32 v4, v4
    s_nop 0
    v_mul_f32 v4, v4, v3
    v_cvt_pk_bf16_f32 v4, v4, v4
    v_lshlrev_b32 v4, 16, v4
    v_cvt_pk_bf16_f32 v5, v231, v231
    v_lshlrev_b32 v5, 16, v5
    v_mul_f32 v9, v4, v5
    v_cvt_pk_bf16_f32 v10, v6, v7
    v_cvt_pk_bf16_f32 v11, v8, v9
    buffer_store_dwordx2 v[10:11], v2, s[8:11], s3 offen offset:0
    v_cvt_pk_bf16_f32 v3, v220, v220
    v_lshlrev_b32 v3, 16, v3
    v_mul_f32 v4, v3, v3
    v_mul_f32 v4, s46, v4
    v_fma_f32 v4, v4, v3, v3
    v_mul_f32 v4, s47, v4
    v_exp_f32 v4, v4
    s_nop 0
    v_add_f32 v4, 1.0, v4
    v_rcp_f32 v4, v4
    s_nop 0
    v_mul_f32 v4, v4, v3
    v_cvt_pk_bf16_f32 v4, v4, v4
    v_lshlrev_b32 v4, 16, v4
    v_cvt_pk_bf16_f32 v5, v232, v232
    v_lshlrev_b32 v5, 16, v5
    v_mul_f32 v6, v4, v5
    v_cvt_pk_bf16_f32 v3, v221, v221
    v_lshlrev_b32 v3, 16, v3
    v_mul_f32 v4, v3, v3
    v_mul_f32 v4, s46, v4
    v_fma_f32 v4, v4, v3, v3
    v_mul_f32 v4, s47, v4
    v_exp_f32 v4, v4
    s_nop 0
    v_add_f32 v4, 1.0, v4
    v_rcp_f32 v4, v4
    s_nop 0
    v_mul_f32 v4, v4, v3
    v_cvt_pk_bf16_f32 v4, v4, v4
    v_lshlrev_b32 v4, 16, v4
    v_cvt_pk_bf16_f32 v5, v233, v233
    v_lshlrev_b32 v5, 16, v5
    v_mul_f32 v7, v4, v5
    v_cvt_pk_bf16_f32 v3, v222, v222
    v_lshlrev_b32 v3, 16, v3
    v_mul_f32 v4, v3, v3
    v_mul_f32 v4, s46, v4
    v_fma_f32 v4, v4, v3, v3
    v_mul_f32 v4, s47, v4
    v_exp_f32 v4, v4
    s_nop 0
    v_add_f32 v4, 1.0, v4
    v_rcp_f32 v4, v4
    s_nop 0
    v_mul_f32 v4, v4, v3
    v_cvt_pk_bf16_f32 v4, v4, v4
    v_lshlrev_b32 v4, 16, v4
    v_cvt_pk_bf16_f32 v5, v234, v234
    v_lshlrev_b32 v5, 16, v5
    v_mul_f32 v8, v4, v5
    v_cvt_pk_bf16_f32 v3, v223, v223
    v_lshlrev_b32 v3, 16, v3
    v_mul_f32 v4, v3, v3
    v_mul_f32 v4, s46, v4
    v_fma_f32 v4, v4, v3, v3
    v_mul_f32 v4, s47, v4
    v_exp_f32 v4, v4
    s_nop 0
    v_add_f32 v4, 1.0, v4
    v_rcp_f32 v4, v4
    s_nop 0
    v_mul_f32 v4, v4, v3
    v_cvt_pk_bf16_f32 v4, v4, v4
    v_lshlrev_b32 v4, 16, v4
    v_cvt_pk_bf16_f32 v5, v235, v235
    v_lshlrev_b32 v5, 16, v5
    v_mul_f32 v9, v4, v5
    v_cvt_pk_bf16_f32 v12, v6, v7
    v_cvt_pk_bf16_f32 v13, v8, v9
    buffer_store_dwordx2 v[12:13], v2, s[8:11], s3 offen offset:32
    v_cvt_pk_bf16_f32 v3, v224, v224
    v_lshlrev_b32 v3, 16, v3
    v_mul_f32 v4, v3, v3
    v_mul_f32 v4, s46, v4
    v_fma_f32 v4, v4, v3, v3
    v_mul_f32 v4, s47, v4
    v_exp_f32 v4, v4
    s_nop 0
    v_add_f32 v4, 1.0, v4
    v_rcp_f32 v4, v4
    s_nop 0
    v_mul_f32 v4, v4, v3
    v_cvt_pk_bf16_f32 v4, v4, v4
    v_lshlrev_b32 v4, 16, v4
    v_cvt_pk_bf16_f32 v5, v236, v236
    v_lshlrev_b32 v5, 16, v5
    v_mul_f32 v6, v4, v5
    v_cvt_pk_bf16_f32 v3, v225, v225
    v_lshlrev_b32 v3, 16, v3
    v_mul_f32 v4, v3, v3
    v_mul_f32 v4, s46, v4
    v_fma_f32 v4, v4, v3, v3
    v_mul_f32 v4, s47, v4
    v_exp_f32 v4, v4
    s_nop 0
    v_add_f32 v4, 1.0, v4
    v_rcp_f32 v4, v4
    s_nop 0
    v_mul_f32 v4, v4, v3
    v_cvt_pk_bf16_f32 v4, v4, v4
    v_lshlrev_b32 v4, 16, v4
    v_cvt_pk_bf16_f32 v5, v237, v237
    v_lshlrev_b32 v5, 16, v5
    v_mul_f32 v7, v4, v5
    v_cvt_pk_bf16_f32 v3, v226, v226
    v_lshlrev_b32 v3, 16, v3
    v_mul_f32 v4, v3, v3
    v_mul_f32 v4, s46, v4
    v_fma_f32 v4, v4, v3, v3
    v_mul_f32 v4, s47, v4
    v_exp_f32 v4, v4
    s_nop 0
    v_add_f32 v4, 1.0, v4
    v_rcp_f32 v4, v4
    s_nop 0
    v_mul_f32 v4, v4, v3
    v_cvt_pk_bf16_f32 v4, v4, v4
    v_lshlrev_b32 v4, 16, v4
    v_cvt_pk_bf16_f32 v5, v238, v238
    v_lshlrev_b32 v5, 16, v5
    v_mul_f32 v8, v4, v5
    v_cvt_pk_bf16_f32 v3, v227, v227
    v_lshlrev_b32 v3, 16, v3
    v_mul_f32 v4, v3, v3
    v_mul_f32 v4, s46, v4
    v_fma_f32 v4, v4, v3, v3
    v_mul_f32 v4, s47, v4
    v_exp_f32 v4, v4
    s_nop 0
    v_add_f32 v4, 1.0, v4
    v_rcp_f32 v4, v4
    s_nop 0
    v_mul_f32 v4, v4, v3
    v_cvt_pk_bf16_f32 v4, v4, v4
    v_lshlrev_b32 v4, 16, v4
    v_cvt_pk_bf16_f32 v5, v239, v239
    v_lshlrev_b32 v5, 16, v5
    v_mul_f32 v9, v4, v5
    v_cvt_pk_bf16_f32 v10, v6, v7
    v_cvt_pk_bf16_f32 v11, v8, v9
    buffer_store_dwordx2 v[10:11], v2, s[8:11], s3 offen offset:64
g1_end2:
    s_waitcnt vmcnt(0)
g1_end:
    s_endpgm
.globl attn_kernel
.p2align 8
.type attn_kernel,@function
attn_kernel:
    s_cmp_ge_u32 s2, 256
    s_cbranch_scc1 at_gemm
    s_load_dwordx2 s[6:7], s[0:1], 72
    v_and_b32 v2, 63, v0
    v_lshrrev_b32 v1, 6, v0
    s_nop 0
    v_readfirstlane_b32 s20, v1
    s_and_b32 s21, s2, 7
    s_lshr_b32 s22, s2, 6
    s_lshl_b32 s22, s22, 3
    s_add_u32 s21, s21, s22
    s_lshr_b32 s22, s2, 3
    s_and_b32 s22, s22, 7
    s_lshl_b32 s22, s22, 8
    s_lshl_b32 s3, s20, 5
    s_add_u32 s22, s22, s3
    s_lshl_b32 s38, s20, 10
    s_waitcnt lgkmcnt(0)
    s_mov_b32 s8, s6
    s_and_b32 s9, s7, 0xffff
    s_mov_b32 s10, 268435456
    s_mov_b32 s11, 0x00020000
    v_and_b32 v1, 31, v2
    v_add_u32 v1, s22, v1
    v_lshlrev_b32 v1, 6, v1
    v_lshrrev_b32 v3, 5, v2
    v_lshl_add_u32 v1, v3, 4, v1
    s_lshl_b32 s3, s21, 17
    s_add_u32 s3, s3, 3145728
    buffer_load_dwordx4 v[16:19], v1, s[8:11], s3 offen
    buffer_load_dwordx4 v[20:23], v1, s[8:11], s3 offen offset:32
    v_lshrrev_b32 v1, 2, v2
    v_lshlrev_b32 v1, 6, v1
    v_and_b32 v3, 3, v2
    v_bfe_u32 v4, v2, 4, 2
    v_xor_b32 v3, v3, v4
    v_lshl_add_u32 v114, v3, 4, v1
    v_lshrrev_b32 v1, 4, v2
    v_and_b32 v3, 15, v2
    v_xor_b32 v3, v3, v1
    s_lshl_b32 s3, s20, 2
    s_and_b32 s3, s3, 12
    v_xor_b32 v3, s3, v3
    v_lshlrev_b32 v1, 12, v1
    v_lshl_add_u32 v115, v3, 4, v1
    s_lshl_b32 s3, s21, 11
    s_lshl_b32 s4, s20, 4
    s_add_u32 s3, s3, s4
    s_lshl_b32 s3, s3, 6
    s_add_u32 s28, s3, 7340032
    s_lshl_b32 s3, s21, 5
    s_lshl_b32 s4, s20, 2
    s_add_u32 s3, s3, s4
    s_lshl_b32 s3, s3, 12
    s_add_u32 s30, s3, 11534336
    v_and_b32 v1, 31, v2
    v_lshrrev_b32 v3, 5, v2
    v_add_u32 v3, 0, v3
    v_bfe_u32 v4, v2, 2, 2
    v_xor_b32 v3, v3, v4
    v_lshlrev_b32 v1, 6, v1
    v_lshl_add_u32 v104, v3, 4, v1
    v_and_b32 v1, 31, v2
    v_lshrrev_b32 v3, 5, v2
    v_add_u32 v3, 2, v3
    v_bfe_u32 v4, v2, 2, 2
    v_xor_b32 v3, v3, v4
    v_lshlrev_b32 v1, 6, v1
    v_lshl_add_u32 v105, v3, 4, v1
    v_and_b32 v1, 31, v2
    v_lshrrev_b32 v3, 5, v2
    v_add_u32 v3, 0, v3
    v_and_b32 v4, 15, v2
    v_xor_b32 v3, v3, v4
    v_lshlrev_b32 v1, 8, v1
    v_lshl_add_u32 v1, v3, 4, v1
    v_add_u32 v106, 8192, v1
    v_and_b32 v1, 31, v2
    v_lshrrev_b32 v3, 5, v2
    v_add_u32 v3, 2, v3
    v_and_b32 v4, 15, v2
    v_xor_b32 v3, v3, v4
    v_lshlrev_b32 v1, 8, v1
    v_lshl_add_u32 v1, v3, 4, v1
    v_add_u32 v107, 8192, v1
    v_and_b32 v1, 31, v2
    v_lshrrev_b32 v3, 5, v2
    v_add_u32 v3, 4, v3
    v_and_b32 v4, 15, v2
    v_xor_b32 v3, v3, v4
    v_lshlrev_b32 v1, 8, v1
    v_lshl_add_u32 v1, v3, 4, v1
    v_add_u32 v108, 8192, v1
    v_and_b32 v1, 31, v2
    v_lshrrev_b32 v3, 5, v2
    v_add_u32 v3, 6, v3
    v_and_b32 v4, 15, v2
    v_xor_b32 v3, v3, v4
    v_lshlrev_b32 v1, 8, v1
    v_lshl_add_u32 v1, v3, 4, v1
    v_add_u32 v109, 8192, v1
    v_and_b32 v1, 31, v2
    v_lshrrev_b32 v3, 5, v2
    v_add_u32 v3, 8, v3
    v_and_b32 v4, 15, v2
    v_xor_b32 v3, v3, v4
    v_lshlrev_b32 v1, 8, v1
    v_lshl_add_u32 v1, v3, 4, v1
    v_add_u32 v110, 8192, v1
    v_and_b32 v1, 31, v2
    v_lshrrev_b32 v3, 5, v2
    v_add_u32 v3, 10, v3
    v_and_b32 v4, 15, v2
    v_xor_b32 v3, v3, v4
    v_lshlrev_b32 v1, 8, v1
    v_lshl_add_u32 v1, v3, 4, v1
    v_add_u32 v111, 8192, v1
    v_and_b32 v1, 31, v2
    v_lshrrev_b32 v3, 5, v2
    v_add_u32 v3, 12, v3
    v_and_b32 v4, 15, v2
    v_xor_b32 v3, v3, v4
    v_lshlrev_b32 v1, 8, v1
    v_lshl_add_u32 v1, v3, 4, v1
    v_add_u32 v112, 8192, v1
    v_and_b32 v1, 31, v2
    v_lshrrev_b32 v3, 5, v2
    v_add_u32 v3, 14, v3
    v_and_b32 v4, 15, v2
    v_xor_b32 v3, v3, v4
    v_lshlrev_b32 v1, 8, v1
    v_lshl_add_u32 v1, v3, 4, v1
    v_add_u32 v113, 8192, v1
    v_xor_b32 v121, 32, v2
    v_lshlrev_b32 v121, 2, v121
    v_mov_b32 v117, 0xff800000
    v_mov_b32 v118, 0
    v_cmp_gt_u32 vcc, 32, v2
    s_nop 1
    v_cndmask_b32 v122, 0, -1, vcc
    v_mov_b32 v88, 0
    v_mov_b32 v89, 0
    v_mov_b32 v90, 0
    v_mov_b32 v91, 0
    v_mov_b32 v92, 0
    v_mov_b32 v93, 0
    v_mov_b32 v94, 0
    v_mov_b32 v95, 0
    v_mov_b32 v96, 0
    v_mov_b32 v97, 0
    v_mov_b32 v98, 0
    v_mov_b32 v99, 0
    v_mov_b32 v100, 0
    v_mov_b32 v101, 0
    v_mov_b32 v102, 0
    v_mov_b32 v103, 0
    s_add_u32 m0, s38, 0
    s_nop 0
    buffer_load_dwordx4 v114, s[8:11], s28 offen lds
    s_add_u32 m0, s38, 8192
    s_nop 0
    buffer_load_dwordx4 v115, s[8:11], s30 offen lds
    s_add_u32 s28, s28, 8192
    s_add_u32 s30, s30, 256
    s_add_u32 m0, s38, 16384
    s_nop 0
    buffer_load_dwordx4 v114, s[8:11], s28 offen lds
    s_add_u32 m0, s38, 24576
    s_nop 0
    buffer_load_dwordx4 v115, s[8:11], s30 offen lds
    s_add_u32 s28, s28, 8192
    s_add_u32 s30, s30, 256
    s_add_u32 m0, s38, 32768
    s_nop 0
    buffer_load_dwordx4 v114, s[8:11], s28 offen lds
    s_add_u32 m0, s38, 40960
    s_nop 0
    buffer_load_dwordx4 v115, s[8:11], s30 offen lds
    s_add_u32 s28, s28, 8192
    s_add_u32 s30, s30, 256
    s_waitcnt vmcnt(6)
    v_and_b32 v20, v20, v122
    v_and_b32 v21, v21, v122
    v_mov_b32 v22, 0
    v_mov_b32 v23, 0
    s_waitcnt vmcnt(4)
    s_barrier
    ds_read_b128 v[24:27], v104 offset:0
    ds_read_b128 v[28:31], v105 offset:0
    ds_read_b128 v[32:35], v104 offset:2048
    ds_read_b128 v[36:39], v105 offset:2048
    ds_read_b128 v[40:43], v106 offset:0
    ds_read_b128 v[44:47], v107 offset:0
    s_waitcnt lgkmcnt(4)
    v_mfma_f32_32x32x16_bf16 v[56:71], v[24:27], v[16:19], 0
    v_mfma_f32_32x32x16_bf16 v[56:71], v[28:31], v[20:23], v[56:71]
    s_mov_b32 s37, 3
at_loop:
    s_waitcnt lgkmcnt(2)
    v_mfma_f32_32x32x16_bf16 v[72:87], v[32:35], v[16:19], 0
    v_mfma_f32_32x32x16_bf16 v[72:87], v[36:39], v[20:23], v[72:87]
    ds_read_b128 v[24:27], v104 offset:4096
    ds_read_b128 v[28:31], v105 offset:4096
    ds_read_b128 v[48:51], v108 offset:0
    ds_read_b128 v[52:55], v109 offset:0
    v_max3_f32 v116, v56, v57, v58
    v_max3_f32 v119, v59, v60, v61
    v_max3_f32 v116, v116, v62, v63
    v_max3_f32 v119, v119, v64, v65
    v_max3_f32 v116, v116, v66, v67
    v_max3_f32 v119, v119, v68, v69
    v_max3_f32 v116, v116, v70, v71
    v_max_f32 v116, v116, v119
    v_cmp_gt_f32 vcc, v116, v117
    s_cbranch_vccnz at_rescl_0
at_backl_0:
    v_exp_f32 v56, v56
    v_exp_f32 v57, v57
    v_exp_f32 v58, v58
    v_exp_f32 v59, v59
    v_exp_f32 v60, v60
    v_exp_f32 v61, v61
    v_exp_f32 v62, v62
    v_exp_f32 v63, v63
    v_exp_f32 v64, v64
    v_exp_f32 v65, v65
    v_exp_f32 v66, v66
    v_exp_f32 v67, v67
    v_exp_f32 v68, v68
    v_exp_f32 v69, v69
    v_exp_f32 v70, v70
    v_exp_f32 v71, v71
    s_nop 0
    v_cvt_pk_bf16_f32 v56, v56, v57
    v_cvt_pk_bf16_f32 v57, v58, v59
    v_cvt_pk_bf16_f32 v58, v60, v61
    v_cvt_pk_bf16_f32 v59, v62, v63
    v_cvt_pk_bf16_f32 v60, v64, v65
    v_cvt_pk_bf16_f32 v61, v66, v67
    v_cvt_pk_bf16_f32 v62, v68, v69
    v_cvt_pk_bf16_f32 v63, v70, v71
    s_waitcnt lgkmcnt(4)
    s_nop 0
    v_mfma_f32_32x32x16_bf16 v[88:103], v[40:43], v[56:59], v[88:103]
    v_mfma_f32_32x32x16_bf16 v[88:103], v[44:47], v[60:63], v[88:103]
    s_waitcnt lgkmcnt(2)
    v_mfma_f32_32x32x16_bf16 v[56:71], v[24:27], v[16:19], 0
    v_mfma_f32_32x32x16_bf16 v[56:71], v[28:31], v[20:23], v[56:71]
    ds_read_b128 v[32:35], v104 offset:6144
    ds_read_b128 v[36:39], v105 offset:6144
    ds_read_b128 v[40:43], v110 offset:0
    ds_read_b128 v[44:47], v111 offset:0
    v_max3_f32 v116, v72, v73, v74
    v_max3_f32 v119, v75, v76, v77
    v_max3_f32 v116, v116, v78, v79
    v_max3_f32 v119, v119, v80, v81
    v_max3_f32 v116, v116, v82, v83
    v_max3_f32 v119, v119, v84, v85
    v_max3_f32 v116, v116, v86, v87
    v_max_f32 v116, v116, v119
    v_cmp_gt_f32 vcc, v116, v117
    s_cbranch_vccnz at_rescl_1
at_backl_1:
    v_exp_f32 v72, v72
    v_exp_f32 v73, v73
    v_exp_f32 v74, v74
    v_exp_f32 v75, v75
    v_exp_f32 v76, v76
    v_exp_f32 v77, v77
    v_exp_f32 v78, v78
    v_exp_f32 v79, v79
    v_exp_f32 v80, v80
    v_exp_f32 v81, v81
    v_exp_f32 v82, v82
    v_exp_f32 v83, v83
    v_exp_f32 v84, v84
    v_exp_f32 v85, v85
    v_exp_f32 v86, v86
    v_exp_f32 v87, v87
    s_nop 0
    v_cvt_pk_bf16_f32 v72, v72, v73
    v_cvt_pk_bf16_f32 v73, v74, v75
    v_cvt_pk_bf16_f32 v74, v76, v77
    v_cvt_pk_bf16_f32 v75, v78, v79
    v_cvt_pk_bf16_f32 v76, v80, v81
    v_cvt_pk_bf16_f32 v77, v82, v83
    v_cvt_pk_bf16_f32 v78, v84, v85
    v_cvt_pk_bf16_f32 v79, v86, v87
    s_waitcnt lgkmcnt(4)
    s_nop 0
    v_mfma_f32_32x32x16_bf16 v[88:103], v[48:51], v[72:75], v[88:103]
    v_mfma_f32_32x32x16_bf16 v[88:103], v[52:55], v[76:79], v[88:103]
    s_waitcnt vmcnt(2)
    s_barrier
    s_add_u32 m0, s38, 49152
    s_nop 0
    buffer_load_dwordx4 v114, s[8:11], s28 offen lds
    s_add_u32 m0, s38, 57344
    s_nop 0
    buffer_load_dwordx4 v115, s[8:11], s30 offen lds
    s_add_u32 s28, s28, 8192
    s_add_u32 s30, s30, 256
    s_waitcnt lgkmcnt(2)
    v_mfma_f32_32x32x16_bf16 v[72:87], v[32:35], v[16:19], 0
    v_mfma_f32_32x32x16_bf16 v[72:87], v[36:39], v[20:23], v[72:87]
    ds_read_b128 v[24:27], v104 offset:16384
    ds_read_b128 v[28:31], v105 offset:16384
    ds_read_b128 v[48:51], v112 offset:0
    ds_read_b128 v[52:55], v113 offset:0
    v_max3_f32 v116, v56, v57, v58
    v_max3_f32 v119, v59, v60, v61
    v_max3_f32 v116, v116, v62, v63
    v_max3_f32 v119, v119, v64, v65
    v_max3_f32 v116, v116, v66, v67
    v_max3_f32 v119, v119, v68, v69
    v_max3_f32 v116, v116, v70, v71
    v_max_f32 v116, v116, v119
    v_cmp_gt_f32 vcc, v116, v117
    s_cbranch_vccnz at_rescl_2
at_backl_2:
    v_exp_f32 v56, v56
    v_exp_f32 v57, v57
    v_exp_f32 v58, v58
    v_exp_f32 v59, v59
    v_exp_f32 v60, v60
    v_exp_f32 v61, v61
    v_exp_f32 v62, v62
    v_exp_f32 v63, v63
    v_exp_f32 v64, v64
    v_exp_f32 v65, v65
    v_exp_f32 v66, v66
    v_exp_f32 v67, v67
    v_exp_f32 v68, v68
    v_exp_f32 v69, v69
    v_exp_f32 v70, v70
    v_exp_f32 v71, v71
    s_nop 0
    v_cvt_pk_bf16_f32 v56, v56, v57
    v_cvt_pk_bf16_f32 v57, v58, v59
    v_cvt_pk_bf16_f32 v58, v60, v61
    v_cvt_pk_bf16_f32 v59, v62, v63
    v_cvt_pk_bf16_f32 v60, v64, v65
    v_cvt_pk_bf16_f32 v61, v66, v67
    v_cvt_pk_bf16_f32 v62, v68, v69
    v_cvt_pk_bf16_f32 v63, v70, v71
    s_waitcnt lgkmcnt(4)
    s_nop 0
    v_mfma_f32_32x32x16_bf16 v[88:103], v[40:43], v[56:59], v[88:103]
    v_mfma_f32_32x32x16_bf16 v[88:103], v[44:47], v[60:63], v[88:103]
    s_waitcnt lgkmcnt(2)
    v_mfma_f32_32x32x16_bf16 v[56:71], v[24:27], v[16:19], 0
    v_mfma_f32_32x32x16_bf16 v[56:71], v[28:31], v[20:23], v[56:71]
    ds_read_b128 v[32:35], v104 offset:18432
    ds_read_b128 v[36:39], v105 offset:18432
    ds_read_b128 v[40:43], v106 offset:16384
    ds_read_b128 v[44:47], v107 offset:16384
    v_max3_f32 v116, v72, v73, v74
    v_max3_f32 v119, v75, v76, v77
    v_max3_f32 v116, v116, v78, v79
    v_max3_f32 v119, v119, v80, v81
    v_max3_f32 v116, v116, v82, v83
    v_max3_f32 v119, v119, v84, v85
    v_max3_f32 v116, v116, v86, v87
    v_max_f32 v116, v116, v119
    v_cmp_gt_f32 vcc, v116, v117
    s_cbranch_vccnz at_rescl_3
at_backl_3:
    v_exp_f32 v72, v72
    v_exp_f32 v73, v73
    v_exp_f32 v74, v74
    v_exp_f32 v75, v75
    v_exp_f32 v76, v76
    v_exp_f32 v77, v77
    v_exp_f32 v78, v78
    v_exp_f32 v79, v79
    v_exp_f32 v80, v80
    v_exp_f32 v81, v81
    v_exp_f32 v82, v82
    v_exp_f32 v83, v83
    v_exp_f32 v84, v84
    v_exp_f32 v85, v85
    v_exp_f32 v86, v86
    v_exp_f32 v87, v87
    s_nop 0
    v_cvt_pk_bf16_f32 v72, v72, v73
    v_cvt_pk_bf16_f32 v73, v74, v75
    v_cvt_pk_bf16_f32 v74, v76, v77
    v_cvt_pk_bf16_f32 v75, v78, v79
    v_cvt_pk_bf16_f32 v76, v80, v81
    v_cvt_pk_bf16_f32 v77, v82, v83
    v_cvt_pk_bf16_f32 v78, v84, v85
    v_cvt_pk_bf16_f32 v79, v86, v87
    s_waitcnt lgkmcnt(4)
    s_nop 0
    v_mfma_f32_32x32x16_bf16 v[88:103], v[48:51], v[72:75], v[88:103]
    v_mfma_f32_32x32x16_bf16 v[88:103], v[52:55], v[76:79], v[88:103]
    s_waitcnt lgkmcnt(2)
    v_mfma_f32_32x32x16_bf16 v[72:87], v[32:35], v[16:19], 0
    v_mfma_f32_32x32x16_bf16 v[72:87], v[36:39], v[20:23], v[72:87]
    ds_read_b128 v[24:27], v104 offset:20480
    ds_read_b128 v[28:31], v105 offset:20480
    ds_read_b128 v[48:51], v108 offset:16384
    ds_read_b128 v[52:55], v109 offset:16384
    v_max3_f32 v116, v56, v57, v58
    v_max3_f32 v119, v59, v60, v61
    v_max3_f32 v116, v116, v62, v63
    v_max3_f32 v119, v119, v64, v65
    v_max3_f32 v116, v116, v66, v67
    v_max3_f32 v119, v119, v68, v69
    v_max3_f32 v116, v116, v70, v71
    v_max_f32 v116, v116, v119
    v_cmp_gt_f32 vcc, v116, v117
    s_cbranch_vccnz at_rescl_4
at_backl_4:
    v_exp_f32 v56, v56
    v_exp_f32 v57, v57
    v_exp_f32 v58, v58
    v_exp_f32 v59, v59
    v_exp_f32 v60, v60
    v_exp_f32 v61, v61
    v_exp_f32 v62, v62
    v_exp_f32 v63, v63
    v_exp_f32 v64, v64
    v_exp_f32 v65, v65
    v_exp_f32 v66, v66
    v_exp_f32 v67, v67
    v_exp_f32 v68, v68
    v_exp_f32 v69, v69
    v_exp_f32 v70, v70
    v_exp_f32 v71, v71
    s_nop 0
    v_cvt_pk_bf16_f32 v56, v56, v57
    v_cvt_pk_bf16_f32 v57, v58, v59
    v_cvt_pk_bf16_f32 v58, v60, v61
    v_cvt_pk_bf16_f32 v59, v62, v63
    v_cvt_pk_bf16_f32 v60, v64, v65
    v_cvt_pk_bf16_f32 v61, v66, v67
    v_cvt_pk_bf16_f32 v62, v68, v69
    v_cvt_pk_bf16_f32 v63, v70, v71
    s_waitcnt lgkmcnt(4)
    s_nop 0
    v_mfma_f32_32x32x16_bf16 v[88:103], v[40:43], v[56:59], v[88:103]
    v_mfma_f32_32x32x16_bf16 v[88:103], v[44:47], v[60:63], v[88:103]
    s_waitcnt lgkmcnt(2)
    v_mfma_f32_32x32x16_bf16 v[56:71], v[24:27], v[16:19], 0
    v_mfma_f32_32x32x16_bf16 v[56:71], v[28:31], v[20:23], v[56:71]
    ds_read_b128 v[32:35], v104 offset:22528
    ds_read_b128 v[36:39], v105 offset:22528
    ds_read_b128 v[40:43], v110 offset:16384
    ds_read_b128 v[44:47], v111 offset:16384
    v_max3_f32 v116, v72, v73, v74
    v_max3_f32 v119, v75, v76, v77
    v_max3_f32 v116, v116, v78, v79
    v_max3_f32 v119, v119, v80, v81
    v_max3_f32 v116, v116, v82, v83
    v_max3_f32 v119, v119, v84, v85
    v_max3_f32 v116, v116, v86, v87
    v_max_f32 v116, v116, v119
    v_cmp_gt_f32 vcc, v116, v117
    s_cbranch_vccnz at_rescl_5
at_backl_5:
    v_exp_f32 v72, v72
    v_exp_f32 v73, v73
    v_exp_f32 v74, v74
    v_exp_f32 v75, v75
    v_exp_f32 v76, v76
    v_exp_f32 v77, v77
    v_exp_f32 v78, v78
    v_exp_f32 v79, v79
    v_exp_f32 v80, v80
    v_exp_f32 v81, v81
    v_exp_f32 v82, v82
    v_exp_f32 v83, v83
    v_exp_f32 v84, v84
    v_exp_f32 v85, v85
    v_exp_f32 v86, v86
    v_exp_f32 v87, v87
    s_nop 0
    v_cvt_pk_bf16_f32 v72, v72, v73
    v_cvt_pk_bf16_f32 v73, v74, v75
    v_cvt_pk_bf16_f32 v74, v76, v77
    v_cvt_pk_bf16_f32 v75, v78, v79
    v_cvt_pk_bf16_f32 v76, v80, v81
    v_cvt_pk_bf16_f32 v77, v82, v83
    v_cvt_pk_bf16_f32 v78, v84, v85
    v_cvt_pk_bf16_f32 v79, v86, v87
    s_waitcnt lgkmcnt(4)
    s_nop 0
    v_mfma_f32_32x32x16_bf16 v[88:103], v[48:51], v[72:75], v[88:103]
    v_mfma_f32_32x32x16_bf16 v[88:103], v[52:55], v[76:79], v[88:103]
    s_waitcnt vmcnt(2)
    s_barrier
    s_add_u32 m0, s38, 0
    s_nop 0
    buffer_load_dwordx4 v114, s[8:11], s28 offen lds
    s_add_u32 m0, s38, 8192
    s_nop 0
    buffer_load_dwordx4 v115, s[8:11], s30 offen lds
    s_add_u32 s28, s28, 8192
    s_add_u32 s30, s30, 256
    s_waitcnt lgkmcnt(2)
    v_mfma_f32_32x32x16_bf16 v[72:87], v[32:35], v[16:19], 0
    v_mfma_f32_32x32x16_bf16 v[72:87], v[36:39], v[20:23], v[72:87]
    ds_read_b128 v[24:27], v104 offset:32768
    ds_read_b128 v[28:31], v105 offset:32768
    ds_read_b128 v[48:51], v112 offset:16384
    ds_read_b128 v[52:55], v113 offset:16384
    v_max3_f32 v116, v56, v57, v58
    v_max3_f32 v119, v59, v60, v61
    v_max3_f32 v116, v116, v62, v63
    v_max3_f32 v119, v119, v64, v65
    v_max3_f32 v116, v116, v66, v67
    v_max3_f32 v119, v119, v68, v69
    v_max3_f32 v116, v116, v70, v71
    v_max_f32 v116, v116, v119
    v_cmp_gt_f32 vcc, v116, v117
    s_cbranch_vccnz at_rescl_6
at_backl_6:
    v_exp_f32 v56, v56
    v_exp_f32 v57, v57
    v_exp_f32 v58, v58
    v_exp_f32 v59, v59
    v_exp_f32 v60, v60
    v_exp_f32 v61, v61
    v_exp_f32 v62, v62
    v_exp_f32 v63, v63
    v_exp_f32 v64, v64
    v_exp_f32 v65, v65
    v_exp_f32 v66, v66
    v_exp_f32 v67, v67
    v_exp_f32 v68, v68
    v_exp_f32 v69, v69
    v_exp_f32 v70, v70
    v_exp_f32 v71, v71
    s_nop 0
    v_cvt_pk_bf16_f32 v56, v56, v57
    v_cvt_pk_bf16_f32 v57, v58, v59
    v_cvt_pk_bf16_f32 v58, v60, v61
    v_cvt_pk_bf16_f32 v59, v62, v63
    v_cvt_pk_bf16_f32 v60, v64, v65
    v_cvt_pk_bf16_f32 v61, v66, v67
    v_cvt_pk_bf16_f32 v62, v68, v69
    v_cvt_pk_bf16_f32 v63, v70, v71
    s_waitcnt lgkmcnt(4)
    s_nop 0
    v_mfma_f32_32x32x16_bf16 v[88:103], v[40:43], v[56:59], v[88:103]
    v_mfma_f32_32x32x16_bf16 v[88:103], v[44:47], v[60:63], v[88:103]
    s_waitcnt lgkmcnt(2)
    v_mfma_f32_32x32x16_bf16 v[56:71], v[24:27], v[16:19], 0
    v_mfma_f32_32x32x16_bf16 v[56:71], v[28:31], v[20:23], v[56:71]
    ds_read_b128 v[32:35], v104 offset:34816
    ds_read_b128 v[36:39], v105 offset:34816
    ds_read_b128 v[40:43], v106 offset:32768
    ds_read_b128 v[44:47], v107 offset:32768
    v_max3_f32 v116, v72, v73, v74
    v_max3_f32 v119, v75, v76, v77
    v_max3_f32 v116, v116, v78, v79
    v_max3_f32 v119, v119, v80, v81
    v_max3_f32 v116, v116, v82, v83
    v_max3_f32 v119, v119, v84, v85
    v_max3_f32 v116, v116, v86, v87
    v_max_f32 v116, v116, v119
    v_cmp_gt_f32 vcc, v116, v117
    s_cbranch_vccnz at_rescl_7
at_backl_7:
    v_exp_f32 v72, v72
    v_exp_f32 v73, v73
    v_exp_f32 v74, v74
    v_exp_f32 v75, v75
    v_exp_f32 v76, v76
    v_exp_f32 v77, v77
    v_exp_f32 v78, v78
    v_exp_f32 v79, v79
    v_exp_f32 v80, v80
    v_exp_f32 v81, v81
    v_exp_f32 v82, v82
    v_exp_f32 v83, v83
    v_exp_f32 v84, v84
    v_exp_f32 v85, v85
    v_exp_f32 v86, v86
    v_exp_f32 v87, v87
    s_nop 0
    v_cvt_pk_bf16_f32 v72, v72, v73
    v_cvt_pk_bf16_f32 v73, v74, v75
    v_cvt_pk_bf16_f32 v74, v76, v77
    v_cvt_pk_bf16_f32 v75, v78, v79
    v_cvt_pk_bf16_f32 v76, v80, v81
    v_cvt_pk_bf16_f32 v77, v82, v83
    v_cvt_pk_bf16_f32 v78, v84, v85
    v_cvt_pk_bf16_f32 v79, v86, v87
    s_waitcnt lgkmcnt(4)
    s_nop 0
    v_mfma_f32_32x32x16_bf16 v[88:103], v[48:51], v[72:75], v[88:103]
    v_mfma_f32_32x32x16_bf16 v[88:103], v[52:55], v[76:79], v[88:103]
    s_waitcnt lgkmcnt(2)
    v_mfma_f32_32x32x16_bf16 v[72:87], v[32:35], v[16:19], 0
    v_mfma_f32_32x32x16_bf16 v[72:87], v[36:39], v[20:23], v[72:87]
    ds_read_b128 v[24:27], v104 offset:36864
    ds_read_b128 v[28:31], v105 offset:36864
    ds_read_b128 v[48:51], v108 offset:32768
    ds_read_b128 v[52:55], v109 offset:32768
    v_max3_f32 v116, v56, v57, v58
    v_max3_f32 v119, v59, v60, v61
    v_max3_f32 v116, v116, v62, v63
    v_max3_f32 v119, v119, v64, v65
    v_max3_f32 v116, v116, v66, v67
    v_max3_f32 v119, v119, v68, v69
    v_max3_f32 v116, v116, v70, v71
    v_max_f32 v116, v116, v119
    v_cmp_gt_f32 vcc, v116, v117
    s_cbranch_vccnz at_rescl_8
at_backl_8:
    v_exp_f32 v56, v56
    v_exp_f32 v57, v57
    v_exp_f32 v58, v58
    v_exp_f32 v59, v59
    v_exp_f32 v60, v60
    v_exp_f32 v61, v61
    v_exp_f32 v62, v62
    v_exp_f32 v63, v63
    v_exp_f32 v64, v64
    v_exp_f32 v65, v65
    v_exp_f32 v66, v66
    v_exp_f32 v67, v67
    v_exp_f32 v68, v68
    v_exp_f32 v69, v69
    v_exp_f32 v70, v70
    v_exp_f32 v71, v71
    s_nop 0
    v_cvt_pk_bf16_f32 v56, v56, v57
    v_cvt_pk_bf16_f32 v57, v58, v59
    v_cvt_pk_bf16_f32 v58, v60, v61
    v_cvt_pk_bf16_f32 v59, v62, v63
    v_cvt_pk_bf16_f32 v60, v64, v65
    v_cvt_pk_bf16_f32 v61, v66, v67
    v_cvt_pk_bf16_f32 v62, v68, v69
    v_cvt_pk_bf16_f32 v63, v70, v71
    s_waitcnt lgkmcnt(4)
    s_nop 0
    v_mfma_f32_32x32x16_bf16 v[88:103], v[40:43], v[56:59], v[88:103]
    v_mfma_f32_32x32x16_bf16 v[88:103], v[44:47], v[60:63], v[88:103]
    s_waitcnt lgkmcnt(2)
    v_mfma_f32_32x32x16_bf16 v[56:71], v[24:27], v[16:19], 0
    v_mfma_f32_32x32x16_bf16 v[56:71], v[28:31], v[20:23], v[56:71]
    ds_read_b128 v[32:35], v104 offset:38912
    ds_read_b128 v[36:39], v105 offset:38912
    ds_read_b128 v[40:43], v110 offset:32768
    ds_read_b128 v[44:47], v111 offset:32768
    v_max3_f32 v116, v72, v73, v74
    v_max3_f32 v119, v75, v76, v77
    v_max3_f32 v116, v116, v78, v79
    v_max3_f32 v119, v119, v80, v81
    v_max3_f32 v116, v116, v82, v83
    v_max3_f32 v119, v119, v84, v85
    v_max3_f32 v116, v116, v86, v87
    v_max_f32 v116, v116, v119
    v_cmp_gt_f32 vcc, v116, v117
    s_cbranch_vccnz at_rescl_9
at_backl_9:
    v_exp_f32 v72, v72
    v_exp_f32 v73, v73
    v_exp_f32 v74, v74
    v_exp_f32 v75, v75
    v_exp_f32 v76, v76
    v_exp_f32 v77, v77
    v_exp_f32 v78, v78
    v_exp_f32 v79, v79
    v_exp_f32 v80, v80
    v_exp_f32 v81, v81
    v_exp_f32 v82, v82
    v_exp_f32 v83, v83
    v_exp_f32 v84, v84
    v_exp_f32 v85, v85
    v_exp_f32 v86, v86
    v_exp_f32 v87, v87
    s_nop 0
    v_cvt_pk_bf16_f32 v72, v72, v73
    v_cvt_pk_bf16_f32 v73, v74, v75
    v_cvt_pk_bf16_f32 v74, v76, v77
    v_cvt_pk_bf16_f32 v75, v78, v79
    v_cvt_pk_bf16_f32 v76, v80, v81
    v_cvt_pk_bf16_f32 v77, v82, v83
    v_cvt_pk_bf16_f32 v78, v84, v85
    v_cvt_pk_bf16_f32 v79, v86, v87
    s_waitcnt lgkmcnt(4)
    s_nop 0
    v_mfma_f32_32x32x16_bf16 v[88:103], v[48:51], v[72:75], v[88:103]
    v_mfma_f32_32x32x16_bf16 v[88:103], v[52:55], v[76:79], v[88:103]
    s_waitcnt vmcnt(2)
    s_barrier
    s_add_u32 m0, s38, 16384
    s_nop 0
    buffer_load_dwordx4 v114, s[8:11], s28 offen lds
    s_add_u32 m0, s38, 24576
    s_nop 0
    buffer_load_dwordx4 v115, s[8:11], s30 offen lds
    s_add_u32 s28, s28, 8192
    s_add_u32 s30, s30, 256
    s_waitcnt lgkmcnt(2)
    v_mfma_f32_32x32x16_bf16 v[72:87], v[32:35], v[16:19], 0
    v_mfma_f32_32x32x16_bf16 v[72:87], v[36:39], v[20:23], v[72:87]
    ds_read_b128 v[24:27], v104 offset:49152
    ds_read_b128 v[28:31], v105 offset:49152
    ds_read_b128 v[48:51], v112 offset:32768
    ds_read_b128 v[52:55], v113 offset:32768
    v_max3_f32 v116, v56, v57, v58
    v_max3_f32 v119, v59, v60, v61
    v_max3_f32 v116, v116, v62, v63
    v_max3_f32 v119, v119, v64, v65
    v_max3_f32 v116, v116, v66, v67
    v_max3_f32 v119, v119, v68, v69
    v_max3_f32 v116, v116, v70, v71
    v_max_f32 v116, v116, v119
    v_cmp_gt_f32 vcc, v116, v117
    s_cbranch_vccnz at_rescl_10
at_backl_10:
    v_exp_f32 v56, v56
    v_exp_f32 v57, v57
    v_exp_f32 v58, v58
    v_exp_f32 v59, v59
    v_exp_f32 v60, v60
    v_exp_f32 v61, v61
    v_exp_f32 v62, v62
    v_exp_f32 v63, v63
    v_exp_f32 v64, v64
    v_exp_f32 v65, v65
    v_exp_f32 v66, v66
    v_exp_f32 v67, v67
    v_exp_f32 v68, v68
    v_exp_f32 v69, v69
    v_exp_f32 v70, v70
    v_exp_f32 v71, v71
    s_nop 0
    v_cvt_pk_bf16_f32 v56, v56, v57
    v_cvt_pk_bf16_f32 v57, v58, v59
    v_cvt_pk_bf16_f32 v58, v60, v61
    v_cvt_pk_bf16_f32 v59, v62, v63
    v_cvt_pk_bf16_f32 v60, v64, v65
    v_cvt_pk_bf16_f32 v61, v66, v67
    v_cvt_pk_bf16_f32 v62, v68, v69
    v_cvt_pk_bf16_f32 v63, v70, v71
    s_waitcnt lgkmcnt(4)
    s_nop 0
    v_mfma_f32_32x32x16_bf16 v[88:103], v[40:43], v[56:59], v[88:103]
    v_mfma_f32_32x32x16_bf16 v[88:103], v[44:47], v[60:63], v[88:103]
    s_waitcnt lgkmcnt(2)
    v_mfma_f32_32x32x16_bf16 v[56:71], v[24:27], v[16:19], 0
    v_mfma_f32_32x32x16_bf16 v[56:71], v[28:31], v[20:23], v[56:71]
    ds_read_b128 v[32:35], v104 offset:51200
    ds_read_b128 v[36:39], v105 offset:51200
    ds_read_b128 v[40:43], v106 offset:49152
    ds_read_b128 v[44:47], v107 offset:49152
    v_max3_f32 v116, v72, v73, v74
    v_max3_f32 v119, v75, v76, v77
    v_max3_f32 v116, v116, v78, v79
    v_max3_f32 v119, v119, v80, v81
    v_max3_f32 v116, v116, v82, v83
    v_max3_f32 v119, v119, v84, v85
    v_max3_f32 v116, v116, v86, v87
    v_max_f32 v116, v116, v119
    v_cmp_gt_f32 vcc, v116, v117
    s_cbranch_vccnz at_rescl_11
at_backl_11:
    v_exp_f32 v72, v72
    v_exp_f32 v73, v73
    v_exp_f32 v74, v74
    v_exp_f32 v75, v75
    v_exp_f32 v76, v76
    v_exp_f32 v77, v77
    v_exp_f32 v78, v78
    v_exp_f32 v79, v79
    v_exp_f32 v80, v80
    v_exp_f32 v81, v81
    v_exp_f32 v82, v82
    v_exp_f32 v83, v83
    v_exp_f32 v84, v84
    v_exp_f32 v85, v85
    v_exp_f32 v86, v86
    v_exp_f32 v87, v87
    s_nop 0
    v_cvt_pk_bf16_f32 v72, v72, v73
    v_cvt_pk_bf16_f32 v73, v74, v75
    v_cvt_pk_bf16_f32 v74, v76, v77
    v_cvt_pk_bf16_f32 v75, v78, v79
    v_cvt_pk_bf16_f32 v76, v80, v81
    v_cvt_pk_bf16_f32 v77, v82, v83
    v_cvt_pk_bf16_f32 v78, v84, v85
    v_cvt_pk_bf16_f32 v79, v86, v87
    s_waitcnt lgkmcnt(4)
    s_nop 0
    v_mfma_f32_32x32x16_bf16 v[88:103], v[48:51], v[72:75], v[88:103]
    v_mfma_f32_32x32x16_bf16 v[88:103], v[52:55], v[76:79], v[88:103]
    s_waitcnt lgkmcnt(2)
    v_mfma_f32_32x32x16_bf16 v[72:87], v[32:35], v[16:19], 0
    v_mfma_f32_32x32x16_bf16 v[72:87], v[36:39], v[20:23], v[72:87]
    ds_read_b128 v[24:27], v104 offset:53248
    ds_read_b128 v[28:31], v105 offset:53248
    ds_read_b128 v[48:51], v108 offset:49152
    ds_read_b128 v[52:55], v109 offset:49152
    v_max3_f32 v116, v56, v57, v58
    v_max3_f32 v119, v59, v60, v61
    v_max3_f32 v116, v116, v62, v63
    v_max3_f32 v119, v119, v64, v65
    v_max3_f32 v116, v116, v66, v67
    v_max3_f32 v119, v119, v68, v69
    v_max3_f32 v116, v116, v70, v71
    v_max_f32 v116, v116, v119
    v_cmp_gt_f32 vcc, v116, v117
    s_cbranch_vccnz at_rescl_12
at_backl_12:
    v_exp_f32 v56, v56
    v_exp_f32 v57, v57
    v_exp_f32 v58, v58
    v_exp_f32 v59, v59
    v_exp_f32 v60, v60
    v_exp_f32 v61, v61
    v_exp_f32 v62, v62
    v_exp_f32 v63, v63
    v_exp_f32 v64, v64
    v_exp_f32 v65, v65
    v_exp_f32 v66, v66
    v_exp_f32 v67, v67
    v_exp_f32 v68, v68
    v_exp_f32 v69, v69
    v_exp_f32 v70, v70
    v_exp_f32 v71, v71
    s_nop 0
    v_cvt_pk_bf16_f32 v56, v56, v57
    v_cvt_pk_bf16_f32 v57, v58, v59
    v_cvt_pk_bf16_f32 v58, v60, v61
    v_cvt_pk_bf16_f32 v59, v62, v63
    v_cvt_pk_bf16_f32 v60, v64, v65
    v_cvt_pk_bf16_f32 v61, v66, v67
    v_cvt_pk_bf16_f32 v62, v68, v69
    v_cvt_pk_bf16_f32 v63, v70, v71
    s_waitcnt lgkmcnt(4)
    s_nop 0
    v_mfma_f32_32x32x16_bf16 v[88:103], v[40:43], v[56:59], v[88:103]
    v_mfma_f32_32x32x16_bf16 v[88:103], v[44:47], v[60:63], v[88:103]
    s_waitcnt lgkmcnt(2)
    v_mfma_f32_32x32x16_bf16 v[56:71], v[24:27], v[16:19], 0
    v_mfma_f32_32x32x16_bf16 v[56:71], v[28:31], v[20:23], v[56:71]
    ds_read_b128 v[32:35], v104 offset:55296
    ds_read_b128 v[36:39], v105 offset:55296
    ds_read_b128 v[40:43], v110 offset:49152
    ds_read_b128 v[44:47], v111 offset:49152
    v_max3_f32 v116, v72, v73, v74
    v_max3_f32 v119, v75, v76, v77
    v_max3_f32 v116, v116, v78, v79
    v_max3_f32 v119, v119, v80, v81
    v_max3_f32 v116, v116, v82, v83
    v_max3_f32 v119, v119, v84, v85
    v_max3_f32 v116, v116, v86, v87
    v_max_f32 v116, v116, v119
    v_cmp_gt_f32 vcc, v116, v117
    s_cbranch_vccnz at_rescl_13
at_backl_13:
    v_exp_f32 v72, v72
    v_exp_f32 v73, v73
    v_exp_f32 v74, v74
    v_exp_f32 v75, v75
    v_exp_f32 v76, v76
    v_exp_f32 v77, v77
    v_exp_f32 v78, v78
    v_exp_f32 v79, v79
    v_exp_f32 v80, v80
    v_exp_f32 v81, v81
    v_exp_f32 v82, v82
    v_exp_f32 v83, v83
    v_exp_f32 v84, v84
    v_exp_f32 v85, v85
    v_exp_f32 v86, v86
    v_exp_f32 v87, v87
    s_nop 0
    v_cvt_pk_bf16_f32 v72, v72, v73
    v_cvt_pk_bf16_f32 v73, v74, v75
    v_cvt_pk_bf16_f32 v74, v76, v77
    v_cvt_pk_bf16_f32 v75, v78, v79
    v_cvt_pk_bf16_f32 v76, v80, v81
    v_cvt_pk_bf16_f32 v77, v82, v83
    v_cvt_pk_bf16_f32 v78, v84, v85
    v_cvt_pk_bf16_f32 v79, v86, v87
    s_waitcnt lgkmcnt(4)
    s_nop 0
    v_mfma_f32_32x32x16_bf16 v[88:103], v[48:51], v[72:75], v[88:103]
    v_mfma_f32_32x32x16_bf16 v[88:103], v[52:55], v[76:79], v[88:103]
    s_waitcnt vmcnt(2)
    s_barrier
    s_add_u32 m0, s38, 32768
    s_nop 0
    buffer_load_dwordx4 v114, s[8:11], s28 offen lds
    s_add_u32 m0, s38, 40960
    s_nop 0
    buffer_load_dwordx4 v115, s[8:11], s30 offen lds
    s_add_u32 s28, s28, 8192
    s_add_u32 s30, s30, 256
    s_waitcnt lgkmcnt(2)
    v_mfma_f32_32x32x16_bf16 v[72:87], v[32:35], v[16:19], 0
    v_mfma_f32_32x32x16_bf16 v[72:87], v[36:39], v[20:23], v[72:87]
    ds_read_b128 v[24:27], v104 offset:0
    ds_read_b128 v[28:31], v105 offset:0
    ds_read_b128 v[48:51], v112 offset:49152
    ds_read_b128 v[52:55], v113 offset:49152
    v_max3_f32 v116, v56, v57, v58
    v_max3_f32 v119, v59, v60, v61
    v_max3_f32 v116, v116, v62, v63
    v_max3_f32 v119, v119, v64, v65
    v_max3_f32 v116, v116, v66, v67
    v_max3_f32 v119, v119, v68, v69
    v_max3_f32 v116, v116, v70, v71
    v_max_f32 v116, v116, v119
    v_cmp_gt_f32 vcc, v116, v117
    s_cbranch_vccnz at_rescl_14
at_backl_14:
    v_exp_f32 v56, v56
    v_exp_f32 v57, v57
    v_exp_f32 v58, v58
    v_exp_f32 v59, v59
    v_exp_f32 v60, v60
    v_exp_f32 v61, v61
    v_exp_f32 v62, v62
    v_exp_f32 v63, v63
    v_exp_f32 v64, v64
    v_exp_f32 v65, v65
    v_exp_f32 v66, v66
    v_exp_f32 v67, v67
    v_exp_f32 v68, v68
    v_exp_f32 v69, v69
    v_exp_f32 v70, v70
    v_exp_f32 v71, v71
    s_nop 0
    v_cvt_pk_bf16_f32 v56, v56, v57
    v_cvt_pk_bf16_f32 v57, v58, v59
    v_cvt_pk_bf16_f32 v58, v60, v61
    v_cvt_pk_bf16_f32 v59, v62, v63
    v_cvt_pk_bf16_f32 v60, v64, v65
    v_cvt_pk_bf16_f32 v61, v66, v67
    v_cvt_pk_bf16_f32 v62, v68, v69
    v_cvt_pk_bf16_f32 v63, v70, v71
    s_waitcnt lgkmcnt(4)
    s_nop 0
    v_mfma_f32_32x32x16_bf16 v[88:103], v[40:43], v[56:59], v[88:103]
    v_mfma_f32_32x32x16_bf16 v[88:103], v[44:47], v[60:63], v[88:103]
    s_waitcnt lgkmcnt(2)
    v_mfma_f32_32x32x16_bf16 v[56:71], v[24:27], v[16:19], 0
    v_mfma_f32_32x32x16_bf16 v[56:71], v[28:31], v[20:23], v[56:71]
    ds_read_b128 v[32:35], v104 offset:2048
    ds_read_b128 v[36:39], v105 offset:2048
    ds_read_b128 v[40:43], v106 offset:0
    ds_read_b128 v[44:47], v107 offset:0
    v_max3_f32 v116, v72, v73, v74
    v_max3_f32 v119, v75, v76, v77
    v_max3_f32 v116, v116, v78, v79
    v_max3_f32 v119, v119, v80, v81
    v_max3_f32 v116, v116, v82, v83
    v_max3_f32 v119, v119, v84, v85
    v_max3_f32 v116, v116, v86, v87
    v_max_f32 v116, v116, v119
    v_cmp_gt_f32 vcc, v116, v117
    s_cbranch_vccnz at_rescl_15
at_backl_15:
    v_exp_f32 v72, v72
    v_exp_f32 v73, v73
    v_exp_f32 v74, v74
    v_exp_f32 v75, v75
    v_exp_f32 v76, v76
    v_exp_f32 v77, v77
    v_exp_f32 v78, v78
    v_exp_f32 v79, v79
    v_exp_f32 v80, v80
    v_exp_f32 v81, v81
    v_exp_f32 v82, v82
    v_exp_f32 v83, v83
    v_exp_f32 v84, v84
    v_exp_f32 v85, v85
    v_exp_f32 v86, v86
    v_exp_f32 v87, v87
    s_nop 0
    v_cvt_pk_bf16_f32 v72, v72, v73
    v_cvt_pk_bf16_f32 v73, v74, v75
    v_cvt_pk_bf16_f32 v74, v76, v77
    v_cvt_pk_bf16_f32 v75, v78, v79
    v_cvt_pk_bf16_f32 v76, v80, v81
    v_cvt_pk_bf16_f32 v77, v82, v83
    v_cvt_pk_bf16_f32 v78, v84, v85
    v_cvt_pk_bf16_f32 v79, v86, v87
    s_waitcnt lgkmcnt(4)
    s_nop 0
    v_mfma_f32_32x32x16_bf16 v[88:103], v[48:51], v[72:75], v[88:103]
    v_mfma_f32_32x32x16_bf16 v[88:103], v[52:55], v[76:79], v[88:103]
    s_sub_u32 s37, s37, 1
    s_cmp_lg_u32 s37, 0
    s_cbranch_scc1 at_loop
    s_waitcnt lgkmcnt(2)
    v_mfma_f32_32x32x16_bf16 v[72:87], v[32:35], v[16:19], 0
    v_mfma_f32_32x32x16_bf16 v[72:87], v[36:39], v[20:23], v[72:87]
    ds_read_b128 v[24:27], v104 offset:4096
    ds_read_b128 v[28:31], v105 offset:4096
    ds_read_b128 v[48:51], v108 offset:0
    ds_read_b128 v[52:55], v109 offset:0
    v_max3_f32 v116, v56, v57, v58
    v_max3_f32 v119, v59, v60, v61
    v_max3_f32 v116, v116, v62, v63
    v_max3_f32 v119, v119, v64, v65
    v_max3_f32 v116, v116, v66, v67
    v_max3_f32 v119, v119, v68, v69
    v_max3_f32 v116, v116, v70, v71
    v_max_f32 v116, v116, v119
    v_cmp_gt_f32 vcc, v116, v117
    s_cbranch_vccnz at_rescf_0
at_backf_0:
    v_exp_f32 v56, v56
    v_exp_f32 v57, v57
    v_exp_f32 v58, v58
    v_exp_f32 v59, v59
    v_exp_f32 v60, v60
    v_exp_f32 v61, v61
    v_exp_f32 v62, v62
    v_exp_f32 v63, v63
    v_exp_f32 v64, v64
    v_exp_f32 v65, v65
    v_exp_f32 v66, v66
    v_exp_f32 v67, v67
    v_exp_f32 v68, v68
    v_exp_f32 v69, v69
    v_exp_f32 v70, v70
    v_exp_f32 v71, v71
    s_nop 0
    v_cvt_pk_bf16_f32 v56, v56, v57
    v_cvt_pk_bf16_f32 v57, v58, v59
    v_cvt_pk_bf16_f32 v58, v60, v61
    v_cvt_pk_bf16_f32 v59, v62, v63
    v_cvt_pk_bf16_f32 v60, v64, v65
    v_cvt_pk_bf16_f32 v61, v66, v67
    v_cvt_pk_bf16_f32 v62, v68, v69
    v_cvt_pk_bf16_f32 v63, v70, v71
    s_waitcnt lgkmcnt(4)
    s_nop 0
    v_mfma_f32_32x32x16_bf16 v[88:103], v[40:43], v[56:59], v[88:103]
    v_mfma_f32_32x32x16_bf16 v[88:103], v[44:47], v[60:63], v[88:103]
    s_waitcnt lgkmcnt(2)
    v_mfma_f32_32x32x16_bf16 v[56:71], v[24:27], v[16:19], 0
    v_mfma_f32_32x32x16_bf16 v[56:71], v[28:31], v[20:23], v[56:71]
    ds_read_b128 v[32:35], v104 offset:6144
    ds_read_b128 v[36:39], v105 offset:6144
    ds_read_b128 v[40:43], v110 offset:0
    ds_read_b128 v[44:47], v111 offset:0
    v_max3_f32 v116, v72, v73, v74
    v_max3_f32 v119, v75, v76, v77
    v_max3_f32 v116, v116, v78, v79
    v_max3_f32 v119, v119, v80, v81
    v_max3_f32 v116, v116, v82, v83
    v_max3_f32 v119, v119, v84, v85
    v_max3_f32 v116, v116, v86, v87
    v_max_f32 v116, v116, v119
    v_cmp_gt_f32 vcc, v116, v117
    s_cbranch_vccnz at_rescf_1
at_backf_1:
    v_exp_f32 v72, v72
    v_exp_f32 v73, v73
    v_exp_f32 v74, v74
    v_exp_f32 v75, v75
    v_exp_f32 v76, v76
    v_exp_f32 v77, v77
    v_exp_f32 v78, v78
    v_exp_f32 v79, v79
    v_exp_f32 v80, v80
    v_exp_f32 v81, v81
    v_exp_f32 v82, v82
    v_exp_f32 v83, v83
    v_exp_f32 v84, v84
    v_exp_f32 v85, v85
    v_exp_f32 v86, v86
    v_exp_f32 v87, v87
    s_nop 0
    v_cvt_pk_bf16_f32 v72, v72, v73
    v_cvt_pk_bf16_f32 v73, v74, v75
    v_cvt_pk_bf16_f32 v74, v76, v77
    v_cvt_pk_bf16_f32 v75, v78, v79
    v_cvt_pk_bf16_f32 v76, v80, v81
    v_cvt_pk_bf16_f32 v77, v82, v83
    v_cvt_pk_bf16_f32 v78, v84, v85
    v_cvt_pk_bf16_f32 v79, v86, v87
    s_waitcnt lgkmcnt(4)
    s_nop 0
    v_mfma_f32_32x32x16_bf16 v[88:103], v[48:51], v[72:75], v[88:103]
    v_mfma_f32_32x32x16_bf16 v[88:103], v[52:55], v[76:79], v[88:103]
    s_waitcnt vmcnt(2)
    s_barrier
    s_add_u32 m0, s38, 49152
    s_nop 0
    buffer_load_dwordx4 v114, s[8:11], s28 offen lds
    s_add_u32 m0, s38, 57344
    s_nop 0
    buffer_load_dwordx4 v115, s[8:11], s30 offen lds
    s_add_u32 s28, s28, 8192
    s_add_u32 s30, s30, 256
    s_waitcnt lgkmcnt(2)
    v_mfma_f32_32x32x16_bf16 v[72:87], v[32:35], v[16:19], 0
    v_mfma_f32_32x32x16_bf16 v[72:87], v[36:39], v[20:23], v[72:87]
    ds_read_b128 v[24:27], v104 offset:16384
    ds_read_b128 v[28:31], v105 offset:16384
    ds_read_b128 v[48:51], v112 offset:0
    ds_read_b128 v[52:55], v113 offset:0
    v_max3_f32 v116, v56, v57, v58
    v_max3_f32 v119, v59, v60, v61
    v_max3_f32 v116, v116, v62, v63
    v_max3_f32 v119, v119, v64, v65
    v_max3_f32 v116, v116, v66, v67
    v_max3_f32 v119, v119, v68, v69
    v_max3_f32 v116, v116, v70, v71
    v_max_f32 v116, v116, v119
    v_cmp_gt_f32 vcc, v116, v117
    s_cbranch_vccnz at_rescf_2
at_backf_2:
    v_exp_f32 v56, v56
    v_exp_f32 v57, v57
    v_exp_f32 v58, v58
    v_exp_f32 v59, v59
    v_exp_f32 v60, v60
    v_exp_f32 v61, v61
    v_exp_f32 v62, v62
    v_exp_f32 v63, v63
    v_exp_f32 v64, v64
    v_exp_f32 v65, v65
    v_exp_f32 v66, v66
    v_exp_f32 v67, v67
    v_exp_f32 v68, v68
    v_exp_f32 v69, v69
    v_exp_f32 v70, v70
    v_exp_f32 v71, v71
    s_nop 0
    v_cvt_pk_bf16_f32 v56, v56, v57
    v_cvt_pk_bf16_f32 v57, v58, v59
    v_cvt_pk_bf16_f32 v58, v60, v61
    v_cvt_pk_bf16_f32 v59, v62, v63
    v_cvt_pk_bf16_f32 v60, v64, v65
    v_cvt_pk_bf16_f32 v61, v66, v67
    v_cvt_pk_bf16_f32 v62, v68, v69
    v_cvt_pk_bf16_f32 v63, v70, v71
    s_waitcnt lgkmcnt(4)
    s_nop 0
    v_mfma_f32_32x32x16_bf16 v[88:103], v[40:43], v[56:59], v[88:103]
    v_mfma_f32_32x32x16_bf16 v[88:103], v[44:47], v[60:63], v[88:103]
    s_waitcnt lgkmcnt(2)
    v_mfma_f32_32x32x16_bf16 v[56:71], v[24:27], v[16:19], 0
    v_mfma_f32_32x32x16_bf16 v[56:71], v[28:31], v[20:23], v[56:71]
    ds_read_b128 v[32:35], v104 offset:18432
    ds_read_b128 v[36:39], v105 offset:18432
    ds_read_b128 v[40:43], v106 offset:16384
    ds_read_b128 v[44:47], v107 offset:16384
    v_max3_f32 v116, v72, v73, v74
    v_max3_f32 v119, v75, v76, v77
    v_max3_f32 v116, v116, v78, v79
    v_max3_f32 v119, v119, v80, v81
    v_max3_f32 v116, v116, v82, v83
    v_max3_f32 v119, v119, v84, v85
    v_max3_f32 v116, v116, v86, v87
    v_max_f32 v116, v116, v119
    v_cmp_gt_f32 vcc, v116, v117
    s_cbranch_vccnz at_rescf_3
at_backf_3:
    v_exp_f32 v72, v72
    v_exp_f32 v73, v73
    v_exp_f32 v74, v74
    v_exp_f32 v75, v75
    v_exp_f32 v76, v76
    v_exp_f32 v77, v77
    v_exp_f32 v78, v78
    v_exp_f32 v79, v79
    v_exp_f32 v80, v80
    v_exp_f32 v81, v81
    v_exp_f32 v82, v82
    v_exp_f32 v83, v83
    v_exp_f32 v84, v84
    v_exp_f32 v85, v85
    v_exp_f32 v86, v86
    v_exp_f32 v87, v87
    s_nop 0
    v_cvt_pk_bf16_f32 v72, v72, v73
    v_cvt_pk_bf16_f32 v73, v74, v75
    v_cvt_pk_bf16_f32 v74, v76, v77
    v_cvt_pk_bf16_f32 v75, v78, v79
    v_cvt_pk_bf16_f32 v76, v80, v81
    v_cvt_pk_bf16_f32 v77, v82, v83
    v_cvt_pk_bf16_f32 v78, v84, v85
    v_cvt_pk_bf16_f32 v79, v86, v87
    s_waitcnt lgkmcnt(4)
    s_nop 0
    v_mfma_f32_32x32x16_bf16 v[88:103], v[48:51], v[72:75], v[88:103]
    v_mfma_f32_32x32x16_bf16 v[88:103], v[52:55], v[76:79], v[88:103]
    s_waitcnt lgkmcnt(2)
    v_mfma_f32_32x32x16_bf16 v[72:87], v[32:35], v[16:19], 0
    v_mfma_f32_32x32x16_bf16 v[72:87], v[36:39], v[20:23], v[72:87]
    ds_read_b128 v[24:27], v104 offset:20480
    ds_read_b128 v[28:31], v105 offset:20480
    ds_read_b128 v[48:51], v108 offset:16384
    ds_read_b128 v[52:55], v109 offset:16384
    v_max3_f32 v116, v56, v57, v58
    v_max3_f32 v119, v59, v60, v61
    v_max3_f32 v116, v116, v62, v63
    v_max3_f32 v119, v119, v64, v65
    v_max3_f32 v116, v116, v66, v67
    v_max3_f32 v119, v119, v68, v69
    v_max3_f32 v116, v116, v70, v71
    v_max_f32 v116, v116, v119
    v_cmp_gt_f32 vcc, v116, v117
    s_cbranch_vccnz at_rescf_4
at_backf_4:
    v_exp_f32 v56, v56
    v_exp_f32 v57, v57
    v_exp_f32 v58, v58
    v_exp_f32 v59, v59
    v_exp_f32 v60, v60
    v_exp_f32 v61, v61
    v_exp_f32 v62, v62
    v_exp_f32 v63, v63
    v_exp_f32 v64, v64
    v_exp_f32 v65, v65
    v_exp_f32 v66, v66
    v_exp_f32 v67, v67
    v_exp_f32 v68, v68
    v_exp_f32 v69, v69
    v_exp_f32 v70, v70
    v_exp_f32 v71, v71
    s_nop 0
    v_cvt_pk_bf16_f32 v56, v56, v57
    v_cvt_pk_bf16_f32 v57, v58, v59
    v_cvt_pk_bf16_f32 v58, v60, v61
    v_cvt_pk_bf16_f32 v59, v62, v63
    v_cvt_pk_bf16_f32 v60, v64, v65
    v_cvt_pk_bf16_f32 v61, v66, v67
    v_cvt_pk_bf16_f32 v62, v68, v69
    v_cvt_pk_bf16_f32 v63, v70, v71
    s_waitcnt lgkmcnt(4)
    s_nop 0
    v_mfma_f32_32x32x16_bf16 v[88:103], v[40:43], v[56:59], v[88:103]
    v_mfma_f32_32x32x16_bf16 v[88:103], v[44:47], v[60:63], v[88:103]
    s_waitcnt lgkmcnt(2)
    v_mfma_f32_32x32x16_bf16 v[56:71], v[24:27], v[16:19], 0
    v_mfma_f32_32x32x16_bf16 v[56:71], v[28:31], v[20:23], v[56:71]
    ds_read_b128 v[32:35], v104 offset:22528
    ds_read_b128 v[36:39], v105 offset:22528
    ds_read_b128 v[40:43], v110 offset:16384
    ds_read_b128 v[44:47], v111 offset:16384
    v_max3_f32 v116, v72, v73, v74
    v_max3_f32 v119, v75, v76, v77
    v_max3_f32 v116, v116, v78, v79
    v_max3_f32 v119, v119, v80, v81
    v_max3_f32 v116, v116, v82, v83
    v_max3_f32 v119, v119, v84, v85
    v_max3_f32 v116, v116, v86, v87
    v_max_f32 v116, v116, v119
    v_cmp_gt_f32 vcc, v116, v117
    s_cbranch_vccnz at_rescf_5
at_backf_5:
    v_exp_f32 v72, v72
    v_exp_f32 v73, v73
    v_exp_f32 v74, v74
    v_exp_f32 v75, v75
    v_exp_f32 v76, v76
    v_exp_f32 v77, v77
    v_exp_f32 v78, v78
    v_exp_f32 v79, v79
    v_exp_f32 v80, v80
    v_exp_f32 v81, v81
    v_exp_f32 v82, v82
    v_exp_f32 v83, v83
    v_exp_f32 v84, v84
    v_exp_f32 v85, v85
    v_exp_f32 v86, v86
    v_exp_f32 v87, v87
    s_nop 0
    v_cvt_pk_bf16_f32 v72, v72, v73
    v_cvt_pk_bf16_f32 v73, v74, v75
    v_cvt_pk_bf16_f32 v74, v76, v77
    v_cvt_pk_bf16_f32 v75, v78, v79
    v_cvt_pk_bf16_f32 v76, v80, v81
    v_cvt_pk_bf16_f32 v77, v82, v83
    v_cvt_pk_bf16_f32 v78, v84, v85
    v_cvt_pk_bf16_f32 v79, v86, v87
    s_waitcnt lgkmcnt(4)
    s_nop 0
    v_mfma_f32_32x32x16_bf16 v[88:103], v[48:51], v[72:75], v[88:103]
    v_mfma_f32_32x32x16_bf16 v[88:103], v[52:55], v[76:79], v[88:103]
    s_waitcnt vmcnt(2)
    s_barrier
    s_waitcnt lgkmcnt(2)
    v_mfma_f32_32x32x16_bf16 v[72:87], v[32:35], v[16:19], 0
    v_mfma_f32_32x32x16_bf16 v[72:87], v[36:39], v[20:23], v[72:87]
    ds_read_b128 v[24:27], v104 offset:32768
    ds_read_b128 v[28:31], v105 offset:32768
    ds_read_b128 v[48:51], v112 offset:16384
    ds_read_b128 v[52:55], v113 offset:16384
    v_max3_f32 v116, v56, v57, v58
    v_max3_f32 v119, v59, v60, v61
    v_max3_f32 v116, v116, v62, v63
    v_max3_f32 v119, v119, v64, v65
    v_max3_f32 v116, v116, v66, v67
    v_max3_f32 v119, v119, v68, v69
    v_max3_f32 v116, v116, v70, v71
    v_max_f32 v116, v116, v119
    v_cmp_gt_f32 vcc, v116, v117
    s_cbranch_vccnz at_rescf_6
at_backf_6:
    v_exp_f32 v56, v56
    v_exp_f32 v57, v57
    v_exp_f32 v58, v58
    v_exp_f32 v59, v59
    v_exp_f32 v60, v60
    v_exp_f32 v61, v61
    v_exp_f32 v62, v62
    v_exp_f32 v63, v63
    v_exp_f32 v64, v64
    v_exp_f32 v65, v65
    v_exp_f32 v66, v66
    v_exp_f32 v67, v67
    v_exp_f32 v68, v68
    v_exp_f32 v69, v69
    v_exp_f32 v70, v70
    v_exp_f32 v71, v71
    s_nop 0
    v_cvt_pk_bf16_f32 v56, v56, v57
    v_cvt_pk_bf16_f32 v57, v58, v59
    v_cvt_pk_bf16_f32 v58, v60, v61
    v_cvt_pk_bf16_f32 v59, v62, v63
    v_cvt_pk_bf16_f32 v60, v64, v65
    v_cvt_pk_bf16_f32 v61, v66, v67
    v_cvt_pk_bf16_f32 v62, v68, v69
    v_cvt_pk_bf16_f32 v63, v70, v71
    s_waitcnt lgkmcnt(4)
    s_nop 0
    v_mfma_f32_32x32x16_bf16 v[88:103], v[40:43], v[56:59], v[88:103]
    v_mfma_f32_32x32x16_bf16 v[88:103], v[44:47], v[60:63], v[88:103]
    s_waitcnt lgkmcnt(2)
    v_mfma_f32_32x32x16_bf16 v[56:71], v[24:27], v[16:19], 0
    v_mfma_f32_32x32x16_bf16 v[56:71], v[28:31], v[20:23], v[56:71]
    ds_read_b128 v[32:35], v104 offset:34816
    ds_read_b128 v[36:39], v105 offset:34816
    ds_read_b128 v[40:43], v106 offset:32768
    ds_read_b128 v[44:47], v107 offset:32768
    v_max3_f32 v116, v72, v73, v74
    v_max3_f32 v119, v75, v76, v77
    v_max3_f32 v116, v116, v78, v79
    v_max3_f32 v119, v119, v80, v81
    v_max3_f32 v116, v116, v82, v83
    v_max3_f32 v119, v119, v84, v85
    v_max3_f32 v116, v116, v86, v87
    v_max_f32 v116, v116, v119
    v_cmp_gt_f32 vcc, v116, v117
    s_cbranch_vccnz at_rescf_7
at_backf_7:
    v_exp_f32 v72, v72
    v_exp_f32 v73, v73
    v_exp_f32 v74, v74
    v_exp_f32 v75, v75
    v_exp_f32 v76, v76
    v_exp_f32 v77, v77
    v_exp_f32 v78, v78
    v_exp_f32 v79, v79
    v_exp_f32 v80, v80
    v_exp_f32 v81, v81
    v_exp_f32 v82, v82
    v_exp_f32 v83, v83
    v_exp_f32 v84, v84
    v_exp_f32 v85, v85
    v_exp_f32 v86, v86
    v_exp_f32 v87, v87
    s_nop 0
    v_cvt_pk_bf16_f32 v72, v72, v73
    v_cvt_pk_bf16_f32 v73, v74, v75
    v_cvt_pk_bf16_f32 v74, v76, v77
    v_cvt_pk_bf16_f32 v75, v78, v79
    v_cvt_pk_bf16_f32 v76, v80, v81
    v_cvt_pk_bf16_f32 v77, v82, v83
    v_cvt_pk_bf16_f32 v78, v84, v85
    v_cvt_pk_bf16_f32 v79, v86, v87
    s_waitcnt lgkmcnt(4)
    s_nop 0
    v_mfma_f32_32x32x16_bf16 v[88:103], v[48:51], v[72:75], v[88:103]
    v_mfma_f32_32x32x16_bf16 v[88:103], v[52:55], v[76:79], v[88:103]
    s_waitcnt lgkmcnt(2)
    v_mfma_f32_32x32x16_bf16 v[72:87], v[32:35], v[16:19], 0
    v_mfma_f32_32x32x16_bf16 v[72:87], v[36:39], v[20:23], v[72:87]
    ds_read_b128 v[24:27], v104 offset:36864
    ds_read_b128 v[28:31], v105 offset:36864
    ds_read_b128 v[48:51], v108 offset:32768
    ds_read_b128 v[52:55], v109 offset:32768
    v_max3_f32 v116, v56, v57, v58
    v_max3_f32 v119, v59, v60, v61
    v_max3_f32 v116, v116, v62, v63
    v_max3_f32 v119, v119, v64, v65
    v_max3_f32 v116, v116, v66, v67
    v_max3_f32 v119, v119, v68, v69
    v_max3_f32 v116, v116, v70, v71
    v_max_f32 v116, v116, v119
    v_cmp_gt_f32 vcc, v116, v117
    s_cbranch_vccnz at_rescf_8
at_backf_8:
    v_exp_f32 v56, v56
    v_exp_f32 v57, v57
    v_exp_f32 v58, v58
    v_exp_f32 v59, v59
    v_exp_f32 v60, v60
    v_exp_f32 v61, v61
    v_exp_f32 v62, v62
    v_exp_f32 v63, v63
    v_exp_f32 v64, v64
    v_exp_f32 v65, v65
    v_exp_f32 v66, v66
    v_exp_f32 v67, v67
    v_exp_f32 v68, v68
    v_exp_f32 v69, v69
    v_exp_f32 v70, v70
    v_exp_f32 v71, v71
    s_nop 0
    v_cvt_pk_bf16_f32 v56, v56, v57
    v_cvt_pk_bf16_f32 v57, v58, v59
    v_cvt_pk_bf16_f32 v58, v60, v61
    v_cvt_pk_bf16_f32 v59, v62, v63
    v_cvt_pk_bf16_f32 v60, v64, v65
    v_cvt_pk_bf16_f32 v61, v66, v67
    v_cvt_pk_bf16_f32 v62, v68, v69
    v_cvt_pk_bf16_f32 v63, v70, v71
    s_waitcnt lgkmcnt(4)
    s_nop 0
    v_mfma_f32_32x32x16_bf16 v[88:103], v[40:43], v[56:59], v[88:103]
    v_mfma_f32_32x32x16_bf16 v[88:103], v[44:47], v[60:63], v[88:103]
    s_waitcnt lgkmcnt(2)
    v_mfma_f32_32x32x16_bf16 v[56:71], v[24:27], v[16:19], 0
    v_mfma_f32_32x32x16_bf16 v[56:71], v[28:31], v[20:23], v[56:71]
    ds_read_b128 v[32:35], v104 offset:38912
    ds_read_b128 v[36:39], v105 offset:38912
    ds_read_b128 v[40:43], v110 offset:32768
    ds_read_b128 v[44:47], v111 offset:32768
    v_max3_f32 v116, v72, v73, v74
    v_max3_f32 v119, v75, v76, v77
    v_max3_f32 v116, v116, v78, v79
    v_max3_f32 v119, v119, v80, v81
    v_max3_f32 v116, v116, v82, v83
    v_max3_f32 v119, v119, v84, v85
    v_max3_f32 v116, v116, v86, v87
    v_max_f32 v116, v116, v119
    v_cmp_gt_f32 vcc, v116, v117
    s_cbranch_vccnz at_rescf_9
at_backf_9:
    v_exp_f32 v72, v72
    v_exp_f32 v73, v73
    v_exp_f32 v74, v74
    v_exp_f32 v75, v75
    v_exp_f32 v76, v76
    v_exp_f32 v77, v77
    v_exp_f32 v78, v78
    v_exp_f32 v79, v79
    v_exp_f32 v80, v80
    v_exp_f32 v81, v81
    v_exp_f32 v82, v82
    v_exp_f32 v83, v83
    v_exp_f32 v84, v84
    v_exp_f32 v85, v85
    v_exp_f32 v86, v86
    v_exp_f32 v87, v87
    s_nop 0
    v_cvt_pk_bf16_f32 v72, v72, v73
    v_cvt_pk_bf16_f32 v73, v74, v75
    v_cvt_pk_bf16_f32 v74, v76, v77
    v_cvt_pk_bf16_f32 v75, v78, v79
    v_cvt_pk_bf16_f32 v76, v80, v81
    v_cvt_pk_bf16_f32 v77, v82, v83
    v_cvt_pk_bf16_f32 v78, v84, v85
    v_cvt_pk_bf16_f32 v79, v86, v87
    s_waitcnt lgkmcnt(4)
    s_nop 0
    v_mfma_f32_32x32x16_bf16 v[88:103], v[48:51], v[72:75], v[88:103]
    v_mfma_f32_32x32x16_bf16 v[88:103], v[52:55], v[76:79], v[88:103]
    s_waitcnt vmcnt(0)
    s_barrier
    s_waitcnt lgkmcnt(2)
    v_mfma_f32_32x32x16_bf16 v[72:87], v[32:35], v[16:19], 0
    v_mfma_f32_32x32x16_bf16 v[72:87], v[36:39], v[20:23], v[72:87]
    ds_read_b128 v[24:27], v104 offset:49152
    ds_read_b128 v[28:31], v105 offset:49152
    ds_read_b128 v[48:51], v112 offset:32768
    ds_read_b128 v[52:55], v113 offset:32768
    v_max3_f32 v116, v56, v57, v58
    v_max3_f32 v119, v59, v60, v61
    v_max3_f32 v116, v116, v62, v63
    v_max3_f32 v119, v119, v64, v65
    v_max3_f32 v116, v116, v66, v67
    v_max3_f32 v119, v119, v68, v69
    v_max3_f32 v116, v116, v70, v71
    v_max_f32 v116, v116, v119
    v_cmp_gt_f32 vcc, v116, v117
    s_cbranch_vccnz at_rescf_10
at_backf_10:
    v_exp_f32 v56, v56
    v_exp_f32 v57, v57
    v_exp_f32 v58, v58
    v_exp_f32 v59, v59
    v_exp_f32 v60, v60
    v_exp_f32 v61, v61
    v_exp_f32 v62, v62
    v_exp_f32 v63, v63
    v_exp_f32 v64, v64
    v_exp_f32 v65, v65
    v_exp_f32 v66, v66
    v_exp_f32 v67, v67
    v_exp_f32 v68, v68
    v_exp_f32 v69, v69
    v_exp_f32 v70, v70
    v_exp_f32 v71, v71
    s_nop 0
    v_cvt_pk_bf16_f32 v56, v56, v57
    v_cvt_pk_bf16_f32 v57, v58, v59
    v_cvt_pk_bf16_f32 v58, v60, v61
    v_cvt_pk_bf16_f32 v59, v62, v63
    v_cvt_pk_bf16_f32 v60, v64, v65
    v_cvt_pk_bf16_f32 v61, v66, v67
    v_cvt_pk_bf16_f32 v62, v68, v69
    v_cvt_pk_bf16_f32 v63, v70, v71
    s_waitcnt lgkmcnt(4)
    s_nop 0
    v_mfma_f32_32x32x16_bf16 v[88:103], v[40:43], v[56:59], v[88:103]
    v_mfma_f32_32x32x16_bf16 v[88:103], v[44:47], v[60:63], v[88:103]
    s_waitcnt lgkmcnt(2)
    v_mfma_f32_32x32x16_bf16 v[56:71], v[24:27], v[16:19], 0
    v_mfma_f32_32x32x16_bf16 v[56:71], v[28:31], v[20:23], v[56:71]
    ds_read_b128 v[32:35], v104 offset:51200
    ds_read_b128 v[36:39], v105 offset:51200
    ds_read_b128 v[40:43], v106 offset:49152
    ds_read_b128 v[44:47], v107 offset:49152
    v_max3_f32 v116, v72, v73, v74
    v_max3_f32 v119, v75, v76, v77
    v_max3_f32 v116, v116, v78, v79
    v_max3_f32 v119, v119, v80, v81
    v_max3_f32 v116, v116, v82, v83
    v_max3_f32 v119, v119, v84, v85
    v_max3_f32 v116, v116, v86, v87
    v_max_f32 v116, v116, v119
    v_cmp_gt_f32 vcc, v116, v117
    s_cbranch_vccnz at_rescf_11
at_backf_11:
    v_exp_f32 v72, v72
    v_exp_f32 v73, v73
    v_exp_f32 v74, v74
    v_exp_f32 v75, v75
    v_exp_f32 v76, v76
    v_exp_f32 v77, v77
    v_exp_f32 v78, v78
    v_exp_f32 v79, v79
    v_exp_f32 v80, v80
    v_exp_f32 v81, v81
    v_exp_f32 v82, v82
    v_exp_f32 v83, v83
    v_exp_f32 v84, v84
    v_exp_f32 v85, v85
    v_exp_f32 v86, v86
    v_exp_f32 v87, v87
    s_nop 0
    v_cvt_pk_bf16_f32 v72, v72, v73
    v_cvt_pk_bf16_f32 v73, v74, v75
    v_cvt_pk_bf16_f32 v74, v76, v77
    v_cvt_pk_bf16_f32 v75, v78, v79
    v_cvt_pk_bf16_f32 v76, v80, v81
    v_cvt_pk_bf16_f32 v77, v82, v83
    v_cvt_pk_bf16_f32 v78, v84, v85
    v_cvt_pk_bf16_f32 v79, v86, v87
    s_waitcnt lgkmcnt(4)
    s_nop 0
    v_mfma_f32_32x32x16_bf16 v[88:103], v[48:51], v[72:75], v[88:103]
    v_mfma_f32_32x32x16_bf16 v[88:103], v[52:55], v[76:79], v[88:103]
    s_waitcnt lgkmcnt(2)
    v_mfma_f32_32x32x16_bf16 v[72:87], v[32:35], v[16:19], 0
    v_mfma_f32_32x32x16_bf16 v[72:87], v[36:39], v[20:23], v[72:87]
    ds_read_b128 v[24:27], v104 offset:53248
    ds_read_b128 v[28:31], v105 offset:53248
    ds_read_b128 v[48:51], v108 offset:49152
    ds_read_b128 v[52:55], v109 offset:49152
    v_max3_f32 v116, v56, v57, v58
    v_max3_f32 v119, v59, v60, v61
    v_max3_f32 v116, v116, v62, v63
    v_max3_f32 v119, v119, v64, v65
    v_max3_f32 v116, v116, v66, v67
    v_max3_f32 v119, v119, v68, v69
    v_max3_f32 v116, v116, v70, v71
    v_max_f32 v116, v116, v119
    v_cmp_gt_f32 vcc, v116, v117
    s_cbranch_vccnz at_rescf_12
at_backf_12:
    v_exp_f32 v56, v56
    v_exp_f32 v57, v57
    v_exp_f32 v58, v58
    v_exp_f32 v59, v59
    v_exp_f32 v60, v60
    v_exp_f32 v61, v61
    v_exp_f32 v62, v62
    v_exp_f32 v63, v63
    v_exp_f32 v64, v64
    v_exp_f32 v65, v65
    v_exp_f32 v66, v66
    v_exp_f32 v67, v67
    v_exp_f32 v68, v68
    v_exp_f32 v69, v69
    v_exp_f32 v70, v70
    v_exp_f32 v71, v71
    s_nop 0
    v_cvt_pk_bf16_f32 v56, v56, v57
    v_cvt_pk_bf16_f32 v57, v58, v59
    v_cvt_pk_bf16_f32 v58, v60, v61
    v_cvt_pk_bf16_f32 v59, v62, v63
    v_cvt_pk_bf16_f32 v60, v64, v65
    v_cvt_pk_bf16_f32 v61, v66, v67
    v_cvt_pk_bf16_f32 v62, v68, v69
    v_cvt_pk_bf16_f32 v63, v70, v71
    s_waitcnt lgkmcnt(4)
    s_nop 0
    v_mfma_f32_32x32x16_bf16 v[88:103], v[40:43], v[56:59], v[88:103]
    v_mfma_f32_32x32x16_bf16 v[88:103], v[44:47], v[60:63], v[88:103]
    s_waitcnt lgkmcnt(2)
    v_mfma_f32_32x32x16_bf16 v[56:71], v[24:27], v[16:19], 0
    v_mfma_f32_32x32x16_bf16 v[56:71], v[28:31], v[20:23], v[56:71]
    ds_read_b128 v[32:35], v104 offset:55296
    ds_read_b128 v[36:39], v105 offset:55296
    ds_read_b128 v[40:43], v110 offset:49152
    ds_read_b128 v[44:47], v111 offset:49152
    v_max3_f32 v116, v72, v73, v74
    v_max3_f32 v119, v75, v76, v77
    v_max3_f32 v116, v116, v78, v79
    v_max3_f32 v119, v119, v80, v81
    v_max3_f32 v116, v116, v82, v83
    v_max3_f32 v119, v119, v84, v85
    v_max3_f32 v116, v116, v86, v87
    v_max_f32 v116, v116, v119
    v_cmp_gt_f32 vcc, v116, v117
    s_cbranch_vccnz at_rescf_13
at_backf_13:
    v_exp_f32 v72, v72
    v_exp_f32 v73, v73
    v_exp_f32 v74, v74
    v_exp_f32 v75, v75
    v_exp_f32 v76, v76
    v_exp_f32 v77, v77
    v_exp_f32 v78, v78
    v_exp_f32 v79, v79
    v_exp_f32 v80, v80
    v_exp_f32 v81, v81
    v_exp_f32 v82, v82
    v_exp_f32 v83, v83
    v_exp_f32 v84, v84
    v_exp_f32 v85, v85
    v_exp_f32 v86, v86
    v_exp_f32 v87, v87
    s_nop 0
    v_cvt_pk_bf16_f32 v72, v72, v73
    v_cvt_pk_bf16_f32 v73, v74, v75
    v_cvt_pk_bf16_f32 v74, v76, v77
    v_cvt_pk_bf16_f32 v75, v78, v79
    v_cvt_pk_bf16_f32 v76, v80, v81
    v_cvt_pk_bf16_f32 v77, v82, v83
    v_cvt_pk_bf16_f32 v78, v84, v85
    v_cvt_pk_bf16_f32 v79, v86, v87
    s_waitcnt lgkmcnt(4)
    s_nop 0
    v_mfma_f32_32x32x16_bf16 v[88:103], v[48:51], v[72:75], v[88:103]
    v_mfma_f32_32x32x16_bf16 v[88:103], v[52:55], v[76:79], v[88:103]
    s_waitcnt lgkmcnt(2)
    v_mfma_f32_32x32x16_bf16 v[72:87], v[32:35], v[16:19], 0
    v_mfma_f32_32x32x16_bf16 v[72:87], v[36:39], v[20:23], v[72:87]
    ds_read_b128 v[24:27], v104 offset:0
    ds_read_b128 v[28:31], v105 offset:0
    ds_read_b128 v[48:51], v112 offset:49152
    ds_read_b128 v[52:55], v113 offset:49152
    v_max3_f32 v116, v56, v57, v58
    v_max3_f32 v119, v59, v60, v61
    v_max3_f32 v116, v116, v62, v63
    v_max3_f32 v119, v119, v64, v65
    v_max3_f32 v116, v116, v66, v67
    v_max3_f32 v119, v119, v68, v69
    v_max3_f32 v116, v116, v70, v71
    v_max_f32 v116, v116, v119
    v_cmp_gt_f32 vcc, v116, v117
    s_cbranch_vccnz at_rescf_14
at_backf_14:
    v_exp_f32 v56, v56
    v_exp_f32 v57, v57
    v_exp_f32 v58, v58
    v_exp_f32 v59, v59
    v_exp_f32 v60, v60
    v_exp_f32 v61, v61
    v_exp_f32 v62, v62
    v_exp_f32 v63, v63
    v_exp_f32 v64, v64
    v_exp_f32 v65, v65
    v_exp_f32 v66, v66
    v_exp_f32 v67, v67
    v_exp_f32 v68, v68
    v_exp_f32 v69, v69
    v_exp_f32 v70, v70
    v_exp_f32 v71, v71
    s_nop 0
    v_cvt_pk_bf16_f32 v56, v56, v57
    v_cvt_pk_bf16_f32 v57, v58, v59
    v_cvt_pk_bf16_f32 v58, v60, v61
    v_cvt_pk_bf16_f32 v59, v62, v63
    v_cvt_pk_bf16_f32 v60, v64, v65
    v_cvt_pk_bf16_f32 v61, v66, v67
    v_cvt_pk_bf16_f32 v62, v68, v69
    v_cvt_pk_bf16_f32 v63, v70, v71
    s_waitcnt lgkmcnt(4)
    s_nop 0
    v_mfma_f32_32x32x16_bf16 v[88:103], v[40:43], v[56:59], v[88:103]
    v_mfma_f32_32x32x16_bf16 v[88:103], v[44:47], v[60:63], v[88:103]
    v_max3_f32 v116, v72, v73, v74
    v_max3_f32 v119, v75, v76, v77
    v_max3_f32 v116, v116, v78, v79
    v_max3_f32 v119, v119, v80, v81
    v_max3_f32 v116, v116, v82, v83
    v_max3_f32 v119, v119, v84, v85
    v_max3_f32 v116, v116, v86, v87
    v_max_f32 v116, v116, v119
    v_cmp_gt_f32 vcc, v116, v117
    s_cbranch_vccnz at_rescf_15
at_backf_15:
    v_exp_f32 v72, v72
    v_exp_f32 v73, v73
    v_exp_f32 v74, v74
    v_exp_f32 v75, v75
    v_exp_f32 v76, v76
    v_exp_f32 v77, v77
    v_exp_f32 v78, v78
    v_exp_f32 v79, v79
    v_exp_f32 v80, v80
    v_exp_f32 v81, v81
    v_exp_f32 v82, v82
    v_exp_f32 v83, v83
    v_exp_f32 v84, v84
    v_exp_f32 v85, v85
    v_exp_f32 v86, v86
    v_exp_f32 v87, v87
    s_nop 0
    v_cvt_pk_bf16_f32 v72, v72, v73
    v_cvt_pk_bf16_f32 v73, v74, v75
    v_cvt_pk_bf16_f32 v74, v76, v77
    v_cvt_pk_bf16_f32 v75, v78, v79
    v_cvt_pk_bf16_f32 v76, v80, v81
    v_cvt_pk_bf16_f32 v77, v82, v83
    v_cvt_pk_bf16_f32 v78, v84, v85
    v_cvt_pk_bf16_f32 v79, v86, v87
    s_waitcnt lgkmcnt(0)
    s_nop 0
    v_mfma_f32_32x32x16_bf16 v[88:103], v[48:51], v[72:75], v[88:103]
    v_mfma_f32_32x32x16_bf16 v[88:103], v[52:55], v[76:79], v[88:103]
    s_nop 15
    s_nop 3
    v_or_b32 v1, 32, v2
    v_lshlrev_b32 v1, 2, v1
    ds_bpermute_b32 v119, v1, v96
    s_waitcnt lgkmcnt(0)
    v_rcp_f32 v120, v119
    s_nop 0
    v_fma_f32 v3, -v119, v120, 1.0
    v_fma_f32 v120, v3, v120, v120
    v_and_b32 v1, 31, v2
    v_add_u32 v1, s22, v1
    s_movk_i32 s3, 1280
    v_mul_lo_u32 v1, v1, s3
    v_lshrrev_b32 v3, 5, v2
    v_lshl_add_u32 v1, v3, 3, v1
    s_mul_i32 s3, s21, 40
    s_add_u32 s3, s3, 24117248
    v_mul_f32 v4, v88, v120
    v_mul_f32 v5, v89, v120
    v_mul_f32 v6, v90, v120
    v_mul_f32 v7, v91, v120
    v_cvt_pk_bf16_f32 v8, v4, v5
    v_cvt_pk_bf16_f32 v9, v6, v7
    buffer_store_dwordx2 v[8:9], v1, s[8:11], s3 offen offset:0
    s_nop 1
    v_mul_f32 v4, v92, v120
    v_mul_f32 v5, v93, v120
    v_mul_f32 v6, v94, v120
    v_mul_f32 v7, v95, v120
    v_cvt_pk_bf16_f32 v8, v4, v5
    v_cvt_pk_bf16_f32 v9, v6, v7
    buffer_store_dwordx2 v[8:9], v1, s[8:11], s3 offen offset:16
    s_nop 1
    v_mul_f32 v4, v96, v120
    v_mul_f32 v5, v97, v120
    v_mul_f32 v6, v98, v120
    v_mul_f32 v7, v99, v120
    v_cvt_pk_bf16_f32 v8, v4, v5
    v_cvt_pk_bf16_f32 v9, v6, v7
    v_cmp_gt_u32 vcc, 32, v2
    s_and_saveexec_b64 s[24:25], vcc
    buffer_store_dwordx2 v[8:9], v1, s[8:11], s3 offen offset:32
    s_mov_b64 exec, s[24:25]
    s_nop 1
    s_branch at_end
at_rescl_0:
    ds_bpermute_b32 v119, v121, v116
    s_waitcnt lgkmcnt(0)
    v_max_f32 v116, v116, v119
    v_cmp_gt_f32 vcc, v116, v117
    s_nop 1
    v_cndmask_b32 v116, 0, v116, vcc
    v_add_f32 v119, v118, v116
    v_cvt_pk_bf16_f32 v119, v119, v119
    v_lshlrev_b32 v119, 16, v119
    v_sub_f32 v116, v119, v118
    v_mov_b32 v118, v119
    v_max_f32 v120, 0, v116
    v_sub_f32 v120, 0, v120
    v_exp_f32 v120, v120
    v_lshrrev_b32 v119, 16, v119
    v_xor_b32 v119, 0x8000, v119
    s_nop 15
    s_nop 15
    v_and_b32 v22, v119, v122
    v_mov_b32 v117, 0x41000000
    v_mul_f32 v88, v88, v120
    v_mul_f32 v89, v89, v120
    v_mul_f32 v90, v90, v120
    v_mul_f32 v91, v91, v120
    v_mul_f32 v92, v92, v120
    v_mul_f32 v93, v93, v120
    v_mul_f32 v94, v94, v120
    v_mul_f32 v95, v95, v120
    v_mul_f32 v96, v96, v120
    v_mul_f32 v97, v97, v120
    v_mul_f32 v98, v98, v120
    v_mul_f32 v99, v99, v120
    v_mul_f32 v100, v100, v120
    v_mul_f32 v101, v101, v120
    v_mul_f32 v102, v102, v120
    v_mul_f32 v103, v103, v120
    v_sub_f32 v56, v56, v116
    v_sub_f32 v57, v57, v116
    v_sub_f32 v58, v58, v116
    v_sub_f32 v59, v59, v116
    v_sub_f32 v60, v60, v116
    v_sub_f32 v61, v61, v116
    v_sub_f32 v62, v62, v116
    v_sub_f32 v63, v63, v116
    v_sub_f32 v64, v64, v116
    v_sub_f32 v65, v65, v116
    v_sub_f32 v66, v66, v116
    v_sub_f32 v67, v67, v116
    v_sub_f32 v68, v68, v116
    v_sub_f32 v69, v69, v116
    v_sub_f32 v70, v70, v116
    v_sub_f32 v71, v71, v116
    v_sub_f32 v72, v72, v116
    v_sub_f32 v73, v73, v116
    v_sub_f32 v74, v74, v116
    v_sub_f32 v75, v75, v116
    v_sub_f32 v76, v76, v116
    v_sub_f32 v77, v77, v116
    v_sub_f32 v78, v78, v116
    v_sub_f32 v79, v79, v116
    v_sub_f32 v80, v80, v116
    v_sub_f32 v81, v81, v116
    v_sub_f32 v82, v82, v116
    v_sub_f32 v83, v83, v116
    v_sub_f32 v84, v84, v116
    v_sub_f32 v85, v85, v116
    v_sub_f32 v86, v86, v116
    v_sub_f32 v87, v87, v116
    s_branch at_backl_0
at_rescl_1:
    ds_bpermute_b32 v119, v121, v116
    s_waitcnt lgkmcnt(0)
    v_max_f32 v116, v116, v119
    v_cmp_gt_f32 vcc, v116, v117
    s_nop 1
    v_cndmask_b32 v116, 0, v116, vcc
    v_add_f32 v119, v118, v116
    v_cvt_pk_bf16_f32 v119, v119, v119
    v_lshlrev_b32 v119, 16, v119
    v_sub_f32 v116, v119, v118
    v_mov_b32 v118, v119
    v_max_f32 v120, 0, v116
    v_sub_f32 v120, 0, v120
    v_exp_f32 v120, v120
    v_lshrrev_b32 v119, 16, v119
    v_xor_b32 v119, 0x8000, v119
    s_nop 15
    s_nop 15
    v_and_b32 v22, v119, v122
    v_mov_b32 v117, 0x41000000
    v_mul_f32 v88, v88, v120
    v_mul_f32 v89, v89, v120
    v_mul_f32 v90, v90, v120
    v_mul_f32 v91, v91, v120
    v_mul_f32 v92, v92, v120
    v_mul_f32 v93, v93, v120
    v_mul_f32 v94, v94, v120
    v_mul_f32 v95, v95, v120
    v_mul_f32 v96, v96, v120
    v_mul_f32 v97, v97, v120
    v_mul_f32 v98, v98, v120
    v_mul_f32 v99, v99, v120
    v_mul_f32 v100, v100, v120
    v_mul_f32 v101, v101, v120
    v_mul_f32 v102, v102, v120
    v_mul_f32 v103, v103, v120
    v_sub_f32 v72, v72, v116
    v_sub_f32 v73, v73, v116
    v_sub_f32 v74, v74, v116
    v_sub_f32 v75, v75, v116
    v_sub_f32 v76, v76, v116
    v_sub_f32 v77, v77, v116
    v_sub_f32 v78, v78, v116
    v_sub_f32 v79, v79, v116
    v_sub_f32 v80, v80, v116
    v_sub_f32 v81, v81, v116
    v_sub_f32 v82, v82, v116
    v_sub_f32 v83, v83, v116
    v_sub_f32 v84, v84, v116
    v_sub_f32 v85, v85, v116
    v_sub_f32 v86, v86, v116
    v_sub_f32 v87, v87, v116
    v_sub_f32 v56, v56, v116
    v_sub_f32 v57, v57, v116
    v_sub_f32 v58, v58, v116
    v_sub_f32 v59, v59, v116
    v_sub_f32 v60, v60, v116
    v_sub_f32 v61, v61, v116
    v_sub_f32 v62, v62, v116
    v_sub_f32 v63, v63, v116
    v_sub_f32 v64, v64, v116
    v_sub_f32 v65, v65, v116
    v_sub_f32 v66, v66, v116
    v_sub_f32 v67, v67, v116
    v_sub_f32 v68, v68, v116
    v_sub_f32 v69, v69, v116
    v_sub_f32 v70, v70, v116
    v_sub_f32 v71, v71, v116
    s_branch at_backl_1
at_rescl_2:
    ds_bpermute_b32 v119, v121, v116
    s_waitcnt lgkmcnt(0)
    v_max_f32 v116, v116, v119
    v_cmp_gt_f32 vcc, v116, v117
    s_nop 1
    v_cndmask_b32 v116, 0, v116, vcc
    v_add_f32 v119, v118, v116
    v_cvt_pk_bf16_f32 v119, v119, v119
    v_lshlrev_b32 v119, 16, v119
    v_sub_f32 v116, v119, v118
    v_mov_b32 v118, v119
    v_max_f32 v120, 0, v116
    v_sub_f32 v120, 0, v120
    v_exp_f32 v120, v120
    v_lshrrev_b32 v119, 16, v119
    v_xor_b32 v119, 0x8000, v119
    s_nop 15
    s_nop 15
    v_and_b32 v22, v119, v122
    v_mov_b32 v117, 0x41000000
    v_mul_f32 v88, v88, v120
    v_mul_f32 v89, v89, v120
    v_mul_f32 v90, v90, v120
    v_mul_f32 v91, v91, v120
    v_mul_f32 v92, v92, v120
    v_mul_f32 v93, v93, v120
    v_mul_f32 v94, v94, v120
    v_mul_f32 v95, v95, v120
    v_mul_f32 v96, v96, v120
    v_mul_f32 v97, v97, v120
    v_mul_f32 v98, v98, v120
    v_mul_f32 v99, v99, v120
    v_mul_f32 v100, v100, v120
    v_mul_f32 v101, v101, v120
    v_mul_f32 v102, v102, v120
    v_mul_f32 v103, v103, v120
    v_sub_f32 v56, v56, v116
    v_sub_f32 v57, v57, v116
    v_sub_f32 v58, v58, v116
    v_sub_f32 v59, v59, v116
    v_sub_f32 v60, v60, v116
    v_sub_f32 v61, v61, v116
    v_sub_f32 v62, v62, v116
    v_sub_f32 v63, v63, v116
    v_sub_f32 v64, v64, v116
    v_sub_f32 v65, v65, v116
    v_sub_f32 v66, v66, v116
    v_sub_f32 v67, v67, v116
    v_sub_f32 v68, v68, v116
    v_sub_f32 v69, v69, v116
    v_sub_f32 v70, v70, v116
    v_sub_f32 v71, v71, v116
    v_sub_f32 v72, v72, v116
    v_sub_f32 v73, v73, v116
    v_sub_f32 v74, v74, v116
    v_sub_f32 v75, v75, v116
    v_sub_f32 v76, v76, v116
    v_sub_f32 v77, v77, v116
    v_sub_f32 v78, v78, v116
    v_sub_f32 v79, v79, v116
    v_sub_f32 v80, v80, v116
    v_sub_f32 v81, v81, v116
    v_sub_f32 v82, v82, v116
    v_sub_f32 v83, v83, v116
    v_sub_f32 v84, v84, v116
    v_sub_f32 v85, v85, v116
    v_sub_f32 v86, v86, v116
    v_sub_f32 v87, v87, v116
    s_branch at_backl_2
at_rescl_3:
    ds_bpermute_b32 v119, v121, v116
    s_waitcnt lgkmcnt(0)
    v_max_f32 v116, v116, v119
    v_cmp_gt_f32 vcc, v116, v117
    s_nop 1
    v_cndmask_b32 v116, 0, v116, vcc
    v_add_f32 v119, v118, v116
    v_cvt_pk_bf16_f32 v119, v119, v119
    v_lshlrev_b32 v119, 16, v119
    v_sub_f32 v116, v119, v118
    v_mov_b32 v118, v119
    v_max_f32 v120, 0, v116
    v_sub_f32 v120, 0, v120
    v_exp_f32 v120, v120
    v_lshrrev_b32 v119, 16, v119
    v_xor_b32 v119, 0x8000, v119
    s_nop 15
    s_nop 15
    v_and_b32 v22, v119, v122
    v_mov_b32 v117, 0x41000000
    v_mul_f32 v88, v88, v120
    v_mul_f32 v89, v89, v120
    v_mul_f32 v90, v90, v120
    v_mul_f32 v91, v91, v120
    v_mul_f32 v92, v92, v120
    v_mul_f32 v93, v93, v120
    v_mul_f32 v94, v94, v120
    v_mul_f32 v95, v95, v120
    v_mul_f32 v96, v96, v120
    v_mul_f32 v97, v97, v120
    v_mul_f32 v98, v98, v120
    v_mul_f32 v99, v99, v120
    v_mul_f32 v100, v100, v120
    v_mul_f32 v101, v101, v120
    v_mul_f32 v102, v102, v120
    v_mul_f32 v103, v103, v120
    v_sub_f32 v72, v72, v116
    v_sub_f32 v73, v73, v116
    v_sub_f32 v74, v74, v116
    v_sub_f32 v75, v75, v116
    v_sub_f32 v76, v76, v116
    v_sub_f32 v77, v77, v116
    v_sub_f32 v78, v78, v116
    v_sub_f32 v79, v79, v116
    v_sub_f32 v80, v80, v116
    v_sub_f32 v81, v81, v116
    v_sub_f32 v82, v82, v116
    v_sub_f32 v83, v83, v116
    v_sub_f32 v84, v84, v116
    v_sub_f32 v85, v85, v116
    v_sub_f32 v86, v86, v116
    v_sub_f32 v87, v87, v116
    v_sub_f32 v56, v56, v116
    v_sub_f32 v57, v57, v116
    v_sub_f32 v58, v58, v116
    v_sub_f32 v59, v59, v116
    v_sub_f32 v60, v60, v116
    v_sub_f32 v61, v61, v116
    v_sub_f32 v62, v62, v116
    v_sub_f32 v63, v63, v116
    v_sub_f32 v64, v64, v116
    v_sub_f32 v65, v65, v116
    v_sub_f32 v66, v66, v116
    v_sub_f32 v67, v67, v116
    v_sub_f32 v68, v68, v116
    v_sub_f32 v69, v69, v116
    v_sub_f32 v70, v70, v116
    v_sub_f32 v71, v71, v116
    s_branch at_backl_3
at_rescl_4:
    ds_bpermute_b32 v119, v121, v116
    s_waitcnt lgkmcnt(0)
    v_max_f32 v116, v116, v119
    v_cmp_gt_f32 vcc, v116, v117
    s_nop 1
    v_cndmask_b32 v116, 0, v116, vcc
    v_add_f32 v119, v118, v116
    v_cvt_pk_bf16_f32 v119, v119, v119
    v_lshlrev_b32 v119, 16, v119
    v_sub_f32 v116, v119, v118
    v_mov_b32 v118, v119
    v_max_f32 v120, 0, v116
    v_sub_f32 v120, 0, v120
    v_exp_f32 v120, v120
    v_lshrrev_b32 v119, 16, v119
    v_xor_b32 v119, 0x8000, v119
    s_nop 15
    s_nop 15
    v_and_b32 v22, v119, v122
    v_mov_b32 v117, 0x41000000
    v_mul_f32 v88, v88, v120
    v_mul_f32 v89, v89, v120
    v_mul_f32 v90, v90, v120
    v_mul_f32 v91, v91, v120
    v_mul_f32 v92, v92, v120
    v_mul_f32 v93, v93, v120
    v_mul_f32 v94, v94, v120
    v_mul_f32 v95, v95, v120
    v_mul_f32 v96, v96, v120
    v_mul_f32 v97, v97, v120
    v_mul_f32 v98, v98, v120
    v_mul_f32 v99, v99, v120
    v_mul_f32 v100, v100, v120
    v_mul_f32 v101, v101, v120
    v_mul_f32 v102, v102, v120
    v_mul_f32 v103, v103, v120
    v_sub_f32 v56, v56, v116
    v_sub_f32 v57, v57, v116
    v_sub_f32 v58, v58, v116
    v_sub_f32 v59, v59, v116
    v_sub_f32 v60, v60, v116
    v_sub_f32 v61, v61, v116
    v_sub_f32 v62, v62, v116
    v_sub_f32 v63, v63, v116
    v_sub_f32 v64, v64, v116
    v_sub_f32 v65, v65, v116
    v_sub_f32 v66, v66, v116
    v_sub_f32 v67, v67, v116
    v_sub_f32 v68, v68, v116
    v_sub_f32 v69, v69, v116
    v_sub_f32 v70, v70, v116
    v_sub_f32 v71, v71, v116
    v_sub_f32 v72, v72, v116
    v_sub_f32 v73, v73, v116
    v_sub_f32 v74, v74, v116
    v_sub_f32 v75, v75, v116
    v_sub_f32 v76, v76, v116
    v_sub_f32 v77, v77, v116
    v_sub_f32 v78, v78, v116
    v_sub_f32 v79, v79, v116
    v_sub_f32 v80, v80, v116
    v_sub_f32 v81, v81, v116
    v_sub_f32 v82, v82, v116
    v_sub_f32 v83, v83, v116
    v_sub_f32 v84, v84, v116
    v_sub_f32 v85, v85, v116
    v_sub_f32 v86, v86, v116
    v_sub_f32 v87, v87, v116
    s_branch at_backl_4
at_rescl_5:
    ds_bpermute_b32 v119, v121, v116
    s_waitcnt lgkmcnt(0)
    v_max_f32 v116, v116, v119
    v_cmp_gt_f32 vcc, v116, v117
    s_nop 1
    v_cndmask_b32 v116, 0, v116, vcc
    v_add_f32 v119, v118, v116
    v_cvt_pk_bf16_f32 v119, v119, v119
    v_lshlrev_b32 v119, 16, v119
    v_sub_f32 v116, v119, v118
    v_mov_b32 v118, v119
    v_max_f32 v120, 0, v116
    v_sub_f32 v120, 0, v120
    v_exp_f32 v120, v120
    v_lshrrev_b32 v119, 16, v119
    v_xor_b32 v119, 0x8000, v119
    s_nop 15
    s_nop 15
    v_and_b32 v22, v119, v122
    v_mov_b32 v117, 0x41000000
    v_mul_f32 v88, v88, v120
    v_mul_f32 v89, v89, v120
    v_mul_f32 v90, v90, v120
    v_mul_f32 v91, v91, v120
    v_mul_f32 v92, v92, v120
    v_mul_f32 v93, v93, v120
    v_mul_f32 v94, v94, v120
    v_mul_f32 v95, v95, v120
    v_mul_f32 v96, v96, v120
    v_mul_f32 v97, v97, v120
    v_mul_f32 v98, v98, v120
    v_mul_f32 v99, v99, v120
    v_mul_f32 v100, v100, v120
    v_mul_f32 v101, v101, v120
    v_mul_f32 v102, v102, v120
    v_mul_f32 v103, v103, v120
    v_sub_f32 v72, v72, v116
    v_sub_f32 v73, v73, v116
    v_sub_f32 v74, v74, v116
    v_sub_f32 v75, v75, v116
    v_sub_f32 v76, v76, v116
    v_sub_f32 v77, v77, v116
    v_sub_f32 v78, v78, v116
    v_sub_f32 v79, v79, v116
    v_sub_f32 v80, v80, v116
    v_sub_f32 v81, v81, v116
    v_sub_f32 v82, v82, v116
    v_sub_f32 v83, v83, v116
    v_sub_f32 v84, v84, v116
    v_sub_f32 v85, v85, v116
    v_sub_f32 v86, v86, v116
    v_sub_f32 v87, v87, v116
    v_sub_f32 v56, v56, v116
    v_sub_f32 v57, v57, v116
    v_sub_f32 v58, v58, v116
    v_sub_f32 v59, v59, v116
    v_sub_f32 v60, v60, v116
    v_sub_f32 v61, v61, v116
    v_sub_f32 v62, v62, v116
    v_sub_f32 v63, v63, v116
    v_sub_f32 v64, v64, v116
    v_sub_f32 v65, v65, v116
    v_sub_f32 v66, v66, v116
    v_sub_f32 v67, v67, v116
    v_sub_f32 v68, v68, v116
    v_sub_f32 v69, v69, v116
    v_sub_f32 v70, v70, v116
    v_sub_f32 v71, v71, v116
    s_branch at_backl_5
at_rescl_6:
    ds_bpermute_b32 v119, v121, v116
    s_waitcnt lgkmcnt(0)
    v_max_f32 v116, v116, v119
    v_cmp_gt_f32 vcc, v116, v117
    s_nop 1
    v_cndmask_b32 v116, 0, v116, vcc
    v_add_f32 v119, v118, v116
    v_cvt_pk_bf16_f32 v119, v119, v119
    v_lshlrev_b32 v119, 16, v119
    v_sub_f32 v116, v119, v118
    v_mov_b32 v118, v119
    v_max_f32 v120, 0, v116
    v_sub_f32 v120, 0, v120
    v_exp_f32 v120, v120
    v_lshrrev_b32 v119, 16, v119
    v_xor_b32 v119, 0x8000, v119
    s_nop 15
    s_nop 15
    v_and_b32 v22, v119, v122
    v_mov_b32 v117, 0x41000000
    v_mul_f32 v88, v88, v120
    v_mul_f32 v89, v89, v120
    v_mul_f32 v90, v90, v120
    v_mul_f32 v91, v91, v120
    v_mul_f32 v92, v92, v120
    v_mul_f32 v93, v93, v120
    v_mul_f32 v94, v94, v120
    v_mul_f32 v95, v95, v120
    v_mul_f32 v96, v96, v120
    v_mul_f32 v97, v97, v120
    v_mul_f32 v98, v98, v120
    v_mul_f32 v99, v99, v120
    v_mul_f32 v100, v100, v120
    v_mul_f32 v101, v101, v120
    v_mul_f32 v102, v102, v120
    v_mul_f32 v103, v103, v120
    v_sub_f32 v56, v56, v116
    v_sub_f32 v57, v57, v116
    v_sub_f32 v58, v58, v116
    v_sub_f32 v59, v59, v116
    v_sub_f32 v60, v60, v116
    v_sub_f32 v61, v61, v116
    v_sub_f32 v62, v62, v116
    v_sub_f32 v63, v63, v116
    v_sub_f32 v64, v64, v116
    v_sub_f32 v65, v65, v116
    v_sub_f32 v66, v66, v116
    v_sub_f32 v67, v67, v116
    v_sub_f32 v68, v68, v116
    v_sub_f32 v69, v69, v116
    v_sub_f32 v70, v70, v116
    v_sub_f32 v71, v71, v116
    v_sub_f32 v72, v72, v116
    v_sub_f32 v73, v73, v116
    v_sub_f32 v74, v74, v116
    v_sub_f32 v75, v75, v116
    v_sub_f32 v76, v76, v116
    v_sub_f32 v77, v77, v116
    v_sub_f32 v78, v78, v116
    v_sub_f32 v79, v79, v116
    v_sub_f32 v80, v80, v116
    v_sub_f32 v81, v81, v116
    v_sub_f32 v82, v82, v116
    v_sub_f32 v83, v83, v116
    v_sub_f32 v84, v84, v116
    v_sub_f32 v85, v85, v116
    v_sub_f32 v86, v86, v116
    v_sub_f32 v87, v87, v116
    s_branch at_backl_6
at_rescl_7:
    ds_bpermute_b32 v119, v121, v116
    s_waitcnt lgkmcnt(0)
    v_max_f32 v116, v116, v119
    v_cmp_gt_f32 vcc, v116, v117
    s_nop 1
    v_cndmask_b32 v116, 0, v116, vcc
    v_add_f32 v119, v118, v116
    v_cvt_pk_bf16_f32 v119, v119, v119
    v_lshlrev_b32 v119, 16, v119
    v_sub_f32 v116, v119, v118
    v_mov_b32 v118, v119
    v_max_f32 v120, 0, v116
    v_sub_f32 v120, 0, v120
    v_exp_f32 v120, v120
    v_lshrrev_b32 v119, 16, v119
    v_xor_b32 v119, 0x8000, v119
    s_nop 15
    s_nop 15
    v_and_b32 v22, v119, v122
    v_mov_b32 v117, 0x41000000
    v_mul_f32 v88, v88, v120
    v_mul_f32 v89, v89, v120
    v_mul_f32 v90, v90, v120
    v_mul_f32 v91, v91, v120
    v_mul_f32 v92, v92, v120
    v_mul_f32 v93, v93, v120
    v_mul_f32 v94, v94, v120
    v_mul_f32 v95, v95, v120
    v_mul_f32 v96, v96, v120
    v_mul_f32 v97, v97, v120
    v_mul_f32 v98, v98, v120
    v_mul_f32 v99, v99, v120
    v_mul_f32 v100, v100, v120
    v_mul_f32 v101, v101, v120
    v_mul_f32 v102, v102, v120
    v_mul_f32 v103, v103, v120
    v_sub_f32 v72, v72, v116
    v_sub_f32 v73, v73, v116
    v_sub_f32 v74, v74, v116
    v_sub_f32 v75, v75, v116
    v_sub_f32 v76, v76, v116
    v_sub_f32 v77, v77, v116
    v_sub_f32 v78, v78, v116
    v_sub_f32 v79, v79, v116
    v_sub_f32 v80, v80, v116
    v_sub_f32 v81, v81, v116
    v_sub_f32 v82, v82, v116
    v_sub_f32 v83, v83, v116
    v_sub_f32 v84, v84, v116
    v_sub_f32 v85, v85, v116
    v_sub_f32 v86, v86, v116
    v_sub_f32 v87, v87, v116
    v_sub_f32 v56, v56, v116
    v_sub_f32 v57, v57, v116
    v_sub_f32 v58, v58, v116
    v_sub_f32 v59, v59, v116
    v_sub_f32 v60, v60, v116
    v_sub_f32 v61, v61, v116
    v_sub_f32 v62, v62, v116
    v_sub_f32 v63, v63, v116
    v_sub_f32 v64, v64, v116
    v_sub_f32 v65, v65, v116
    v_sub_f32 v66, v66, v116
    v_sub_f32 v67, v67, v116
    v_sub_f32 v68, v68, v116
    v_sub_f32 v69, v69, v116
    v_sub_f32 v70, v70, v116
    v_sub_f32 v71, v71, v116
    s_branch at_backl_7
at_rescl_8:
    ds_bpermute_b32 v119, v121, v116
    s_waitcnt lgkmcnt(0)
    v_max_f32 v116, v116, v119
    v_cmp_gt_f32 vcc, v116, v117
    s_nop 1
    v_cndmask_b32 v116, 0, v116, vcc
    v_add_f32 v119, v118, v116
    v_cvt_pk_bf16_f32 v119, v119, v119
    v_lshlrev_b32 v119, 16, v119
    v_sub_f32 v116, v119, v118
    v_mov_b32 v118, v119
    v_max_f32 v120, 0, v116
    v_sub_f32 v120, 0, v120
    v_exp_f32 v120, v120
    v_lshrrev_b32 v119, 16, v119
    v_xor_b32 v119, 0x8000, v119
    s_nop 15
    s_nop 15
    v_and_b32 v22, v119, v122
    v_mov_b32 v117, 0x41000000
    v_mul_f32 v88, v88, v120
    v_mul_f32 v89, v89, v120
    v_mul_f32 v90, v90, v120
    v_mul_f32 v91, v91, v120
    v_mul_f32 v92, v92, v120
    v_mul_f32 v93, v93, v120
    v_mul_f32 v94, v94, v120
    v_mul_f32 v95, v95, v120
    v_mul_f32 v96, v96, v120
    v_mul_f32 v97, v97, v120
    v_mul_f32 v98, v98, v120
    v_mul_f32 v99, v99, v120
    v_mul_f32 v100, v100, v120
    v_mul_f32 v101, v101, v120
    v_mul_f32 v102, v102, v120
    v_mul_f32 v103, v103, v120
    v_sub_f32 v56, v56, v116
    v_sub_f32 v57, v57, v116
    v_sub_f32 v58, v58, v116
    v_sub_f32 v59, v59, v116
    v_sub_f32 v60, v60, v116
    v_sub_f32 v61, v61, v116
    v_sub_f32 v62, v62, v116
    v_sub_f32 v63, v63, v116
    v_sub_f32 v64, v64, v116
    v_sub_f32 v65, v65, v116
    v_sub_f32 v66, v66, v116
    v_sub_f32 v67, v67, v116
    v_sub_f32 v68, v68, v116
    v_sub_f32 v69, v69, v116
    v_sub_f32 v70, v70, v116
    v_sub_f32 v71, v71, v116
    v_sub_f32 v72, v72, v116
    v_sub_f32 v73, v73, v116
    v_sub_f32 v74, v74, v116
    v_sub_f32 v75, v75, v116
    v_sub_f32 v76, v76, v116
    v_sub_f32 v77, v77, v116
    v_sub_f32 v78, v78, v116
    v_sub_f32 v79, v79, v116
    v_sub_f32 v80, v80, v116
    v_sub_f32 v81, v81, v116
    v_sub_f32 v82, v82, v116
    v_sub_f32 v83, v83, v116
    v_sub_f32 v84, v84, v116
    v_sub_f32 v85, v85, v116
    v_sub_f32 v86, v86, v116
    v_sub_f32 v87, v87, v116
    s_branch at_backl_8
at_rescl_9:
    ds_bpermute_b32 v119, v121, v116
    s_waitcnt lgkmcnt(0)
    v_max_f32 v116, v116, v119
    v_cmp_gt_f32 vcc, v116, v117
    s_nop 1
    v_cndmask_b32 v116, 0, v116, vcc
    v_add_f32 v119, v118, v116
    v_cvt_pk_bf16_f32 v119, v119, v119
    v_lshlrev_b32 v119, 16, v119
    v_sub_f32 v116, v119, v118
    v_mov_b32 v118, v119
    v_max_f32 v120, 0, v116
    v_sub_f32 v120, 0, v120
    v_exp_f32 v120, v120
    v_lshrrev_b32 v119, 16, v119
    v_xor_b32 v119, 0x8000, v119
    s_nop 15
    s_nop 15
    v_and_b32 v22, v119, v122
    v_mov_b32 v117, 0x41000000
    v_mul_f32 v88, v88, v120
    v_mul_f32 v89, v89, v120
    v_mul_f32 v90, v90, v120
    v_mul_f32 v91, v91, v120
    v_mul_f32 v92, v92, v120
    v_mul_f32 v93, v93, v120
    v_mul_f32 v94, v94, v120
    v_mul_f32 v95, v95, v120
    v_mul_f32 v96, v96, v120
    v_mul_f32 v97, v97, v120
    v_mul_f32 v98, v98, v120
    v_mul_f32 v99, v99, v120
    v_mul_f32 v100, v100, v120
    v_mul_f32 v101, v101, v120
    v_mul_f32 v102, v102, v120
    v_mul_f32 v103, v103, v120
    v_sub_f32 v72, v72, v116
    v_sub_f32 v73, v73, v116
    v_sub_f32 v74, v74, v116
    v_sub_f32 v75, v75, v116
    v_sub_f32 v76, v76, v116
    v_sub_f32 v77, v77, v116
    v_sub_f32 v78, v78, v116
    v_sub_f32 v79, v79, v116
    v_sub_f32 v80, v80, v116
    v_sub_f32 v81, v81, v116
    v_sub_f32 v82, v82, v116
    v_sub_f32 v83, v83, v116
    v_sub_f32 v84, v84, v116
    v_sub_f32 v85, v85, v116
    v_sub_f32 v86, v86, v116
    v_sub_f32 v87, v87, v116
    v_sub_f32 v56, v56, v116
    v_sub_f32 v57, v57, v116
    v_sub_f32 v58, v58, v116
    v_sub_f32 v59, v59, v116
    v_sub_f32 v60, v60, v116
    v_sub_f32 v61, v61, v116
    v_sub_f32 v62, v62, v116
    v_sub_f32 v63, v63, v116
    v_sub_f32 v64, v64, v116
    v_sub_f32 v65, v65, v116
    v_sub_f32 v66, v66, v116
    v_sub_f32 v67, v67, v116
    v_sub_f32 v68, v68, v116
    v_sub_f32 v69, v69, v116
    v_sub_f32 v70, v70, v116
    v_sub_f32 v71, v71, v116
    s_branch at_backl_9
at_rescl_10:
    ds_bpermute_b32 v119, v121, v116
    s_waitcnt lgkmcnt(0)
    v_max_f32 v116, v116, v119
    v_cmp_gt_f32 vcc, v116, v117
    s_nop 1
    v_cndmask_b32 v116, 0, v116, vcc
    v_add_f32 v119, v118, v116
    v_cvt_pk_bf16_f32 v119, v119, v119
    v_lshlrev_b32 v119, 16, v119
    v_sub_f32 v116, v119, v118
    v_mov_b32 v118, v119
    v_max_f32 v120, 0, v116
    v_sub_f32 v120, 0, v120
    v_exp_f32 v120, v120
    v_lshrrev_b32 v119, 16, v119
    v_xor_b32 v119, 0x8000, v119
    s_nop 15
    s_nop 15
    v_and_b32 v22, v119, v122
    v_mov_b32 v117, 0x41000000
    v_mul_f32 v88, v88, v120
    v_mul_f32 v89, v89, v120
    v_mul_f32 v90, v90, v120
    v_mul_f32 v91, v91, v120
    v_mul_f32 v92, v92, v120
    v_mul_f32 v93, v93, v120
    v_mul_f32 v94, v94, v120
    v_mul_f32 v95, v95, v120
    v_mul_f32 v96, v96, v120
    v_mul_f32 v97, v97, v120
    v_mul_f32 v98, v98, v120
    v_mul_f32 v99, v99, v120
    v_mul_f32 v100, v100, v120
    v_mul_f32 v101, v101, v120
    v_mul_f32 v102, v102, v120
    v_mul_f32 v103, v103, v120
    v_sub_f32 v56, v56, v116
    v_sub_f32 v57, v57, v116
    v_sub_f32 v58, v58, v116
    v_sub_f32 v59, v59, v116
    v_sub_f32 v60, v60, v116
    v_sub_f32 v61, v61, v116
    v_sub_f32 v62, v62, v116
    v_sub_f32 v63, v63, v116
    v_sub_f32 v64, v64, v116
    v_sub_f32 v65, v65, v116
    v_sub_f32 v66, v66, v116
    v_sub_f32 v67, v67, v116
    v_sub_f32 v68, v68, v116
    v_sub_f32 v69, v69, v116
    v_sub_f32 v70, v70, v116
    v_sub_f32 v71, v71, v116
    v_sub_f32 v72, v72, v116
    v_sub_f32 v73, v73, v116
    v_sub_f32 v74, v74, v116
    v_sub_f32 v75, v75, v116
    v_sub_f32 v76, v76, v116
    v_sub_f32 v77, v77, v116
    v_sub_f32 v78, v78, v116
    v_sub_f32 v79, v79, v116
    v_sub_f32 v80, v80, v116
    v_sub_f32 v81, v81, v116
    v_sub_f32 v82, v82, v116
    v_sub_f32 v83, v83, v116
    v_sub_f32 v84, v84, v116
    v_sub_f32 v85, v85, v116
    v_sub_f32 v86, v86, v116
    v_sub_f32 v87, v87, v116
    s_branch at_backl_10
at_rescl_11:
    ds_bpermute_b32 v119, v121, v116
    s_waitcnt lgkmcnt(0)
    v_max_f32 v116, v116, v119
    v_cmp_gt_f32 vcc, v116, v117
    s_nop 1
    v_cndmask_b32 v116, 0, v116, vcc
    v_add_f32 v119, v118, v116
    v_cvt_pk_bf16_f32 v119, v119, v119
    v_lshlrev_b32 v119, 16, v119
    v_sub_f32 v116, v119, v118
    v_mov_b32 v118, v119
    v_max_f32 v120, 0, v116
    v_sub_f32 v120, 0, v120
    v_exp_f32 v120, v120
    v_lshrrev_b32 v119, 16, v119
    v_xor_b32 v119, 0x8000, v119
    s_nop 15
    s_nop 15
    v_and_b32 v22, v119, v122
    v_mov_b32 v117, 0x41000000
    v_mul_f32 v88, v88, v120
    v_mul_f32 v89, v89, v120
    v_mul_f32 v90, v90, v120
    v_mul_f32 v91, v91, v120
    v_mul_f32 v92, v92, v120
    v_mul_f32 v93, v93, v120
    v_mul_f32 v94, v94, v120
    v_mul_f32 v95, v95, v120
    v_mul_f32 v96, v96, v120
    v_mul_f32 v97, v97, v120
    v_mul_f32 v98, v98, v120
    v_mul_f32 v99, v99, v120
    v_mul_f32 v100, v100, v120
    v_mul_f32 v101, v101, v120
    v_mul_f32 v102, v102, v120
    v_mul_f32 v103, v103, v120
    v_sub_f32 v72, v72, v116
    v_sub_f32 v73, v73, v116
    v_sub_f32 v74, v74, v116
    v_sub_f32 v75, v75, v116
    v_sub_f32 v76, v76, v116
    v_sub_f32 v77, v77, v116
    v_sub_f32 v78, v78, v116
    v_sub_f32 v79, v79, v116
    v_sub_f32 v80, v80, v116
    v_sub_f32 v81, v81, v116
    v_sub_f32 v82, v82, v116
    v_sub_f32 v83, v83, v116
    v_sub_f32 v84, v84, v116
    v_sub_f32 v85, v85, v116
    v_sub_f32 v86, v86, v116
    v_sub_f32 v87, v87, v116
    v_sub_f32 v56, v56, v116
    v_sub_f32 v57, v57, v116
    v_sub_f32 v58, v58, v116
    v_sub_f32 v59, v59, v116
    v_sub_f32 v60, v60, v116
    v_sub_f32 v61, v61, v116
    v_sub_f32 v62, v62, v116
    v_sub_f32 v63, v63, v116
    v_sub_f32 v64, v64, v116
    v_sub_f32 v65, v65, v116
    v_sub_f32 v66, v66, v116
    v_sub_f32 v67, v67, v116
    v_sub_f32 v68, v68, v116
    v_sub_f32 v69, v69, v116
    v_sub_f32 v70, v70, v116
    v_sub_f32 v71, v71, v116
    s_branch at_backl_11
at_rescl_12:
    ds_bpermute_b32 v119, v121, v116
    s_waitcnt lgkmcnt(0)
    v_max_f32 v116, v116, v119
    v_cmp_gt_f32 vcc, v116, v117
    s_nop 1
    v_cndmask_b32 v116, 0, v116, vcc
    v_add_f32 v119, v118, v116
    v_cvt_pk_bf16_f32 v119, v119, v119
    v_lshlrev_b32 v119, 16, v119
    v_sub_f32 v116, v119, v118
    v_mov_b32 v118, v119
    v_max_f32 v120, 0, v116
    v_sub_f32 v120, 0, v120
    v_exp_f32 v120, v120
    v_lshrrev_b32 v119, 16, v119
    v_xor_b32 v119, 0x8000, v119
    s_nop 15
    s_nop 15
    v_and_b32 v22, v119, v122
    v_mov_b32 v117, 0x41000000
    v_mul_f32 v88, v88, v120
    v_mul_f32 v89, v89, v120
    v_mul_f32 v90, v90, v120
    v_mul_f32 v91, v91, v120
    v_mul_f32 v92, v92, v120
    v_mul_f32 v93, v93, v120
    v_mul_f32 v94, v94, v120
    v_mul_f32 v95, v95, v120
    v_mul_f32 v96, v96, v120
    v_mul_f32 v97, v97, v120
    v_mul_f32 v98, v98, v120
    v_mul_f32 v99, v99, v120
    v_mul_f32 v100, v100, v120
    v_mul_f32 v101, v101, v120
    v_mul_f32 v102, v102, v120
    v_mul_f32 v103, v103, v120
    v_sub_f32 v56, v56, v116
    v_sub_f32 v57, v57, v116
    v_sub_f32 v58, v58, v116
    v_sub_f32 v59, v59, v116
    v_sub_f32 v60, v60, v116
    v_sub_f32 v61, v61, v116
    v_sub_f32 v62, v62, v116
    v_sub_f32 v63, v63, v116
    v_sub_f32 v64, v64, v116
    v_sub_f32 v65, v65, v116
    v_sub_f32 v66, v66, v116
    v_sub_f32 v67, v67, v116
    v_sub_f32 v68, v68, v116
    v_sub_f32 v69, v69, v116
    v_sub_f32 v70, v70, v116
    v_sub_f32 v71, v71, v116
    v_sub_f32 v72, v72, v116
    v_sub_f32 v73, v73, v116
    v_sub_f32 v74, v74, v116
    v_sub_f32 v75, v75, v116
    v_sub_f32 v76, v76, v116
    v_sub_f32 v77, v77, v116
    v_sub_f32 v78, v78, v116
    v_sub_f32 v79, v79, v116
    v_sub_f32 v80, v80, v116
    v_sub_f32 v81, v81, v116
    v_sub_f32 v82, v82, v116
    v_sub_f32 v83, v83, v116
    v_sub_f32 v84, v84, v116
    v_sub_f32 v85, v85, v116
    v_sub_f32 v86, v86, v116
    v_sub_f32 v87, v87, v116
    s_branch at_backl_12
at_rescl_13:
    ds_bpermute_b32 v119, v121, v116
    s_waitcnt lgkmcnt(0)
    v_max_f32 v116, v116, v119
    v_cmp_gt_f32 vcc, v116, v117
    s_nop 1
    v_cndmask_b32 v116, 0, v116, vcc
    v_add_f32 v119, v118, v116
    v_cvt_pk_bf16_f32 v119, v119, v119
    v_lshlrev_b32 v119, 16, v119
    v_sub_f32 v116, v119, v118
    v_mov_b32 v118, v119
    v_max_f32 v120, 0, v116
    v_sub_f32 v120, 0, v120
    v_exp_f32 v120, v120
    v_lshrrev_b32 v119, 16, v119
    v_xor_b32 v119, 0x8000, v119
    s_nop 15
    s_nop 15
    v_and_b32 v22, v119, v122
    v_mov_b32 v117, 0x41000000
    v_mul_f32 v88, v88, v120
    v_mul_f32 v89, v89, v120
    v_mul_f32 v90, v90, v120
    v_mul_f32 v91, v91, v120
    v_mul_f32 v92, v92, v120
    v_mul_f32 v93, v93, v120
    v_mul_f32 v94, v94, v120
    v_mul_f32 v95, v95, v120
    v_mul_f32 v96, v96, v120
    v_mul_f32 v97, v97, v120
    v_mul_f32 v98, v98, v120
    v_mul_f32 v99, v99, v120
    v_mul_f32 v100, v100, v120
    v_mul_f32 v101, v101, v120
    v_mul_f32 v102, v102, v120
    v_mul_f32 v103, v103, v120
    v_sub_f32 v72, v72, v116
    v_sub_f32 v73, v73, v116
    v_sub_f32 v74, v74, v116
    v_sub_f32 v75, v75, v116
    v_sub_f32 v76, v76, v116
    v_sub_f32 v77, v77, v116
    v_sub_f32 v78, v78, v116
    v_sub_f32 v79, v79, v116
    v_sub_f32 v80, v80, v116
    v_sub_f32 v81, v81, v116
    v_sub_f32 v82, v82, v116
    v_sub_f32 v83, v83, v116
    v_sub_f32 v84, v84, v116
    v_sub_f32 v85, v85, v116
    v_sub_f32 v86, v86, v116
    v_sub_f32 v87, v87, v116
    v_sub_f32 v56, v56, v116
    v_sub_f32 v57, v57, v116
    v_sub_f32 v58, v58, v116
    v_sub_f32 v59, v59, v116
    v_sub_f32 v60, v60, v116
    v_sub_f32 v61, v61, v116
    v_sub_f32 v62, v62, v116
    v_sub_f32 v63, v63, v116
    v_sub_f32 v64, v64, v116
    v_sub_f32 v65, v65, v116
    v_sub_f32 v66, v66, v116
    v_sub_f32 v67, v67, v116
    v_sub_f32 v68, v68, v116
    v_sub_f32 v69, v69, v116
    v_sub_f32 v70, v70, v116
    v_sub_f32 v71, v71, v116
    s_branch at_backl_13
at_rescl_14:
    ds_bpermute_b32 v119, v121, v116
    s_waitcnt lgkmcnt(0)
    v_max_f32 v116, v116, v119
    v_cmp_gt_f32 vcc, v116, v117
    s_nop 1
    v_cndmask_b32 v116, 0, v116, vcc
    v_add_f32 v119, v118, v116
    v_cvt_pk_bf16_f32 v119, v119, v119
    v_lshlrev_b32 v119, 16, v119
    v_sub_f32 v116, v119, v118
    v_mov_b32 v118, v119
    v_max_f32 v120, 0, v116
    v_sub_f32 v120, 0, v120
    v_exp_f32 v120, v120
    v_lshrrev_b32 v119, 16, v119
    v_xor_b32 v119, 0x8000, v119
    s_nop 15
    s_nop 15
    v_and_b32 v22, v119, v122
    v_mov_b32 v117, 0x41000000
    v_mul_f32 v88, v88, v120
    v_mul_f32 v89, v89, v120
    v_mul_f32 v90, v90, v120
    v_mul_f32 v91, v91, v120
    v_mul_f32 v92, v92, v120
    v_mul_f32 v93, v93, v120
    v_mul_f32 v94, v94, v120
    v_mul_f32 v95, v95, v120
    v_mul_f32 v96, v96, v120
    v_mul_f32 v97, v97, v120
    v_mul_f32 v98, v98, v120
    v_mul_f32 v99, v99, v120
    v_mul_f32 v100, v100, v120
    v_mul_f32 v101, v101, v120
    v_mul_f32 v102, v102, v120
    v_mul_f32 v103, v103, v120
    v_sub_f32 v56, v56, v116
    v_sub_f32 v57, v57, v116
    v_sub_f32 v58, v58, v116
    v_sub_f32 v59, v59, v116
    v_sub_f32 v60, v60, v116
    v_sub_f32 v61, v61, v116
    v_sub_f32 v62, v62, v116
    v_sub_f32 v63, v63, v116
    v_sub_f32 v64, v64, v116
    v_sub_f32 v65, v65, v116
    v_sub_f32 v66, v66, v116
    v_sub_f32 v67, v67, v116
    v_sub_f32 v68, v68, v116
    v_sub_f32 v69, v69, v116
    v_sub_f32 v70, v70, v116
    v_sub_f32 v71, v71, v116
    v_sub_f32 v72, v72, v116
    v_sub_f32 v73, v73, v116
    v_sub_f32 v74, v74, v116
    v_sub_f32 v75, v75, v116
    v_sub_f32 v76, v76, v116
    v_sub_f32 v77, v77, v116
    v_sub_f32 v78, v78, v116
    v_sub_f32 v79, v79, v116
    v_sub_f32 v80, v80, v116
    v_sub_f32 v81, v81, v116
    v_sub_f32 v82, v82, v116
    v_sub_f32 v83, v83, v116
    v_sub_f32 v84, v84, v116
    v_sub_f32 v85, v85, v116
    v_sub_f32 v86, v86, v116
    v_sub_f32 v87, v87, v116
    s_branch at_backl_14
at_rescl_15:
    ds_bpermute_b32 v119, v121, v116
    s_waitcnt lgkmcnt(0)
    v_max_f32 v116, v116, v119
    v_cmp_gt_f32 vcc, v116, v117
    s_nop 1
    v_cndmask_b32 v116, 0, v116, vcc
    v_add_f32 v119, v118, v116
    v_cvt_pk_bf16_f32 v119, v119, v119
    v_lshlrev_b32 v119, 16, v119
    v_sub_f32 v116, v119, v118
    v_mov_b32 v118, v119
    v_max_f32 v120, 0, v116
    v_sub_f32 v120, 0, v120
    v_exp_f32 v120, v120
    v_lshrrev_b32 v119, 16, v119
    v_xor_b32 v119, 0x8000, v119
    s_nop 15
    s_nop 15
    v_and_b32 v22, v119, v122
    v_mov_b32 v117, 0x41000000
    v_mul_f32 v88, v88, v120
    v_mul_f32 v89, v89, v120
    v_mul_f32 v90, v90, v120
    v_mul_f32 v91, v91, v120
    v_mul_f32 v92, v92, v120
    v_mul_f32 v93, v93, v120
    v_mul_f32 v94, v94, v120
    v_mul_f32 v95, v95, v120
    v_mul_f32 v96, v96, v120
    v_mul_f32 v97, v97, v120
    v_mul_f32 v98, v98, v120
    v_mul_f32 v99, v99, v120
    v_mul_f32 v100, v100, v120
    v_mul_f32 v101, v101, v120
    v_mul_f32 v102, v102, v120
    v_mul_f32 v103, v103, v120
    v_sub_f32 v72, v72, v116
    v_sub_f32 v73, v73, v116
    v_sub_f32 v74, v74, v116
    v_sub_f32 v75, v75, v116
    v_sub_f32 v76, v76, v116
    v_sub_f32 v77, v77, v116
    v_sub_f32 v78, v78, v116
    v_sub_f32 v79, v79, v116
    v_sub_f32 v80, v80, v116
    v_sub_f32 v81, v81, v116
    v_sub_f32 v82, v82, v116
    v_sub_f32 v83, v83, v116
    v_sub_f32 v84, v84, v116
    v_sub_f32 v85, v85, v116
    v_sub_f32 v86, v86, v116
    v_sub_f32 v87, v87, v116
    v_sub_f32 v56, v56, v116
    v_sub_f32 v57, v57, v116
    v_sub_f32 v58, v58, v116
    v_sub_f32 v59, v59, v116
    v_sub_f32 v60, v60, v116
    v_sub_f32 v61, v61, v116
    v_sub_f32 v62, v62, v116
    v_sub_f32 v63, v63, v116
    v_sub_f32 v64, v64, v116
    v_sub_f32 v65, v65, v116
    v_sub_f32 v66, v66, v116
    v_sub_f32 v67, v67, v116
    v_sub_f32 v68, v68, v116
    v_sub_f32 v69, v69, v116
    v_sub_f32 v70, v70, v116
    v_sub_f32 v71, v71, v116
    s_branch at_backl_15
at_rescf_0:
    ds_bpermute_b32 v119, v121, v116
    s_waitcnt lgkmcnt(0)
    v_max_f32 v116, v116, v119
    v_cmp_gt_f32 vcc, v116, v117
    s_nop 1
    v_cndmask_b32 v116, 0, v116, vcc
    v_add_f32 v119, v118, v116
    v_cvt_pk_bf16_f32 v119, v119, v119
    v_lshlrev_b32 v119, 16, v119
    v_sub_f32 v116, v119, v118
    v_mov_b32 v118, v119
    v_max_f32 v120, 0, v116
    v_sub_f32 v120, 0, v120
    v_exp_f32 v120, v120
    v_lshrrev_b32 v119, 16, v119
    v_xor_b32 v119, 0x8000, v119
    s_nop 15
    s_nop 15
    v_and_b32 v22, v119, v122
    v_mov_b32 v117, 0x41000000
    v_mul_f32 v88, v88, v120
    v_mul_f32 v89, v89, v120
    v_mul_f32 v90, v90, v120
    v_mul_f32 v91, v91, v120
    v_mul_f32 v92, v92, v120
    v_mul_f32 v93, v93, v120
    v_mul_f32 v94, v94, v120
    v_mul_f32 v95, v95, v120
    v_mul_f32 v96, v96, v120
    v_mul_f32 v97, v97, v120
    v_mul_f32 v98, v98, v120
    v_mul_f32 v99, v99, v120
    v_mul_f32 v100, v100, v120
    v_mul_f32 v101, v101, v120
    v_mul_f32 v102, v102, v120
    v_mul_f32 v103, v103, v120
    v_sub_f32 v56, v56, v116
    v_sub_f32 v57, v57, v116
    v_sub_f32 v58, v58, v116
    v_sub_f32 v59, v59, v116
    v_sub_f32 v60, v60, v116
    v_sub_f32 v61, v61, v116
    v_sub_f32 v62, v62, v116
    v_sub_f32 v63, v63, v116
    v_sub_f32 v64, v64, v116
    v_sub_f32 v65, v65, v116
    v_sub_f32 v66, v66, v116
    v_sub_f32 v67, v67, v116
    v_sub_f32 v68, v68, v116
    v_sub_f32 v69, v69, v116
    v_sub_f32 v70, v70, v116
    v_sub_f32 v71, v71, v116
    v_sub_f32 v72, v72, v116
    v_sub_f32 v73, v73, v116
    v_sub_f32 v74, v74, v116
    v_sub_f32 v75, v75, v116
    v_sub_f32 v76, v76, v116
    v_sub_f32 v77, v77, v116
    v_sub_f32 v78, v78, v116
    v_sub_f32 v79, v79, v116
    v_sub_f32 v80, v80, v116
    v_sub_f32 v81, v81, v116
    v_sub_f32 v82, v82, v116
    v_sub_f32 v83, v83, v116
    v_sub_f32 v84, v84, v116
    v_sub_f32 v85, v85, v116
    v_sub_f32 v86, v86, v116
    v_sub_f32 v87, v87, v116
    s_branch at_backf_0
at_rescf_1:
    ds_bpermute_b32 v119, v121, v116
    s_waitcnt lgkmcnt(0)
    v_max_f32 v116, v116, v119
    v_cmp_gt_f32 vcc, v116, v117
    s_nop 1
    v_cndmask_b32 v116, 0, v116, vcc
    v_add_f32 v119, v118, v116
    v_cvt_pk_bf16_f32 v119, v119, v119
    v_lshlrev_b32 v119, 16, v119
    v_sub_f32 v116, v119, v118
    v_mov_b32 v118, v119
    v_max_f32 v120, 0, v116
    v_sub_f32 v120, 0, v120
    v_exp_f32 v120, v120
    v_lshrrev_b32 v119, 16, v119
    v_xor_b32 v119, 0x8000, v119
    s_nop 15
    s_nop 15
    v_and_b32 v22, v119, v122
    v_mov_b32 v117, 0x41000000
    v_mul_f32 v88, v88, v120
    v_mul_f32 v89, v89, v120
    v_mul_f32 v90, v90, v120
    v_mul_f32 v91, v91, v120
    v_mul_f32 v92, v92, v120
    v_mul_f32 v93, v93, v120
    v_mul_f32 v94, v94, v120
    v_mul_f32 v95, v95, v120
    v_mul_f32 v96, v96, v120
    v_mul_f32 v97, v97, v120
    v_mul_f32 v98, v98, v120
    v_mul_f32 v99, v99, v120
    v_mul_f32 v100, v100, v120
    v_mul_f32 v101, v101, v120
    v_mul_f32 v102, v102, v120
    v_mul_f32 v103, v103, v120
    v_sub_f32 v72, v72, v116
    v_sub_f32 v73, v73, v116
    v_sub_f32 v74, v74, v116
    v_sub_f32 v75, v75, v116
    v_sub_f32 v76, v76, v116
    v_sub_f32 v77, v77, v116
    v_sub_f32 v78, v78, v116
    v_sub_f32 v79, v79, v116
    v_sub_f32 v80, v80, v116
    v_sub_f32 v81, v81, v116
    v_sub_f32 v82, v82, v116
    v_sub_f32 v83, v83, v116
    v_sub_f32 v84, v84, v116
    v_sub_f32 v85, v85, v116
    v_sub_f32 v86, v86, v116
    v_sub_f32 v87, v87, v116
    v_sub_f32 v56, v56, v116
    v_sub_f32 v57, v57, v116
    v_sub_f32 v58, v58, v116
    v_sub_f32 v59, v59, v116
    v_sub_f32 v60, v60, v116
    v_sub_f32 v61, v61, v116
    v_sub_f32 v62, v62, v116
    v_sub_f32 v63, v63, v116
    v_sub_f32 v64, v64, v116
    v_sub_f32 v65, v65, v116
    v_sub_f32 v66, v66, v116
    v_sub_f32 v67, v67, v116
    v_sub_f32 v68, v68, v116
    v_sub_f32 v69, v69, v116
    v_sub_f32 v70, v70, v116
    v_sub_f32 v71, v71, v116
    s_branch at_backf_1
at_rescf_2:
    ds_bpermute_b32 v119, v121, v116
    s_waitcnt lgkmcnt(0)
    v_max_f32 v116, v116, v119
    v_cmp_gt_f32 vcc, v116, v117
    s_nop 1
    v_cndmask_b32 v116, 0, v116, vcc
    v_add_f32 v119, v118, v116
    v_cvt_pk_bf16_f32 v119, v119, v119
    v_lshlrev_b32 v119, 16, v119
    v_sub_f32 v116, v119, v118
    v_mov_b32 v118, v119
    v_max_f32 v120, 0, v116
    v_sub_f32 v120, 0, v120
    v_exp_f32 v120, v120
    v_lshrrev_b32 v119, 16, v119
    v_xor_b32 v119, 0x8000, v119
    s_nop 15
    s_nop 15
    v_and_b32 v22, v119, v122
    v_mov_b32 v117, 0x41000000
    v_mul_f32 v88, v88, v120
    v_mul_f32 v89, v89, v120
    v_mul_f32 v90, v90, v120
    v_mul_f32 v91, v91, v120
    v_mul_f32 v92, v92, v120
    v_mul_f32 v93, v93, v120
    v_mul_f32 v94, v94, v120
    v_mul_f32 v95, v95, v120
    v_mul_f32 v96, v96, v120
    v_mul_f32 v97, v97, v120
    v_mul_f32 v98, v98, v120
    v_mul_f32 v99, v99, v120
    v_mul_f32 v100, v100, v120
    v_mul_f32 v101, v101, v120
    v_mul_f32 v102, v102, v120
    v_mul_f32 v103, v103, v120
    v_sub_f32 v56, v56, v116
    v_sub_f32 v57, v57, v116
    v_sub_f32 v58, v58, v116
    v_sub_f32 v59, v59, v116
    v_sub_f32 v60, v60, v116
    v_sub_f32 v61, v61, v116
    v_sub_f32 v62, v62, v116
    v_sub_f32 v63, v63, v116
    v_sub_f32 v64, v64, v116
    v_sub_f32 v65, v65, v116
    v_sub_f32 v66, v66, v116
    v_sub_f32 v67, v67, v116
    v_sub_f32 v68, v68, v116
    v_sub_f32 v69, v69, v116
    v_sub_f32 v70, v70, v116
    v_sub_f32 v71, v71, v116
    v_sub_f32 v72, v72, v116
    v_sub_f32 v73, v73, v116
    v_sub_f32 v74, v74, v116
    v_sub_f32 v75, v75, v116
    v_sub_f32 v76, v76, v116
    v_sub_f32 v77, v77, v116
    v_sub_f32 v78, v78, v116
    v_sub_f32 v79, v79, v116
    v_sub_f32 v80, v80, v116
    v_sub_f32 v81, v81, v116
    v_sub_f32 v82, v82, v116
    v_sub_f32 v83, v83, v116
    v_sub_f32 v84, v84, v116
    v_sub_f32 v85, v85, v116
    v_sub_f32 v86, v86, v116
    v_sub_f32 v87, v87, v116
    s_branch at_backf_2
at_rescf_3:
    ds_bpermute_b32 v119, v121, v116
    s_waitcnt lgkmcnt(0)
    v_max_f32 v116, v116, v119
    v_cmp_gt_f32 vcc, v116, v117
    s_nop 1
    v_cndmask_b32 v116, 0, v116, vcc
    v_add_f32 v119, v118, v116
    v_cvt_pk_bf16_f32 v119, v119, v119
    v_lshlrev_b32 v119, 16, v119
    v_sub_f32 v116, v119, v118
    v_mov_b32 v118, v119
    v_max_f32 v120, 0, v116
    v_sub_f32 v120, 0, v120
    v_exp_f32 v120, v120
    v_lshrrev_b32 v119, 16, v119
    v_xor_b32 v119, 0x8000, v119
    s_nop 15
    s_nop 15
    v_and_b32 v22, v119, v122
    v_mov_b32 v117, 0x41000000
    v_mul_f32 v88, v88, v120
    v_mul_f32 v89, v89, v120
    v_mul_f32 v90, v90, v120
    v_mul_f32 v91, v91, v120
    v_mul_f32 v92, v92, v120
    v_mul_f32 v93, v93, v120
    v_mul_f32 v94, v94, v120
    v_mul_f32 v95, v95, v120
    v_mul_f32 v96, v96, v120
    v_mul_f32 v97, v97, v120
    v_mul_f32 v98, v98, v120
    v_mul_f32 v99, v99, v120
    v_mul_f32 v100, v100, v120
    v_mul_f32 v101, v101, v120
    v_mul_f32 v102, v102, v120
    v_mul_f32 v103, v103, v120
    v_sub_f32 v72, v72, v116
    v_sub_f32 v73, v73, v116
    v_sub_f32 v74, v74, v116
    v_sub_f32 v75, v75, v116
    v_sub_f32 v76, v76, v116
    v_sub_f32 v77, v77, v116
    v_sub_f32 v78, v78, v116
    v_sub_f32 v79, v79, v116
    v_sub_f32 v80, v80, v116
    v_sub_f32 v81, v81, v116
    v_sub_f32 v82, v82, v116
    v_sub_f32 v83, v83, v116
    v_sub_f32 v84, v84, v116
    v_sub_f32 v85, v85, v116
    v_sub_f32 v86, v86, v116
    v_sub_f32 v87, v87, v116
    v_sub_f32 v56, v56, v116
    v_sub_f32 v57, v57, v116
    v_sub_f32 v58, v58, v116
    v_sub_f32 v59, v59, v116
    v_sub_f32 v60, v60, v116
    v_sub_f32 v61, v61, v116
    v_sub_f32 v62, v62, v116
    v_sub_f32 v63, v63, v116
    v_sub_f32 v64, v64, v116
    v_sub_f32 v65, v65, v116
    v_sub_f32 v66, v66, v116
    v_sub_f32 v67, v67, v116
    v_sub_f32 v68, v68, v116
    v_sub_f32 v69, v69, v116
    v_sub_f32 v70, v70, v116
    v_sub_f32 v71, v71, v116
    s_branch at_backf_3
at_rescf_4:
    ds_bpermute_b32 v119, v121, v116
    s_waitcnt lgkmcnt(0)
    v_max_f32 v116, v116, v119
    v_cmp_gt_f32 vcc, v116, v117
    s_nop 1
    v_cndmask_b32 v116, 0, v116, vcc
    v_add_f32 v119, v118, v116
    v_cvt_pk_bf16_f32 v119, v119, v119
    v_lshlrev_b32 v119, 16, v119
    v_sub_f32 v116, v119, v118
    v_mov_b32 v118, v119
    v_max_f32 v120, 0, v116
    v_sub_f32 v120, 0, v120
    v_exp_f32 v120, v120
    v_lshrrev_b32 v119, 16, v119
    v_xor_b32 v119, 0x8000, v119
    s_nop 15
    s_nop 15
    v_and_b32 v22, v119, v122
    v_mov_b32 v117, 0x41000000
    v_mul_f32 v88, v88, v120
    v_mul_f32 v89, v89, v120
    v_mul_f32 v90, v90, v120
    v_mul_f32 v91, v91, v120
    v_mul_f32 v92, v92, v120
    v_mul_f32 v93, v93, v120
    v_mul_f32 v94, v94, v120
    v_mul_f32 v95, v95, v120
    v_mul_f32 v96, v96, v120
    v_mul_f32 v97, v97, v120
    v_mul_f32 v98, v98, v120
    v_mul_f32 v99, v99, v120
    v_mul_f32 v100, v100, v120
    v_mul_f32 v101, v101, v120
    v_mul_f32 v102, v102, v120
    v_mul_f32 v103, v103, v120
    v_sub_f32 v56, v56, v116
    v_sub_f32 v57, v57, v116
    v_sub_f32 v58, v58, v116
    v_sub_f32 v59, v59, v116
    v_sub_f32 v60, v60, v116
    v_sub_f32 v61, v61, v116
    v_sub_f32 v62, v62, v116
    v_sub_f32 v63, v63, v116
    v_sub_f32 v64, v64, v116
    v_sub_f32 v65, v65, v116
    v_sub_f32 v66, v66, v116
    v_sub_f32 v67, v67, v116
    v_sub_f32 v68, v68, v116
    v_sub_f32 v69, v69, v116
    v_sub_f32 v70, v70, v116
    v_sub_f32 v71, v71, v116
    v_sub_f32 v72, v72, v116
    v_sub_f32 v73, v73, v116
    v_sub_f32 v74, v74, v116
    v_sub_f32 v75, v75, v116
    v_sub_f32 v76, v76, v116
    v_sub_f32 v77, v77, v116
    v_sub_f32 v78, v78, v116
    v_sub_f32 v79, v79, v116
    v_sub_f32 v80, v80, v116
    v_sub_f32 v81, v81, v116
    v_sub_f32 v82, v82, v116
    v_sub_f32 v83, v83, v116
    v_sub_f32 v84, v84, v116
    v_sub_f32 v85, v85, v116
    v_sub_f32 v86, v86, v116
    v_sub_f32 v87, v87, v116
    s_branch at_backf_4
at_rescf_5:
    ds_bpermute_b32 v119, v121, v116
    s_waitcnt lgkmcnt(0)
    v_max_f32 v116, v116, v119
    v_cmp_gt_f32 vcc, v116, v117
    s_nop 1
    v_cndmask_b32 v116, 0, v116, vcc
    v_add_f32 v119, v118, v116
    v_cvt_pk_bf16_f32 v119, v119, v119
    v_lshlrev_b32 v119, 16, v119
    v_sub_f32 v116, v119, v118
    v_mov_b32 v118, v119
    v_max_f32 v120, 0, v116
    v_sub_f32 v120, 0, v120
    v_exp_f32 v120, v120
    v_lshrrev_b32 v119, 16, v119
    v_xor_b32 v119, 0x8000, v119
    s_nop 15
    s_nop 15
    v_and_b32 v22, v119, v122
    v_mov_b32 v117, 0x41000000
    v_mul_f32 v88, v88, v120
    v_mul_f32 v89, v89, v120
    v_mul_f32 v90, v90, v120
    v_mul_f32 v91, v91, v120
    v_mul_f32 v92, v92, v120
    v_mul_f32 v93, v93, v120
    v_mul_f32 v94, v94, v120
    v_mul_f32 v95, v95, v120
    v_mul_f32 v96, v96, v120
    v_mul_f32 v97, v97, v120
    v_mul_f32 v98, v98, v120
    v_mul_f32 v99, v99, v120
    v_mul_f32 v100, v100, v120
    v_mul_f32 v101, v101, v120
    v_mul_f32 v102, v102, v120
    v_mul_f32 v103, v103, v120
    v_sub_f32 v72, v72, v116
    v_sub_f32 v73, v73, v116
    v_sub_f32 v74, v74, v116
    v_sub_f32 v75, v75, v116
    v_sub_f32 v76, v76, v116
    v_sub_f32 v77, v77, v116
    v_sub_f32 v78, v78, v116
    v_sub_f32 v79, v79, v116
    v_sub_f32 v80, v80, v116
    v_sub_f32 v81, v81, v116
    v_sub_f32 v82, v82, v116
    v_sub_f32 v83, v83, v116
    v_sub_f32 v84, v84, v116
    v_sub_f32 v85, v85, v116
    v_sub_f32 v86, v86, v116
    v_sub_f32 v87, v87, v116
    v_sub_f32 v56, v56, v116
    v_sub_f32 v57, v57, v116
    v_sub_f32 v58, v58, v116
    v_sub_f32 v59, v59, v116
    v_sub_f32 v60, v60, v116
    v_sub_f32 v61, v61, v116
    v_sub_f32 v62, v62, v116
    v_sub_f32 v63, v63, v116
    v_sub_f32 v64, v64, v116
    v_sub_f32 v65, v65, v116
    v_sub_f32 v66, v66, v116
    v_sub_f32 v67, v67, v116
    v_sub_f32 v68, v68, v116
    v_sub_f32 v69, v69, v116
    v_sub_f32 v70, v70, v116
    v_sub_f32 v71, v71, v116
    s_branch at_backf_5
at_rescf_6:
    ds_bpermute_b32 v119, v121, v116
    s_waitcnt lgkmcnt(0)
    v_max_f32 v116, v116, v119
    v_cmp_gt_f32 vcc, v116, v117
    s_nop 1
    v_cndmask_b32 v116, 0, v116, vcc
    v_add_f32 v119, v118, v116
    v_cvt_pk_bf16_f32 v119, v119, v119
    v_lshlrev_b32 v119, 16, v119
    v_sub_f32 v116, v119, v118
    v_mov_b32 v118, v119
    v_max_f32 v120, 0, v116
    v_sub_f32 v120, 0, v120
    v_exp_f32 v120, v120
    v_lshrrev_b32 v119, 16, v119
    v_xor_b32 v119, 0x8000, v119
    s_nop 15
    s_nop 15
    v_and_b32 v22, v119, v122
    v_mov_b32 v117, 0x41000000
    v_mul_f32 v88, v88, v120
    v_mul_f32 v89, v89, v120
    v_mul_f32 v90, v90, v120
    v_mul_f32 v91, v91, v120
    v_mul_f32 v92, v92, v120
    v_mul_f32 v93, v93, v120
    v_mul_f32 v94, v94, v120
    v_mul_f32 v95, v95, v120
    v_mul_f32 v96, v96, v120
    v_mul_f32 v97, v97, v120
    v_mul_f32 v98, v98, v120
    v_mul_f32 v99, v99, v120
    v_mul_f32 v100, v100, v120
    v_mul_f32 v101, v101, v120
    v_mul_f32 v102, v102, v120
    v_mul_f32 v103, v103, v120
    v_sub_f32 v56, v56, v116
    v_sub_f32 v57, v57, v116
    v_sub_f32 v58, v58, v116
    v_sub_f32 v59, v59, v116
    v_sub_f32 v60, v60, v116
    v_sub_f32 v61, v61, v116
    v_sub_f32 v62, v62, v116
    v_sub_f32 v63, v63, v116
    v_sub_f32 v64, v64, v116
    v_sub_f32 v65, v65, v116
    v_sub_f32 v66, v66, v116
    v_sub_f32 v67, v67, v116
    v_sub_f32 v68, v68, v116
    v_sub_f32 v69, v69, v116
    v_sub_f32 v70, v70, v116
    v_sub_f32 v71, v71, v116
    v_sub_f32 v72, v72, v116
    v_sub_f32 v73, v73, v116
    v_sub_f32 v74, v74, v116
    v_sub_f32 v75, v75, v116
    v_sub_f32 v76, v76, v116
    v_sub_f32 v77, v77, v116
    v_sub_f32 v78, v78, v116
    v_sub_f32 v79, v79, v116
    v_sub_f32 v80, v80, v116
    v_sub_f32 v81, v81, v116
    v_sub_f32 v82, v82, v116
    v_sub_f32 v83, v83, v116
    v_sub_f32 v84, v84, v116
    v_sub_f32 v85, v85, v116
    v_sub_f32 v86, v86, v116
    v_sub_f32 v87, v87, v116
    s_branch at_backf_6
at_rescf_7:
    ds_bpermute_b32 v119, v121, v116
    s_waitcnt lgkmcnt(0)
    v_max_f32 v116, v116, v119
    v_cmp_gt_f32 vcc, v116, v117
    s_nop 1
    v_cndmask_b32 v116, 0, v116, vcc
    v_add_f32 v119, v118, v116
    v_cvt_pk_bf16_f32 v119, v119, v119
    v_lshlrev_b32 v119, 16, v119
    v_sub_f32 v116, v119, v118
    v_mov_b32 v118, v119
    v_max_f32 v120, 0, v116
    v_sub_f32 v120, 0, v120
    v_exp_f32 v120, v120
    v_lshrrev_b32 v119, 16, v119
    v_xor_b32 v119, 0x8000, v119
    s_nop 15
    s_nop 15
    v_and_b32 v22, v119, v122
    v_mov_b32 v117, 0x41000000
    v_mul_f32 v88, v88, v120
    v_mul_f32 v89, v89, v120
    v_mul_f32 v90, v90, v120
    v_mul_f32 v91, v91, v120
    v_mul_f32 v92, v92, v120
    v_mul_f32 v93, v93, v120
    v_mul_f32 v94, v94, v120
    v_mul_f32 v95, v95, v120
    v_mul_f32 v96, v96, v120
    v_mul_f32 v97, v97, v120
    v_mul_f32 v98, v98, v120
    v_mul_f32 v99, v99, v120
    v_mul_f32 v100, v100, v120
    v_mul_f32 v101, v101, v120
    v_mul_f32 v102, v102, v120
    v_mul_f32 v103, v103, v120
    v_sub_f32 v72, v72, v116
    v_sub_f32 v73, v73, v116
    v_sub_f32 v74, v74, v116
    v_sub_f32 v75, v75, v116
    v_sub_f32 v76, v76, v116
    v_sub_f32 v77, v77, v116
    v_sub_f32 v78, v78, v116
    v_sub_f32 v79, v79, v116
    v_sub_f32 v80, v80, v116
    v_sub_f32 v81, v81, v116
    v_sub_f32 v82, v82, v116
    v_sub_f32 v83, v83, v116
    v_sub_f32 v84, v84, v116
    v_sub_f32 v85, v85, v116
    v_sub_f32 v86, v86, v116
    v_sub_f32 v87, v87, v116
    v_sub_f32 v56, v56, v116
    v_sub_f32 v57, v57, v116
    v_sub_f32 v58, v58, v116
    v_sub_f32 v59, v59, v116
    v_sub_f32 v60, v60, v116
    v_sub_f32 v61, v61, v116
    v_sub_f32 v62, v62, v116
    v_sub_f32 v63, v63, v116
    v_sub_f32 v64, v64, v116
    v_sub_f32 v65, v65, v116
    v_sub_f32 v66, v66, v116
    v_sub_f32 v67, v67, v116
    v_sub_f32 v68, v68, v116
    v_sub_f32 v69, v69, v116
    v_sub_f32 v70, v70, v116
    v_sub_f32 v71, v71, v116
    s_branch at_backf_7
at_rescf_8:
    ds_bpermute_b32 v119, v121, v116
    s_waitcnt lgkmcnt(0)
    v_max_f32 v116, v116, v119
    v_cmp_gt_f32 vcc, v116, v117
    s_nop 1
    v_cndmask_b32 v116, 0, v116, vcc
    v_add_f32 v119, v118, v116
    v_cvt_pk_bf16_f32 v119, v119, v119
    v_lshlrev_b32 v119, 16, v119
    v_sub_f32 v116, v119, v118
    v_mov_b32 v118, v119
    v_max_f32 v120, 0, v116
    v_sub_f32 v120, 0, v120
    v_exp_f32 v120, v120
    v_lshrrev_b32 v119, 16, v119
    v_xor_b32 v119, 0x8000, v119
    s_nop 15
    s_nop 15
    v_and_b32 v22, v119, v122
    v_mov_b32 v117, 0x41000000
    v_mul_f32 v88, v88, v120
    v_mul_f32 v89, v89, v120
    v_mul_f32 v90, v90, v120
    v_mul_f32 v91, v91, v120
    v_mul_f32 v92, v92, v120
    v_mul_f32 v93, v93, v120
    v_mul_f32 v94, v94, v120
    v_mul_f32 v95, v95, v120
    v_mul_f32 v96, v96, v120
    v_mul_f32 v97, v97, v120
    v_mul_f32 v98, v98, v120
    v_mul_f32 v99, v99, v120
    v_mul_f32 v100, v100, v120
    v_mul_f32 v101, v101, v120
    v_mul_f32 v102, v102, v120
    v_mul_f32 v103, v103, v120
    v_sub_f32 v56, v56, v116
    v_sub_f32 v57, v57, v116
    v_sub_f32 v58, v58, v116
    v_sub_f32 v59, v59, v116
    v_sub_f32 v60, v60, v116
    v_sub_f32 v61, v61, v116
    v_sub_f32 v62, v62, v116
    v_sub_f32 v63, v63, v116
    v_sub_f32 v64, v64, v116
    v_sub_f32 v65, v65, v116
    v_sub_f32 v66, v66, v116
    v_sub_f32 v67, v67, v116
    v_sub_f32 v68, v68, v116
    v_sub_f32 v69, v69, v116
    v_sub_f32 v70, v70, v116
    v_sub_f32 v71, v71, v116
    v_sub_f32 v72, v72, v116
    v_sub_f32 v73, v73, v116
    v_sub_f32 v74, v74, v116
    v_sub_f32 v75, v75, v116
    v_sub_f32 v76, v76, v116
    v_sub_f32 v77, v77, v116
    v_sub_f32 v78, v78, v116
    v_sub_f32 v79, v79, v116
    v_sub_f32 v80, v80, v116
    v_sub_f32 v81, v81, v116
    v_sub_f32 v82, v82, v116
    v_sub_f32 v83, v83, v116
    v_sub_f32 v84, v84, v116
    v_sub_f32 v85, v85, v116
    v_sub_f32 v86, v86, v116
    v_sub_f32 v87, v87, v116
    s_branch at_backf_8
at_rescf_9:
    ds_bpermute_b32 v119, v121, v116
    s_waitcnt lgkmcnt(0)
    v_max_f32 v116, v116, v119
    v_cmp_gt_f32 vcc, v116, v117
    s_nop 1
    v_cndmask_b32 v116, 0, v116, vcc
    v_add_f32 v119, v118, v116
    v_cvt_pk_bf16_f32 v119, v119, v119
    v_lshlrev_b32 v119, 16, v119
    v_sub_f32 v116, v119, v118
    v_mov_b32 v118, v119
    v_max_f32 v120, 0, v116
    v_sub_f32 v120, 0, v120
    v_exp_f32 v120, v120
    v_lshrrev_b32 v119, 16, v119
    v_xor_b32 v119, 0x8000, v119
    s_nop 15
    s_nop 15
    v_and_b32 v22, v119, v122
    v_mov_b32 v117, 0x41000000
    v_mul_f32 v88, v88, v120
    v_mul_f32 v89, v89, v120
    v_mul_f32 v90, v90, v120
    v_mul_f32 v91, v91, v120
    v_mul_f32 v92, v92, v120
    v_mul_f32 v93, v93, v120
    v_mul_f32 v94, v94, v120
    v_mul_f32 v95, v95, v120
    v_mul_f32 v96, v96, v120
    v_mul_f32 v97, v97, v120
    v_mul_f32 v98, v98, v120
    v_mul_f32 v99, v99, v120
    v_mul_f32 v100, v100, v120
    v_mul_f32 v101, v101, v120
    v_mul_f32 v102, v102, v120
    v_mul_f32 v103, v103, v120
    v_sub_f32 v72, v72, v116
    v_sub_f32 v73, v73, v116
    v_sub_f32 v74, v74, v116
    v_sub_f32 v75, v75, v116
    v_sub_f32 v76, v76, v116
    v_sub_f32 v77, v77, v116
    v_sub_f32 v78, v78, v116
    v_sub_f32 v79, v79, v116
    v_sub_f32 v80, v80, v116
    v_sub_f32 v81, v81, v116
    v_sub_f32 v82, v82, v116
    v_sub_f32 v83, v83, v116
    v_sub_f32 v84, v84, v116
    v_sub_f32 v85, v85, v116
    v_sub_f32 v86, v86, v116
    v_sub_f32 v87, v87, v116
    v_sub_f32 v56, v56, v116
    v_sub_f32 v57, v57, v116
    v_sub_f32 v58, v58, v116
    v_sub_f32 v59, v59, v116
    v_sub_f32 v60, v60, v116
    v_sub_f32 v61, v61, v116
    v_sub_f32 v62, v62, v116
    v_sub_f32 v63, v63, v116
    v_sub_f32 v64, v64, v116
    v_sub_f32 v65, v65, v116
    v_sub_f32 v66, v66, v116
    v_sub_f32 v67, v67, v116
    v_sub_f32 v68, v68, v116
    v_sub_f32 v69, v69, v116
    v_sub_f32 v70, v70, v116
    v_sub_f32 v71, v71, v116
    s_branch at_backf_9
at_rescf_10:
    ds_bpermute_b32 v119, v121, v116
    s_waitcnt lgkmcnt(0)
    v_max_f32 v116, v116, v119
    v_cmp_gt_f32 vcc, v116, v117
    s_nop 1
    v_cndmask_b32 v116, 0, v116, vcc
    v_add_f32 v119, v118, v116
    v_cvt_pk_bf16_f32 v119, v119, v119
    v_lshlrev_b32 v119, 16, v119
    v_sub_f32 v116, v119, v118
    v_mov_b32 v118, v119
    v_max_f32 v120, 0, v116
    v_sub_f32 v120, 0, v120
    v_exp_f32 v120, v120
    v_lshrrev_b32 v119, 16, v119
    v_xor_b32 v119, 0x8000, v119
    s_nop 15
    s_nop 15
    v_and_b32 v22, v119, v122
    v_mov_b32 v117, 0x41000000
    v_mul_f32 v88, v88, v120
    v_mul_f32 v89, v89, v120
    v_mul_f32 v90, v90, v120
    v_mul_f32 v91, v91, v120
    v_mul_f32 v92, v92, v120
    v_mul_f32 v93, v93, v120
    v_mul_f32 v94, v94, v120
    v_mul_f32 v95, v95, v120
    v_mul_f32 v96, v96, v120
    v_mul_f32 v97, v97, v120
    v_mul_f32 v98, v98, v120
    v_mul_f32 v99, v99, v120
    v_mul_f32 v100, v100, v120
    v_mul_f32 v101, v101, v120
    v_mul_f32 v102, v102, v120
    v_mul_f32 v103, v103, v120
    v_sub_f32 v56, v56, v116
    v_sub_f32 v57, v57, v116
    v_sub_f32 v58, v58, v116
    v_sub_f32 v59, v59, v116
    v_sub_f32 v60, v60, v116
    v_sub_f32 v61, v61, v116
    v_sub_f32 v62, v62, v116
    v_sub_f32 v63, v63, v116
    v_sub_f32 v64, v64, v116
    v_sub_f32 v65, v65, v116
    v_sub_f32 v66, v66, v116
    v_sub_f32 v67, v67, v116
    v_sub_f32 v68, v68, v116
    v_sub_f32 v69, v69, v116
    v_sub_f32 v70, v70, v116
    v_sub_f32 v71, v71, v116
    v_sub_f32 v72, v72, v116
    v_sub_f32 v73, v73, v116
    v_sub_f32 v74, v74, v116
    v_sub_f32 v75, v75, v116
    v_sub_f32 v76, v76, v116
    v_sub_f32 v77, v77, v116
    v_sub_f32 v78, v78, v116
    v_sub_f32 v79, v79, v116
    v_sub_f32 v80, v80, v116
    v_sub_f32 v81, v81, v116
    v_sub_f32 v82, v82, v116
    v_sub_f32 v83, v83, v116
    v_sub_f32 v84, v84, v116
    v_sub_f32 v85, v85, v116
    v_sub_f32 v86, v86, v116
    v_sub_f32 v87, v87, v116
    s_branch at_backf_10
at_rescf_11:
    ds_bpermute_b32 v119, v121, v116
    s_waitcnt lgkmcnt(0)
    v_max_f32 v116, v116, v119
    v_cmp_gt_f32 vcc, v116, v117
    s_nop 1
    v_cndmask_b32 v116, 0, v116, vcc
    v_add_f32 v119, v118, v116
    v_cvt_pk_bf16_f32 v119, v119, v119
    v_lshlrev_b32 v119, 16, v119
    v_sub_f32 v116, v119, v118
    v_mov_b32 v118, v119
    v_max_f32 v120, 0, v116
    v_sub_f32 v120, 0, v120
    v_exp_f32 v120, v120
    v_lshrrev_b32 v119, 16, v119
    v_xor_b32 v119, 0x8000, v119
    s_nop 15
    s_nop 15
    v_and_b32 v22, v119, v122
    v_mov_b32 v117, 0x41000000
    v_mul_f32 v88, v88, v120
    v_mul_f32 v89, v89, v120
    v_mul_f32 v90, v90, v120
    v_mul_f32 v91, v91, v120
    v_mul_f32 v92, v92, v120
    v_mul_f32 v93, v93, v120
    v_mul_f32 v94, v94, v120
    v_mul_f32 v95, v95, v120
    v_mul_f32 v96, v96, v120
    v_mul_f32 v97, v97, v120
    v_mul_f32 v98, v98, v120
    v_mul_f32 v99, v99, v120
    v_mul_f32 v100, v100, v120
    v_mul_f32 v101, v101, v120
    v_mul_f32 v102, v102, v120
    v_mul_f32 v103, v103, v120
    v_sub_f32 v72, v72, v116
    v_sub_f32 v73, v73, v116
    v_sub_f32 v74, v74, v116
    v_sub_f32 v75, v75, v116
    v_sub_f32 v76, v76, v116
    v_sub_f32 v77, v77, v116
    v_sub_f32 v78, v78, v116
    v_sub_f32 v79, v79, v116
    v_sub_f32 v80, v80, v116
    v_sub_f32 v81, v81, v116
    v_sub_f32 v82, v82, v116
    v_sub_f32 v83, v83, v116
    v_sub_f32 v84, v84, v116
    v_sub_f32 v85, v85, v116
    v_sub_f32 v86, v86, v116
    v_sub_f32 v87, v87, v116
    v_sub_f32 v56, v56, v116
    v_sub_f32 v57, v57, v116
    v_sub_f32 v58, v58, v116
    v_sub_f32 v59, v59, v116
    v_sub_f32 v60, v60, v116
    v_sub_f32 v61, v61, v116
    v_sub_f32 v62, v62, v116
    v_sub_f32 v63, v63, v116
    v_sub_f32 v64, v64, v116
    v_sub_f32 v65, v65, v116
    v_sub_f32 v66, v66, v116
    v_sub_f32 v67, v67, v116
    v_sub_f32 v68, v68, v116
    v_sub_f32 v69, v69, v116
    v_sub_f32 v70, v70, v116
    v_sub_f32 v71, v71, v116
    s_branch at_backf_11
at_rescf_12:
    ds_bpermute_b32 v119, v121, v116
    s_waitcnt lgkmcnt(0)
    v_max_f32 v116, v116, v119
    v_cmp_gt_f32 vcc, v116, v117
    s_nop 1
    v_cndmask_b32 v116, 0, v116, vcc
    v_add_f32 v119, v118, v116
    v_cvt_pk_bf16_f32 v119, v119, v119
    v_lshlrev_b32 v119, 16, v119
    v_sub_f32 v116, v119, v118
    v_mov_b32 v118, v119
    v_max_f32 v120, 0, v116
    v_sub_f32 v120, 0, v120
    v_exp_f32 v120, v120
    v_lshrrev_b32 v119, 16, v119
    v_xor_b32 v119, 0x8000, v119
    s_nop 15
    s_nop 15
    v_and_b32 v22, v119, v122
    v_mov_b32 v117, 0x41000000
    v_mul_f32 v88, v88, v120
    v_mul_f32 v89, v89, v120
    v_mul_f32 v90, v90, v120
    v_mul_f32 v91, v91, v120
    v_mul_f32 v92, v92, v120
    v_mul_f32 v93, v93, v120
    v_mul_f32 v94, v94, v120
    v_mul_f32 v95, v95, v120
    v_mul_f32 v96, v96, v120
    v_mul_f32 v97, v97, v120
    v_mul_f32 v98, v98, v120
    v_mul_f32 v99, v99, v120
    v_mul_f32 v100, v100, v120
    v_mul_f32 v101, v101, v120
    v_mul_f32 v102, v102, v120
    v_mul_f32 v103, v103, v120
    v_sub_f32 v56, v56, v116
    v_sub_f32 v57, v57, v116
    v_sub_f32 v58, v58, v116
    v_sub_f32 v59, v59, v116
    v_sub_f32 v60, v60, v116
    v_sub_f32 v61, v61, v116
    v_sub_f32 v62, v62, v116
    v_sub_f32 v63, v63, v116
    v_sub_f32 v64, v64, v116
    v_sub_f32 v65, v65, v116
    v_sub_f32 v66, v66, v116
    v_sub_f32 v67, v67, v116
    v_sub_f32 v68, v68, v116
    v_sub_f32 v69, v69, v116
    v_sub_f32 v70, v70, v116
    v_sub_f32 v71, v71, v116
    v_sub_f32 v72, v72, v116
    v_sub_f32 v73, v73, v116
    v_sub_f32 v74, v74, v116
    v_sub_f32 v75, v75, v116
    v_sub_f32 v76, v76, v116
    v_sub_f32 v77, v77, v116
    v_sub_f32 v78, v78, v116
    v_sub_f32 v79, v79, v116
    v_sub_f32 v80, v80, v116
    v_sub_f32 v81, v81, v116
    v_sub_f32 v82, v82, v116
    v_sub_f32 v83, v83, v116
    v_sub_f32 v84, v84, v116
    v_sub_f32 v85, v85, v116
    v_sub_f32 v86, v86, v116
    v_sub_f32 v87, v87, v116
    s_branch at_backf_12
at_rescf_13:
    ds_bpermute_b32 v119, v121, v116
    s_waitcnt lgkmcnt(0)
    v_max_f32 v116, v116, v119
    v_cmp_gt_f32 vcc, v116, v117
    s_nop 1
    v_cndmask_b32 v116, 0, v116, vcc
    v_add_f32 v119, v118, v116
    v_cvt_pk_bf16_f32 v119, v119, v119
    v_lshlrev_b32 v119, 16, v119
    v_sub_f32 v116, v119, v118
    v_mov_b32 v118, v119
    v_max_f32 v120, 0, v116
    v_sub_f32 v120, 0, v120
    v_exp_f32 v120, v120
    v_lshrrev_b32 v119, 16, v119
    v_xor_b32 v119, 0x8000, v119
    s_nop 15
    s_nop 15
    v_and_b32 v22, v119, v122
    v_mov_b32 v117, 0x41000000
    v_mul_f32 v88, v88, v120
    v_mul_f32 v89, v89, v120
    v_mul_f32 v90, v90, v120
    v_mul_f32 v91, v91, v120
    v_mul_f32 v92, v92, v120
    v_mul_f32 v93, v93, v120
    v_mul_f32 v94, v94, v120
    v_mul_f32 v95, v95, v120
    v_mul_f32 v96, v96, v120
    v_mul_f32 v97, v97, v120
    v_mul_f32 v98, v98, v120
    v_mul_f32 v99, v99, v120
    v_mul_f32 v100, v100, v120
    v_mul_f32 v101, v101, v120
    v_mul_f32 v102, v102, v120
    v_mul_f32 v103, v103, v120
    v_sub_f32 v72, v72, v116
    v_sub_f32 v73, v73, v116
    v_sub_f32 v74, v74, v116
    v_sub_f32 v75, v75, v116
    v_sub_f32 v76, v76, v116
    v_sub_f32 v77, v77, v116
    v_sub_f32 v78, v78, v116
    v_sub_f32 v79, v79, v116
    v_sub_f32 v80, v80, v116
    v_sub_f32 v81, v81, v116
    v_sub_f32 v82, v82, v116
    v_sub_f32 v83, v83, v116
    v_sub_f32 v84, v84, v116
    v_sub_f32 v85, v85, v116
    v_sub_f32 v86, v86, v116
    v_sub_f32 v87, v87, v116
    v_sub_f32 v56, v56, v116
    v_sub_f32 v57, v57, v116
    v_sub_f32 v58, v58, v116
    v_sub_f32 v59, v59, v116
    v_sub_f32 v60, v60, v116
    v_sub_f32 v61, v61, v116
    v_sub_f32 v62, v62, v116
    v_sub_f32 v63, v63, v116
    v_sub_f32 v64, v64, v116
    v_sub_f32 v65, v65, v116
    v_sub_f32 v66, v66, v116
    v_sub_f32 v67, v67, v116
    v_sub_f32 v68, v68, v116
    v_sub_f32 v69, v69, v116
    v_sub_f32 v70, v70, v116
    v_sub_f32 v71, v71, v116
    s_branch at_backf_13
at_rescf_14:
    ds_bpermute_b32 v119, v121, v116
    s_waitcnt lgkmcnt(0)
    v_max_f32 v116, v116, v119
    v_cmp_gt_f32 vcc, v116, v117
    s_nop 1
    v_cndmask_b32 v116, 0, v116, vcc
    v_add_f32 v119, v118, v116
    v_cvt_pk_bf16_f32 v119, v119, v119
    v_lshlrev_b32 v119, 16, v119
    v_sub_f32 v116, v119, v118
    v_mov_b32 v118, v119
    v_max_f32 v120, 0, v116
    v_sub_f32 v120, 0, v120
    v_exp_f32 v120, v120
    v_lshrrev_b32 v119, 16, v119
    v_xor_b32 v119, 0x8000, v119
    s_nop 15
    s_nop 15
    v_and_b32 v22, v119, v122
    v_mov_b32 v117, 0x41000000
    v_mul_f32 v88, v88, v120
    v_mul_f32 v89, v89, v120
    v_mul_f32 v90, v90, v120
    v_mul_f32 v91, v91, v120
    v_mul_f32 v92, v92, v120
    v_mul_f32 v93, v93, v120
    v_mul_f32 v94, v94, v120
    v_mul_f32 v95, v95, v120
    v_mul_f32 v96, v96, v120
    v_mul_f32 v97, v97, v120
    v_mul_f32 v98, v98, v120
    v_mul_f32 v99, v99, v120
    v_mul_f32 v100, v100, v120
    v_mul_f32 v101, v101, v120
    v_mul_f32 v102, v102, v120
    v_mul_f32 v103, v103, v120
    v_sub_f32 v56, v56, v116
    v_sub_f32 v57, v57, v116
    v_sub_f32 v58, v58, v116
    v_sub_f32 v59, v59, v116
    v_sub_f32 v60, v60, v116
    v_sub_f32 v61, v61, v116
    v_sub_f32 v62, v62, v116
    v_sub_f32 v63, v63, v116
    v_sub_f32 v64, v64, v116
    v_sub_f32 v65, v65, v116
    v_sub_f32 v66, v66, v116
    v_sub_f32 v67, v67, v116
    v_sub_f32 v68, v68, v116
    v_sub_f32 v69, v69, v116
    v_sub_f32 v70, v70, v116
    v_sub_f32 v71, v71, v116
    v_sub_f32 v72, v72, v116
    v_sub_f32 v73, v73, v116
    v_sub_f32 v74, v74, v116
    v_sub_f32 v75, v75, v116
    v_sub_f32 v76, v76, v116
    v_sub_f32 v77, v77, v116
    v_sub_f32 v78, v78, v116
    v_sub_f32 v79, v79, v116
    v_sub_f32 v80, v80, v116
    v_sub_f32 v81, v81, v116
    v_sub_f32 v82, v82, v116
    v_sub_f32 v83, v83, v116
    v_sub_f32 v84, v84, v116
    v_sub_f32 v85, v85, v116
    v_sub_f32 v86, v86, v116
    v_sub_f32 v87, v87, v116
    s_branch at_backf_14
at_rescf_15:
    ds_bpermute_b32 v119, v121, v116
    s_waitcnt lgkmcnt(0)
    v_max_f32 v116, v116, v119
    v_cmp_gt_f32 vcc, v116, v117
    s_nop 1
    v_cndmask_b32 v116, 0, v116, vcc
    v_add_f32 v119, v118, v116
    v_cvt_pk_bf16_f32 v119, v119, v119
    v_lshlrev_b32 v119, 16, v119
    v_sub_f32 v116, v119, v118
    v_mov_b32 v118, v119
    v_max_f32 v120, 0, v116
    v_sub_f32 v120, 0, v120
    v_exp_f32 v120, v120
    v_lshrrev_b32 v119, 16, v119
    v_xor_b32 v119, 0x8000, v119
    s_nop 15
    s_nop 15
    v_and_b32 v22, v119, v122
    v_mov_b32 v117, 0x41000000
    v_mul_f32 v88, v88, v120
    v_mul_f32 v89, v89, v120
    v_mul_f32 v90, v90, v120
    v_mul_f32 v91, v91, v120
    v_mul_f32 v92, v92, v120
    v_mul_f32 v93, v93, v120
    v_mul_f32 v94, v94, v120
    v_mul_f32 v95, v95, v120
    v_mul_f32 v96, v96, v120
    v_mul_f32 v97, v97, v120
    v_mul_f32 v98, v98, v120
    v_mul_f32 v99, v99, v120
    v_mul_f32 v100, v100, v120
    v_mul_f32 v101, v101, v120
    v_mul_f32 v102, v102, v120
    v_mul_f32 v103, v103, v120
    v_sub_f32 v72, v72, v116
    v_sub_f32 v73, v73, v116
    v_sub_f32 v74, v74, v116
    v_sub_f32 v75, v75, v116
    v_sub_f32 v76, v76, v116
    v_sub_f32 v77, v77, v116
    v_sub_f32 v78, v78, v116
    v_sub_f32 v79, v79, v116
    v_sub_f32 v80, v80, v116
    v_sub_f32 v81, v81, v116
    v_sub_f32 v82, v82, v116
    v_sub_f32 v83, v83, v116
    v_sub_f32 v84, v84, v116
    v_sub_f32 v85, v85, v116
    v_sub_f32 v86, v86, v116
    v_sub_f32 v87, v87, v116
    s_branch at_backf_15
at_end:
    s_endpgm
at_gemm:
    s_sub_u32 s2, s2, 256
    v_cmp_le_u32 vcc, 256, v0
    s_cbranch_vccnz at_end
    s_cmp_ge_u32 s2, 160
    s_cbranch_scc1 dp_end
    s_load_dwordx2 s[4:5], s[0:1], 48
    s_load_dwordx2 s[6:7], s[0:1], 72
    s_load_dwordx2 s[26:27], s[0:1], 0
    s_load_dwordx2 s[50:51], s[0:1], 56
    v_and_b32 v23, 63, v0
    v_lshrrev_b32 v1, 6, v0
    s_nop 0
    v_readfirstlane_b32 s20, v1
    s_lshr_b32 s21, s20, 1
    s_and_b32 s22, s20, 1
    s_lshl_b32 s38, s20, 10
    v_and_b32 v1, 31, v23
    s_lshl_b32 s3, s21, 6
    v_add_u32 v1, s3, v1
    v_lshlrev_b32 v1, 6, v1
    v_lshrrev_b32 v2, 5, v23
    v_bfe_u32 v3, v23, 2, 2
    v_add_u32 v4, 0, v2
    v_xor_b32 v4, v4, v3
    v_lshl_add_u32 v16, v4, 4, v1
    v_add_u32 v4, 2, v2
    v_xor_b32 v4, v4, v3
    v_lshl_add_u32 v17, v4, 4, v1
    v_lshrrev_b32 v1, 5, v23
    v_lshlrev_b32 v1, 3, v1
    v_bfe_u32 v2, v23, 2, 2
    v_add_u32 v1, v1, v2
    v_lshlrev_b32 v1, 7, v1
    v_bfe_u32 v2, v23, 4, 1
    v_lshlrev_b32 v2, 1, v2
    v_bfe_u32 v3, v23, 1, 1
    v_add_u32 v2, v2, v3
    s_lshl_b32 s3, s22, 2
    v_add_u32 v2, s3, v2
    v_bfe_u32 v3, v23, 3, 1
    v_lshlrev_b32 v3, 2, v3
    v_xor_b32 v2, v2, v3
    v_lshl_add_u32 v1, v2, 4, v1
    v_and_b32 v2, 1, v23
    v_lshl_add_u32 v1, v2, 3, v1
    v_add_u32 v20, 8192, v1
    s_waitcnt lgkmcnt(0)
    s_mov_b32 s8, s6
    s_and_b32 s9, s7, 0xffff
    s_mov_b32 s10, 268435456
    s_mov_b32 s11, 0x00020000
    s_mov_b32 s40, s6
    s_and_b32 s41, s7, 0xffff
    s_mov_b32 s42, 268435456
    s_mov_b32 s43, 0x00020000
    s_mov_b32 s12, s4
    s_and_b32 s13, s5, 0xffff
    s_mov_b32 s14, 2211840
    s_mov_b32 s15, 0x00020000
    s_mov_b32 s52, s26
    s_and_b32 s53, s27, 0xffff
    s_mov_b32 s54, 2621440
    s_mov_b32 s55, 0x00020000
    s_mov_b32 s56, s50
    s_and_b32 s57, s51, 0xffff
    s_mov_b32 s58, 2621440
    s_mov_b32 s59, 0x00020000
    s_lshr_b32 s3, s2, 3
    s_and_b32 s5, s2, 7
    s_lshl_b32 s5, s5, 1
    s_cmp_ge_u32 s3, 10
    s_cselect_b32 s4, 1, 0
    s_add_u32 s5, s5, s4
    s_mul_i32 s4, s4, 10
    s_sub_u32 s4, s3, s4
    s_lshl_b32 s23, s5, 7
    s_movk_i32 s44, 1280
    v_lshrrev_b32 v1, 2, v23
    s_mov_b32 s3, 3456
    v_mul_lo_u32 v1, v1, s3
    v_bfe_u32 v2, v23, 4, 2
    v_and_b32 v3, 3, v23
    v_xor_b32 v2, v2, v3
    v_lshl_add_u32 v21, v2, 4, v1
    v_lshrrev_b32 v1, 3, v23
    v_mul_lo_u32 v1, v1, s44
    v_bfe_u32 v2, v23, 4, 1
    v_lshlrev_b32 v2, 2, v2
    v_and_b32 v3, 7, v23
    v_xor_b32 v2, v2, v3
    v_lshl_add_u32 v22, v2, 4, v1
    v_and_b32 v2, 31, v23
    s_lshl_b32 s6, s21, 6
    s_add_u32 s6, s6, s23
    v_add_u32 v2, s6, v2
    s_movk_i32 s7, 1280
    v_mul_lo_u32 v2, v2, s7
    v_lshrrev_b32 v1, 5, v23
    v_lshlrev_b32 v1, 3, v1
    v_add_u32 v25, v2, v1
    v_add_u32 v26, 40960, v25
    s_lshl_b32 s3, s4, 7
    s_lshl_b32 s6, s22, 6
    s_add_u32 s49, s3, s6
    s_add_u32 s48, s49, 27262976
    s_lshl_b32 s6, s4, 7
    s_lshl_b32 s3, s20, 4
    s_add_u32 s3, s3, 0
    s_add_u32 s3, s3, s23
    s_mul_i32 s3, s3, 3456
    s_add_u32 s28, s3, 15728640
    s_lshl_b32 s3, s20, 4
    s_add_u32 s3, s3, 64
    s_add_u32 s3, s3, s23
    s_mul_i32 s3, s3, 3456
    s_add_u32 s29, s3, 15728640
    s_lshl_b32 s3, s20, 3
    s_mul_i32 s3, s3, s44
    s_add_u32 s32, s3, s6
    s_lshl_b32 s36, s44, 5
    v_mov_b32 v64, 0
    v_mov_b32 v65, 0
    v_mov_b32 v66, 0
    v_mov_b32 v67, 0
    v_mov_b32 v68, 0
    v_mov_b32 v69, 0
    v_mov_b32 v70, 0
    v_mov_b32 v71, 0
    v_mov_b32 v72, 0
    v_mov_b32 v73, 0
    v_mov_b32 v74, 0
    v_mov_b32 v75, 0
    v_mov_b32 v76, 0
    v_mov_b32 v77, 0
    v_mov_b32 v78, 0
    v_mov_b32 v79, 0
    v_mov_b32 v80, 0
    v_mov_b32 v81, 0
    v_mov_b32 v82, 0
    v_mov_b32 v83, 0
    v_mov_b32 v84, 0
    v_mov_b32 v85, 0
    v_mov_b32 v86, 0
    v_mov_b32 v87, 0
    v_mov_b32 v88, 0
    v_mov_b32 v89, 0
    v_mov_b32 v90, 0
    v_mov_b32 v91, 0
    v_mov_b32 v92, 0
    v_mov_b32 v93, 0
    v_mov_b32 v94, 0
    v_mov_b32 v95, 0
    s_add_u32 m0, s38, 0
    s_nop 0
    buffer_load_dwordx4 v21, s[40:43], s28 offen lds
    s_add_u32 m0, s38, 4096
    s_nop 0
    buffer_load_dwordx4 v21, s[40:43], s29 offen lds
    s_add_u32 m0, s38, 8192
    s_nop 0
    buffer_load_dwordx4 v22, s[12:15], s32 offen lds
    s_add_u32 s28, s28, 64
    s_add_u32 s29, s29, 64
    s_add_u32 s32, s32, s36
    s_add_u32 m0, s38, 16384
    s_nop 0
    buffer_load_dwordx4 v21, s[40:43], s28 offen lds
    s_add_u32 m0, s38, 20480
    s_nop 0
    buffer_load_dwordx4 v21, s[40:43], s29 offen lds
    s_add_u32 m0, s38, 24576
    s_nop 0
    buffer_load_dwordx4 v22, s[12:15], s32 offen lds
    s_add_u32 s28, s28, 64
    s_add_u32 s29, s29, 64
    s_add_u32 s32, s32, s36
    s_add_u32 m0, s38, 32768
    s_nop 0
    buffer_load_dwordx4 v21, s[40:43], s28 offen lds
    s_add_u32 m0, s38, 36864
    s_nop 0
    buffer_load_dwordx4 v21, s[40:43], s29 offen lds
    s_add_u32 m0, s38, 40960
    s_nop 0
    buffer_load_dwordx4 v22, s[12:15], s32 offen lds
    s_add_u32 s28, s28, 64
    s_add_u32 s29, s29, 64
    s_add_u32 s32, s32, s36
    s_waitcnt vmcnt(6)
    s_barrier
    ds_read_b128 v[32:35], v16 offset:0
    ds_read_b128 v[36:39], v16 offset:2048
    ds_read_b64_tr_b16 v[48:49], v20 offset:0
    ds_read_b64_tr_b16 v[50:51], v20 offset:512
    s_waitcnt vmcnt(3)
    s_barrier
    s_add_u32 m0, s38, 49152
    s_nop 0
    buffer_load_dwordx4 v21, s[40:43], s28 offen lds
    s_add_u32 m0, s38, 53248
    s_nop 0
    buffer_load_dwordx4 v21, s[40:43], s29 offen lds
    s_add_u32 m0, s38, 57344
    s_nop 0
    buffer_load_dwordx4 v22, s[12:15], s32 offen lds
    s_add_u32 s28, s28, 64
    s_add_u32 s29, s29, 64
    s_add_u32 s32, s32, s36
    ds_read_b128 v[40:43], v17 offset:0
    ds_read_b128 v[44:47], v17 offset:2048
    ds_read_b64_tr_b16 v[56:57], v20 offset:2048
    ds_read_b64_tr_b16 v[58:59], v20 offset:2560
    s_waitcnt lgkmcnt(4)
    v_mfma_f32_32x32x16_bf16 v[64:79], v[48:51], v[32:35], v[64:79]
    v_mfma_f32_32x32x16_bf16 v[80:95], v[48:51], v[36:39], v[80:95]
    ds_read_b128 v[32:35], v16 offset:16384
    ds_read_b128 v[36:39], v16 offset:18432
    ds_read_b64_tr_b16 v[48:49], v20 offset:16384
    ds_read_b64_tr_b16 v[50:51], v20 offset:16896
    s_waitcnt lgkmcnt(4)
    v_mfma_f32_32x32x16_bf16 v[64:79], v[56:59], v[40:43], v[64:79]
    v_mfma_f32_32x32x16_bf16 v[80:95], v[56:59], v[44:47], v[80:95]
    s_waitcnt vmcnt(3)
    s_barrier
    s_add_u32 m0, s38, 0
    s_nop 0
    buffer_load_dwordx4 v21, s[40:43], s28 offen lds
    s_add_u32 m0, s38, 4096
    s_nop 0
    buffer_load_dwordx4 v21, s[40:43], s29 offen lds
    s_add_u32 m0, s38, 8192
    s_nop 0
    buffer_load_dwordx4 v22, s[12:15], s32 offen lds
    s_add_u32 s28, s28, 64
    s_add_u32 s29, s29, 64
    s_add_u32 s32, s32, s36
    ds_read_b128 v[40:43], v17 offset:16384
    ds_read_b128 v[44:47], v17 offset:18432
    ds_read_b64_tr_b16 v[56:57], v20 offset:18432
    ds_read_b64_tr_b16 v[58:59], v20 offset:18944
    s_waitcnt lgkmcnt(4)
    v_mfma_f32_32x32x16_bf16 v[64:79], v[48:51], v[32:35], v[64:79]
    v_mfma_f32_32x32x16_bf16 v[80:95], v[48:51], v[36:39], v[80:95]
    ds_read_b128 v[32:35], v16 offset:32768
    ds_read_b128 v[36:39], v16 offset:34816
    ds_read_b64_tr_b16 v[48:49], v20 offset:32768
    ds_read_b64_tr_b16 v[50:51], v20 offset:33280
    s_waitcnt lgkmcnt(4)
    v_mfma_f32_32x32x16_bf16 v[64:79], v[56:59], v[40:43], v[64:79]
    v_mfma_f32_32x32x16_bf16 v[80:95], v[56:59], v[44:47], v[80:95]
    s_waitcnt vmcnt(3)
    s_barrier
    s_add_u32 m0, s38, 16384
    s_nop 0
    buffer_load_dwordx4 v21, s[40:43], s28 offen lds
    s_add_u32 m0, s38, 20480
    s_nop 0
    buffer_load_dwordx4 v21, s[40:43], s29 offen lds
    s_add_u32 m0, s38, 24576
    s_nop 0
    buffer_load_dwordx4 v22, s[12:15], s32 offen lds
    s_add_u32 s28, s28, 64
    s_add_u32 s29, s29, 64
    s_add_u32 s32, s32, s36
    ds_read_b128 v[40:43], v17 offset:32768
    ds_read_b128 v[44:47], v17 offset:34816
    ds_read_b64_tr_b16 v[56:57], v20 offset:34816
    ds_read_b64_tr_b16 v[58:59], v20 offset:35328
    s_waitcnt lgkmcnt(4)
    v_mfma_f32_32x32x16_bf16 v[64:79], v[48:51], v[32:35], v[64:79]
    v_mfma_f32_32x32x16_bf16 v[80:95], v[48:51], v[36:39], v[80:95]
    ds_read_b128 v[32:35], v16 offset:49152
    ds_read_b128 v[36:39], v16 offset:51200
    ds_read_b64_tr_b16 v[48:49], v20 offset:49152
    ds_read_b64_tr_b16 v[50:51], v20 offset:49664
    s_waitcnt lgkmcnt(4)
    v_mfma_f32_32x32x16_bf16 v[64:79], v[56:59], v[40:43], v[64:79]
    v_mfma_f32_32x32x16_bf16 v[80:95], v[56:59], v[44:47], v[80:95]
    s_waitcnt vmcnt(3)
    s_barrier
    s_add_u32 m0, s38, 32768
    s_nop 0
    buffer_load_dwordx4 v21, s[40:43], s28 offen lds
    s_add_u32 m0, s38, 36864
    s_nop 0
    buffer_load_dwordx4 v21, s[40:43], s29 offen lds
    s_add_u32 m0, s38, 40960
    s_nop 0
    buffer_load_dwordx4 v22, s[12:15], s32 offen lds
    s_add_u32 s28, s28, 64
    s_add_u32 s29, s29, 64
    s_add_u32 s32, s32, s36
    ds_read_b128 v[40:43], v17 offset:49152
    ds_read_b128 v[44:47], v17 offset:51200
    ds_read_b64_tr_b16 v[56:57], v20 offset:51200
    ds_read_b64_tr_b16 v[58:59], v20 offset:51712
    s_waitcnt lgkmcnt(4)
    v_mfma_f32_32x32x16_bf16 v[64:79], v[48:51], v[32:35], v[64:79]
    v_mfma_f32_32x32x16_bf16 v[80:95], v[48:51], v[36:39], v[80:95]
    ds_read_b128 v[32:35], v16 offset:0
    ds_read_b128 v[36:39], v16 offset:2048
    ds_read_b64_tr_b16 v[48:49], v20 offset:0
    ds_read_b64_tr_b16 v[50:51], v20 offset:512
    s_waitcnt lgkmcnt(4)
    v_mfma_f32_32x32x16_bf16 v[64:79], v[56:59], v[40:43], v[64:79]
    v_mfma_f32_32x32x16_bf16 v[80:95], v[56:59], v[44:47], v[80:95]
    s_waitcnt vmcnt(3)
    s_barrier
    s_add_u32 m0, s38, 49152
    s_nop 0
    buffer_load_dwordx4 v21, s[40:43], s28 offen lds
    s_add_u32 m0, s38, 53248
    s_nop 0
    buffer_load_dwordx4 v21, s[40:43], s29 offen lds
    s_add_u32 m0, s38, 57344
    s_nop 0
    buffer_load_dwordx4 v22, s[12:15], s32 offen lds
    s_add_u32 s28, s28, 64
    s_add_u32 s29, s29, 64
    s_add_u32 s32, s32, s36
    ds_read_b128 v[40:43], v17 offset:0
    ds_read_b128 v[44:47], v17 offset:2048
    ds_read_b64_tr_b16 v[56:57], v20 offset:2048
    ds_read_b64_tr_b16 v[58:59], v20 offset:2560
    s_waitcnt lgkmcnt(4)
    v_mfma_f32_32x32x16_bf16 v[64:79], v[48:51], v[32:35], v[64:79]
    v_mfma_f32_32x32x16_bf16 v[80:95], v[48:51], v[36:39], v[80:95]
    ds_read_b128 v[32:35], v16 offset:16384
    ds_read_b128 v[36:39], v16 offset:18432
    ds_read_b64_tr_b16 v[48:49], v20 offset:16384
    ds_read_b64_tr_b16 v[50:51], v20 offset:16896
    s_waitcnt lgkmcnt(4)
    v_mfma_f32_32x32x16_bf16 v[64:79], v[56:59], v[40:43], v[64:79]
    v_mfma_f32_32x32x16_bf16 v[80:95], v[56:59], v[44:47], v[80:95]
    s_waitcnt vmcnt(3)
    s_barrier
    s_add_u32 m0, s38, 0
    s_nop 0
    buffer_load_dwordx4 v21, s[40:43], s28 offen lds
    s_add_u32 m0, s38, 4096
    s_nop 0
    buffer_load_dwordx4 v21, s[40:43], s29 offen lds
    s_add_u32 m0, s38, 8192
    s_nop 0
    buffer_load_dwordx4 v22, s[12:15], s32 offen lds
    s_add_u32 s28, s28, 64
    s_add_u32 s29, s29, 64
    s_add_u32 s32, s32, s36
    ds_read_b128 v[40:43], v17 offset:16384
    ds_read_b128 v[44:47], v17 offset:18432
    ds_read_b64_tr_b16 v[56:57], v20 offset:18432
    ds_read_b64_tr_b16 v[58:59], v20 offset:18944
    s_waitcnt lgkmcnt(4)
    v_mfma_f32_32x32x16_bf16 v[64:79], v[48:51], v[32:35], v[64:79]
    v_mfma_f32_32x32x16_bf16 v[80:95], v[48:51], v[36:39], v[80:95]
    ds_read_b128 v[32:35], v16 offset:32768
    ds_read_b128 v[36:39], v16 offset:34816
    ds_read_b64_tr_b16 v[48:49], v20 offset:32768
    ds_read_b64_tr_b16 v[50:51], v20 offset:33280
    s_waitcnt lgkmcnt(4)
    v_mfma_f32_32x32x16_bf16 v[64:79], v[56:59], v[40:43], v[64:79]
    v_mfma_f32_32x32x16_bf16 v[80:95], v[56:59], v[44:47], v[80:95]
    s_waitcnt vmcnt(3)
    s_barrier
    s_add_u32 m0, s38, 16384
    s_nop 0
    buffer_load_dwordx4 v21, s[40:43], s28 offen lds
    s_add_u32 m0, s38, 20480
    s_nop 0
    buffer_load_dwordx4 v21, s[40:43], s29 offen lds
    s_add_u32 m0, s38, 24576
    s_nop 0
    buffer_load_dwordx4 v22, s[12:15], s32 offen lds
    s_add_u32 s28, s28, 64
    s_add_u32 s29, s29, 64
    s_add_u32 s32, s32, s36
    ds_read_b128 v[40:43], v17 offset:32768
    ds_read_b128 v[44:47], v17 offset:34816
    ds_read_b64_tr_b16 v[56:57], v20 offset:34816
    ds_read_b64_tr_b16 v[58:59], v20 offset:35328
    s_waitcnt lgkmcnt(4)
    v_mfma_f32_32x32x16_bf16 v[64:79], v[48:51], v[32:35], v[64:79]
    v_mfma_f32_32x32x16_bf16 v[80:95], v[48:51], v[36:39], v[80:95]
    ds_read_b128 v[32:35], v16 offset:49152
    ds_read_b128 v[36:39], v16 offset:51200
    ds_read_b64_tr_b16 v[48:49], v20 offset:49152
    ds_read_b64_tr_b16 v[50:51], v20 offset:49664
    s_waitcnt lgkmcnt(4)
    v_mfma_f32_32x32x16_bf16 v[64:79], v[56:59], v[40:43], v[64:79]
    v_mfma_f32_32x32x16_bf16 v[80:95], v[56:59], v[44:47], v[80:95]
    s_waitcnt vmcnt(3)
    s_barrier
    s_add_u32 m0, s38, 32768
    s_nop 0
    buffer_load_dwordx4 v21, s[40:43], s28 offen lds
    s_add_u32 m0, s38, 36864
    s_nop 0
    buffer_load_dwordx4 v21, s[40:43], s29 offen lds
    s_add_u32 m0, s38, 40960
    s_nop 0
    buffer_load_dwordx4 v22, s[12:15], s32 offen lds
    s_add_u32 s28, s28, 64
    s_add_u32 s29, s29, 64
    s_add_u32 s32, s32, s36
    ds_read_b128 v[40:43], v17 offset:49152
    ds_read_b128 v[44:47], v17 offset:51200
    ds_read_b64_tr_b16 v[56:57], v20 offset:51200
    ds_read_b64_tr_b16 v[58:59], v20 offset:51712
    s_waitcnt lgkmcnt(4)
    v_mfma_f32_32x32x16_bf16 v[64:79], v[48:51], v[32:35], v[64:79]
    v_mfma_f32_32x32x16_bf16 v[80:95], v[48:51], v[36:39], v[80:95]
    ds_read_b128 v[32:35], v16 offset:0
    ds_read_b128 v[36:39], v16 offset:2048
    ds_read_b64_tr_b16 v[48:49], v20 offset:0
    ds_read_b64_tr_b16 v[50:51], v20 offset:512
    s_waitcnt lgkmcnt(4)
    v_mfma_f32_32x32x16_bf16 v[64:79], v[56:59], v[40:43], v[64:79]
    v_mfma_f32_32x32x16_bf16 v[80:95], v[56:59], v[44:47], v[80:95]
    s_waitcnt vmcnt(3)
    s_barrier
    s_add_u32 m0, s38, 49152
    s_nop 0
    buffer_load_dwordx4 v21, s[40:43], s28 offen lds
    s_add_u32 m0, s38, 53248
    s_nop 0
    buffer_load_dwordx4 v21, s[40:43], s29 offen lds
    s_add_u32 m0, s38, 57344
    s_nop 0
    buffer_load_dwordx4 v22, s[12:15], s32 offen lds
    s_add_u32 s28, s28, 64
    s_add_u32 s29, s29, 64
    s_add_u32 s32, s32, s36
    ds_read_b128 v[40:43], v17 offset:0
    ds_read_b128 v[44:47], v17 offset:2048
    ds_read_b64_tr_b16 v[56:57], v20 offset:2048
    ds_read_b64_tr_b16 v[58:59], v20 offset:2560
    s_waitcnt lgkmcnt(4)
    v_mfma_f32_32x32x16_bf16 v[64:79], v[48:51], v[32:35], v[64:79]
    v_mfma_f32_32x32x16_bf16 v[80:95], v[48:51], v[36:39], v[80:95]
    ds_read_b128 v[32:35], v16 offset:16384
    ds_read_b128 v[36:39], v16 offset:18432
    ds_read_b64_tr_b16 v[48:49], v20 offset:16384
    ds_read_b64_tr_b16 v[50:51], v20 offset:16896
    s_waitcnt lgkmcnt(4)
    v_mfma_f32_32x32x16_bf16 v[64:79], v[56:59], v[40:43], v[64:79]
    v_mfma_f32_32x32x16_bf16 v[80:95], v[56:59], v[44:47], v[80:95]
    s_waitcnt vmcnt(3)
    s_barrier
    s_add_u32 m0, s38, 0
    s_nop 0
    buffer_load_dwordx4 v21, s[40:43], s28 offen lds
    s_add_u32 m0, s38, 4096
    s_nop 0
    buffer_load_dwordx4 v21, s[40:43], s29 offen lds
    s_add_u32 m0, s38, 8192
    s_nop 0
    buffer_load_dwordx4 v22, s[12:15], s32 offen lds
    s_add_u32 s28, s28, 64
    s_add_u32 s29, s29, 64
    s_add_u32 s32, s32, s36
    ds_read_b128 v[40:43], v17 offset:16384
    ds_read_b128 v[44:47], v17 offset:18432
    ds_read_b64_tr_b16 v[56:57], v20 offset:18432
    ds_read_b64_tr_b16 v[58:59], v20 offset:18944
    s_waitcnt lgkmcnt(4)
    v_mfma_f32_32x32x16_bf16 v[64:79], v[48:51], v[32:35], v[64:79]
    v_mfma_f32_32x32x16_bf16 v[80:95], v[48:51], v[36:39], v[80:95]
    ds_read_b128 v[32:35], v16 offset:32768
    ds_read_b128 v[36:39], v16 offset:34816
    ds_read_b64_tr_b16 v[48:49], v20 offset:32768
    ds_read_b64_tr_b16 v[50:51], v20 offset:33280
    s_waitcnt lgkmcnt(4)
    v_mfma_f32_32x32x16_bf16 v[64:79], v[56:59], v[40:43], v[64:79]
    v_mfma_f32_32x32x16_bf16 v[80:95], v[56:59], v[44:47], v[80:95]
    s_waitcnt vmcnt(3)
    s_barrier
    s_add_u32 m0, s38, 16384
    s_nop 0
    buffer_load_dwordx4 v21, s[40:43], s28 offen lds
    s_add_u32 m0, s38, 20480
    s_nop 0
    buffer_load_dwordx4 v21, s[40:43], s29 offen lds
    s_add_u32 m0, s38, 24576
    s_nop 0
    buffer_load_dwordx4 v22, s[12:15], s32 offen lds
    s_add_u32 s28, s28, 64
    s_add_u32 s29, s29, 64
    s_add_u32 s32, s32, s36
    ds_read_b128 v[40:43], v17 offset:32768
    ds_read_b128 v[44:47], v17 offset:34816
    ds_read_b64_tr_b16 v[56:57], v20 offset:34816
    ds_read_b64_tr_b16 v[58:59], v20 offset:35328
    s_waitcnt lgkmcnt(4)
    v_mfma_f32_32x32x16_bf16 v[64:79], v[48:51], v[32:35], v[64:79]
    v_mfma_f32_32x32x16_bf16 v[80:95], v[48:51], v[36:39], v[80:95]
    ds_read_b128 v[32:35], v16 offset:49152
    ds_read_b128 v[36:39], v16 offset:51200
    ds_read_b64_tr_b16 v[48:49], v20 offset:49152
    ds_read_b64_tr_b16 v[50:51], v20 offset:49664
    s_waitcnt lgkmcnt(4)
    v_mfma_f32_32x32x16_bf16 v[64:79], v[56:59], v[40:43], v[64:79]
    v_mfma_f32_32x32x16_bf16 v[80:95], v[56:59], v[44:47], v[80:95]
    s_waitcnt vmcnt(3)
    s_barrier
    s_add_u32 m0, s38, 32768
    s_nop 0
    buffer_load_dwordx4 v21, s[40:43], s28 offen lds
    s_add_u32 m0, s38, 36864
    s_nop 0
    buffer_load_dwordx4 v21, s[40:43], s29 offen lds
    s_add_u32 m0, s38, 40960
    s_nop 0
    buffer_load_dwordx4 v22, s[12:15], s32 offen lds
    s_add_u32 s28, s28, 64
    s_add_u32 s29, s29, 64
    s_add_u32 s32, s32, s36
    ds_read_b128 v[40:43], v17 offset:49152
    ds_read_b128 v[44:47], v17 offset:51200
    ds_read_b64_tr_b16 v[56:57], v20 offset:51200
    ds_read_b64_tr_b16 v[58:59], v20 offset:51712
    s_waitcnt lgkmcnt(4)
    v_mfma_f32_32x32x16_bf16 v[64:79], v[48:51], v[32:35], v[64:79]
    v_mfma_f32_32x32x16_bf16 v[80:95], v[48:51], v[36:39], v[80:95]
    ds_read_b128 v[32:35], v16 offset:0
    ds_read_b128 v[36:39], v16 offset:2048
    ds_read_b64_tr_b16 v[48:49], v20 offset:0
    ds_read_b64_tr_b16 v[50:51], v20 offset:512
    s_waitcnt lgkmcnt(4)
    v_mfma_f32_32x32x16_bf16 v[64:79], v[56:59], v[40:43], v[64:79]
    v_mfma_f32_32x32x16_bf16 v[80:95], v[56:59], v[44:47], v[80:95]
    s_waitcnt vmcnt(3)
    s_barrier
    s_add_u32 m0, s38, 49152
    s_nop 0
    buffer_load_dwordx4 v21, s[40:43], s28 offen lds
    s_add_u32 m0, s38, 53248
    s_nop 0
    buffer_load_dwordx4 v21, s[40:43], s29 offen lds
    s_add_u32 m0, s38, 57344
    s_nop 0
    buffer_load_dwordx4 v22, s[12:15], s32 offen lds
    s_add_u32 s28, s28, 64
    s_add_u32 s29, s29, 64
    s_add_u32 s32, s32, s36
    ds_read_b128 v[40:43], v17 offset:0
    ds_read_b128 v[44:47], v17 offset:2048
    ds_read_b64_tr_b16 v[56:57], v20 offset:2048
    ds_read_b64_tr_b16 v[58:59], v20 offset:2560
    s_waitcnt lgkmcnt(4)
    v_mfma_f32_32x32x16_bf16 v[64:79], v[48:51], v[32:35], v[64:79]
    v_mfma_f32_32x32x16_bf16 v[80:95], v[48:51], v[36:39], v[80:95]
    ds_read_b128 v[32:35], v16 offset:16384
    ds_read_b128 v[36:39], v16 offset:18432
    ds_read_b64_tr_b16 v[48:49], v20 offset:16384
    ds_read_b64_tr_b16 v[50:51], v20 offset:16896
    s_waitcnt lgkmcnt(4)
    v_mfma_f32_32x32x16_bf16 v[64:79], v[56:59], v[40:43], v[64:79]
    v_mfma_f32_32x32x16_bf16 v[80:95], v[56:59], v[44:47], v[80:95]
    s_waitcnt vmcnt(3)
    s_barrier
    s_add_u32 m0, s38, 0
    s_nop 0
    buffer_load_dwordx4 v21, s[40:43], s28 offen lds
    s_add_u32 m0, s38, 4096
    s_nop 0
    buffer_load_dwordx4 v21, s[40:43], s29 offen lds
    s_add_u32 m0, s38, 8192
    s_nop 0
    buffer_load_dwordx4 v22, s[12:15], s32 offen lds
    s_add_u32 s28, s28, 64
    s_add_u32 s29, s29, 64
    s_add_u32 s32, s32, s36
    ds_read_b128 v[40:43], v17 offset:16384
    ds_read_b128 v[44:47], v17 offset:18432
    ds_read_b64_tr_b16 v[56:57], v20 offset:18432
    ds_read_b64_tr_b16 v[58:59], v20 offset:18944
    s_waitcnt lgkmcnt(4)
    v_mfma_f32_32x32x16_bf16 v[64:79], v[48:51], v[32:35], v[64:79]
    v_mfma_f32_32x32x16_bf16 v[80:95], v[48:51], v[36:39], v[80:95]
    ds_read_b128 v[32:35], v16 offset:32768
    ds_read_b128 v[36:39], v16 offset:34816
    ds_read_b64_tr_b16 v[48:49], v20 offset:32768
    ds_read_b64_tr_b16 v[50:51], v20 offset:33280
    s_waitcnt lgkmcnt(4)
    v_mfma_f32_32x32x16_bf16 v[64:79], v[56:59], v[40:43], v[64:79]
    v_mfma_f32_32x32x16_bf16 v[80:95], v[56:59], v[44:47], v[80:95]
    s_waitcnt vmcnt(3)
    s_barrier
    s_add_u32 m0, s38, 16384
    s_nop 0
    buffer_load_dwordx4 v21, s[40:43], s28 offen lds
    s_add_u32 m0, s38, 20480
    s_nop 0
    buffer_load_dwordx4 v21, s[40:43], s29 offen lds
    s_add_u32 m0, s38, 24576
    s_nop 0
    buffer_load_dwordx4 v22, s[12:15], s32 offen lds
    s_add_u32 s28, s28, 64
    s_add_u32 s29, s29, 64
    s_add_u32 s32, s32, s36
    ds_read_b128 v[40:43], v17 offset:32768
    ds_read_b128 v[44:47], v17 offset:34816
    ds_read_b64_tr_b16 v[56:57], v20 offset:34816
    ds_read_b64_tr_b16 v[58:59], v20 offset:35328
    s_waitcnt lgkmcnt(4)
    v_mfma_f32_32x32x16_bf16 v[64:79], v[48:51], v[32:35], v[64:79]
    v_mfma_f32_32x32x16_bf16 v[80:95], v[48:51], v[36:39], v[80:95]
    ds_read_b128 v[32:35], v16 offset:49152
    ds_read_b128 v[36:39], v16 offset:51200
    ds_read_b64_tr_b16 v[48:49], v20 offset:49152
    ds_read_b64_tr_b16 v[50:51], v20 offset:49664
    s_waitcnt lgkmcnt(4)
    v_mfma_f32_32x32x16_bf16 v[64:79], v[56:59], v[40:43], v[64:79]
    v_mfma_f32_32x32x16_bf16 v[80:95], v[56:59], v[44:47], v[80:95]
    s_waitcnt vmcnt(3)
    s_barrier
    s_add_u32 m0, s38, 32768
    s_nop 0
    buffer_load_dwordx4 v21, s[40:43], s28 offen lds
    s_add_u32 m0, s38, 36864
    s_nop 0
    buffer_load_dwordx4 v21, s[40:43], s29 offen lds
    s_add_u32 m0, s38, 40960
    s_nop 0
    buffer_load_dwordx4 v22, s[12:15], s32 offen lds
    s_add_u32 s28, s28, 64
    s_add_u32 s29, s29, 64
    s_add_u32 s32, s32, s36
    ds_read_b128 v[40:43], v17 offset:49152
    ds_read_b128 v[44:47], v17 offset:51200
    ds_read_b64_tr_b16 v[56:57], v20 offset:51200
    ds_read_b64_tr_b16 v[58:59], v20 offset:51712
    s_waitcnt lgkmcnt(4)
    v_mfma_f32_32x32x16_bf16 v[64:79], v[48:51], v[32:35], v[64:79]
    v_mfma_f32_32x32x16_bf16 v[80:95], v[48:51], v[36:39], v[80:95]
    ds_read_b128 v[32:35], v16 offset:0
    ds_read_b128 v[36:39], v16 offset:2048
    ds_read_b64_tr_b16 v[48:49], v20 offset:0
    ds_read_b64_tr_b16 v[50:51], v20 offset:512
    s_waitcnt lgkmcnt(4)
    v_mfma_f32_32x32x16_bf16 v[64:79], v[56:59], v[40:43], v[64:79]
    v_mfma_f32_32x32x16_bf16 v[80:95], v[56:59], v[44:47], v[80:95]
    s_waitcnt vmcnt(3)
    s_barrier
    s_add_u32 m0, s38, 49152
    s_nop 0
    buffer_load_dwordx4 v21, s[40:43], s28 offen lds
    s_add_u32 m0, s38, 53248
    s_nop 0
    buffer_load_dwordx4 v21, s[40:43], s29 offen lds
    s_add_u32 m0, s38, 57344
    s_nop 0
    buffer_load_dwordx4 v22, s[12:15], s32 offen lds
    s_add_u32 s28, s28, 64
    s_add_u32 s29, s29, 64
    s_add_u32 s32, s32, s36
    ds_read_b128 v[40:43], v17 offset:0
    ds_read_b128 v[44:47], v17 offset:2048
    ds_read_b64_tr_b16 v[56:57], v20 offset:2048
    ds_read_b64_tr_b16 v[58:59], v20 offset:2560
    s_waitcnt lgkmcnt(4)
    v_mfma_f32_32x32x16_bf16 v[64:79], v[48:51], v[32:35], v[64:79]
    v_mfma_f32_32x32x16_bf16 v[80:95], v[48:51], v[36:39], v[80:95]
    ds_read_b128 v[32:35], v16 offset:16384
    ds_read_b128 v[36:39], v16 offset:18432
    ds_read_b64_tr_b16 v[48:49], v20 offset:16384
    ds_read_b64_tr_b16 v[50:51], v20 offset:16896
    s_waitcnt lgkmcnt(4)
    v_mfma_f32_32x32x16_bf16 v[64:79], v[56:59], v[40:43], v[64:79]
    v_mfma_f32_32x32x16_bf16 v[80:95], v[56:59], v[44:47], v[80:95]
    s_waitcnt vmcnt(3)
    s_barrier
    s_add_u32 m0, s38, 0
    s_nop 0
    buffer_load_dwordx4 v21, s[40:43], s28 offen lds
    s_add_u32 m0, s38, 4096
    s_nop 0
    buffer_load_dwordx4 v21, s[40:43], s29 offen lds
    s_add_u32 m0, s38, 8192
    s_nop 0
    buffer_load_dwordx4 v22, s[12:15], s32 offen lds
    s_add_u32 s28, s28, 64
    s_add_u32 s29, s29, 64
    s_add_u32 s32, s32, s36
    ds_read_b128 v[40:43], v17 offset:16384
    ds_read_b128 v[44:47], v17 offset:18432
    ds_read_b64_tr_b16 v[56:57], v20 offset:18432
    ds_read_b64_tr_b16 v[58:59], v20 offset:18944
    s_waitcnt lgkmcnt(4)
    v_mfma_f32_32x32x16_bf16 v[64:79], v[48:51], v[32:35], v[64:79]
    v_mfma_f32_32x32x16_bf16 v[80:95], v[48:51], v[36:39], v[80:95]
    ds_read_b128 v[32:35], v16 offset:32768
    ds_read_b128 v[36:39], v16 offset:34816
    ds_read_b64_tr_b16 v[48:49], v20 offset:32768
    ds_read_b64_tr_b16 v[50:51], v20 offset:33280
    s_waitcnt lgkmcnt(4)
    v_mfma_f32_32x32x16_bf16 v[64:79], v[56:59], v[40:43], v[64:79]
    v_mfma_f32_32x32x16_bf16 v[80:95], v[56:59], v[44:47], v[80:95]
    s_waitcnt vmcnt(3)
    s_barrier
    s_add_u32 m0, s38, 16384
    s_nop 0
    buffer_load_dwordx4 v21, s[40:43], s28 offen lds
    s_add_u32 m0, s38, 20480
    s_nop 0
    buffer_load_dwordx4 v21, s[40:43], s29 offen lds
    s_add_u32 m0, s38, 24576
    s_nop 0
    buffer_load_dwordx4 v22, s[12:15], s32 offen lds
    s_add_u32 s28, s28, 64
    s_add_u32 s29, s29, 64
    s_add_u32 s32, s32, s36
    ds_read_b128 v[40:43], v17 offset:32768
    ds_read_b128 v[44:47], v17 offset:34816
    ds_read_b64_tr_b16 v[56:57], v20 offset:34816
    ds_read_b64_tr_b16 v[58:59], v20 offset:35328
    s_waitcnt lgkmcnt(4)
    v_mfma_f32_32x32x16_bf16 v[64:79], v[48:51], v[32:35], v[64:79]
    v_mfma_f32_32x32x16_bf16 v[80:95], v[48:51], v[36:39], v[80:95]
    ds_read_b128 v[32:35], v16 offset:49152
    ds_read_b128 v[36:39], v16 offset:51200
    ds_read_b64_tr_b16 v[48:49], v20 offset:49152
    ds_read_b64_tr_b16 v[50:51], v20 offset:49664
    s_waitcnt lgkmcnt(4)
    v_mfma_f32_32x32x16_bf16 v[64:79], v[56:59], v[40:43], v[64:79]
    v_mfma_f32_32x32x16_bf16 v[80:95], v[56:59], v[44:47], v[80:95]
    s_waitcnt vmcnt(3)
    s_barrier
    s_add_u32 m0, s38, 32768
    s_nop 0
    buffer_load_dwordx4 v21, s[40:43], s28 offen lds
    s_add_u32 m0, s38, 36864
    s_nop 0
    buffer_load_dwordx4 v21, s[40:43], s29 offen lds
    s_add_u32 m0, s38, 40960
    s_nop 0
    buffer_load_dwordx4 v22, s[12:15], s32 offen lds
    s_add_u32 s28, s28, 64
    s_add_u32 s29, s29, 64
    s_add_u32 s32, s32, s36
    ds_read_b128 v[40:43], v17 offset:49152
    ds_read_b128 v[44:47], v17 offset:51200
    ds_read_b64_tr_b16 v[56:57], v20 offset:51200
    ds_read_b64_tr_b16 v[58:59], v20 offset:51712
    s_waitcnt lgkmcnt(4)
    v_mfma_f32_32x32x16_bf16 v[64:79], v[48:51], v[32:35], v[64:79]
    v_mfma_f32_32x32x16_bf16 v[80:95], v[48:51], v[36:39], v[80:95]
    ds_read_b128 v[32:35], v16 offset:0
    ds_read_b128 v[36:39], v16 offset:2048
    ds_read_b64_tr_b16 v[48:49], v20 offset:0
    ds_read_b64_tr_b16 v[50:51], v20 offset:512
    s_waitcnt lgkmcnt(4)
    v_mfma_f32_32x32x16_bf16 v[64:79], v[56:59], v[40:43], v[64:79]
    v_mfma_f32_32x32x16_bf16 v[80:95], v[56:59], v[44:47], v[80:95]
    s_waitcnt vmcnt(3)
    s_barrier
    s_add_u32 m0, s38, 49152
    s_nop 0
    buffer_load_dwordx4 v21, s[40:43], s28 offen lds
    s_add_u32 m0, s38, 53248
    s_nop 0
    buffer_load_dwordx4 v21, s[40:43], s29 offen lds
    s_add_u32 m0, s38, 57344
    s_nop 0
    buffer_load_dwordx4 v22, s[12:15], s32 offen lds
    s_add_u32 s28, s28, 64
    s_add_u32 s29, s29, 64
    s_add_u32 s32, s32, s36
    ds_read_b128 v[40:43], v17 offset:0
    ds_read_b128 v[44:47], v17 offset:2048
    ds_read_b64_tr_b16 v[56:57], v20 offset:2048
    ds_read_b64_tr_b16 v[58:59], v20 offset:2560
    s_waitcnt lgkmcnt(4)
    v_mfma_f32_32x32x16_bf16 v[64:79], v[48:51], v[32:35], v[64:79]
    v_mfma_f32_32x32x16_bf16 v[80:95], v[48:51], v[36:39], v[80:95]
    ds_read_b128 v[32:35], v16 offset:16384
    ds_read_b128 v[36:39], v16 offset:18432
    ds_read_b64_tr_b16 v[48:49], v20 offset:16384
    ds_read_b64_tr_b16 v[50:51], v20 offset:16896
    s_waitcnt lgkmcnt(4)
    v_mfma_f32_32x32x16_bf16 v[64:79], v[56:59], v[40:43], v[64:79]
    v_mfma_f32_32x32x16_bf16 v[80:95], v[56:59], v[44:47], v[80:95]
    s_waitcnt vmcnt(3)
    s_barrier
    s_add_u32 m0, s38, 0
    s_nop 0
    buffer_load_dwordx4 v21, s[40:43], s28 offen lds
    s_add_u32 m0, s38, 4096
    s_nop 0
    buffer_load_dwordx4 v21, s[40:43], s29 offen lds
    s_add_u32 m0, s38, 8192
    s_nop 0
    buffer_load_dwordx4 v22, s[12:15], s32 offen lds
    s_add_u32 s28, s28, 64
    s_add_u32 s29, s29, 64
    s_add_u32 s32, s32, s36
    ds_read_b128 v[40:43], v17 offset:16384
    ds_read_b128 v[44:47], v17 offset:18432
    ds_read_b64_tr_b16 v[56:57], v20 offset:18432
    ds_read_b64_tr_b16 v[58:59], v20 offset:18944
    s_waitcnt lgkmcnt(4)
    v_mfma_f32_32x32x16_bf16 v[64:79], v[48:51], v[32:35], v[64:79]
    v_mfma_f32_32x32x16_bf16 v[80:95], v[48:51], v[36:39], v[80:95]
    ds_read_b128 v[32:35], v16 offset:32768
    ds_read_b128 v[36:39], v16 offset:34816
    ds_read_b64_tr_b16 v[48:49], v20 offset:32768
    ds_read_b64_tr_b16 v[50:51], v20 offset:33280
    s_waitcnt lgkmcnt(4)
    v_mfma_f32_32x32x16_bf16 v[64:79], v[56:59], v[40:43], v[64:79]
    v_mfma_f32_32x32x16_bf16 v[80:95], v[56:59], v[44:47], v[80:95]
    s_waitcnt vmcnt(3)
    s_barrier
    s_add_u32 m0, s38, 16384
    s_nop 0
    buffer_load_dwordx4 v21, s[40:43], s28 offen lds
    s_add_u32 m0, s38, 20480
    s_nop 0
    buffer_load_dwordx4 v21, s[40:43], s29 offen lds
    s_add_u32 m0, s38, 24576
    s_nop 0
    buffer_load_dwordx4 v22, s[12:15], s32 offen lds
    s_add_u32 s28, s28, 64
    s_add_u32 s29, s29, 64
    s_add_u32 s32, s32, s36
    ds_read_b128 v[40:43], v17 offset:32768
    ds_read_b128 v[44:47], v17 offset:34816
    ds_read_b64_tr_b16 v[56:57], v20 offset:34816
    ds_read_b64_tr_b16 v[58:59], v20 offset:35328
    s_waitcnt lgkmcnt(4)
    v_mfma_f32_32x32x16_bf16 v[64:79], v[48:51], v[32:35], v[64:79]
    v_mfma_f32_32x32x16_bf16 v[80:95], v[48:51], v[36:39], v[80:95]
    ds_read_b128 v[32:35], v16 offset:49152
    ds_read_b128 v[36:39], v16 offset:51200
    ds_read_b64_tr_b16 v[48:49], v20 offset:49152
    ds_read_b64_tr_b16 v[50:51], v20 offset:49664
    s_waitcnt lgkmcnt(4)
    v_mfma_f32_32x32x16_bf16 v[64:79], v[56:59], v[40:43], v[64:79]
    v_mfma_f32_32x32x16_bf16 v[80:95], v[56:59], v[44:47], v[80:95]
    s_waitcnt vmcnt(3)
    s_barrier
    s_add_u32 m0, s38, 32768
    s_nop 0
    buffer_load_dwordx4 v21, s[40:43], s28 offen lds
    s_add_u32 m0, s38, 36864
    s_nop 0
    buffer_load_dwordx4 v21, s[40:43], s29 offen lds
    s_add_u32 m0, s38, 40960
    s_nop 0
    buffer_load_dwordx4 v22, s[12:15], s32 offen lds
    s_add_u32 s28, s28, 64
    s_add_u32 s29, s29, 64
    s_add_u32 s32, s32, s36
    ds_read_b128 v[40:43], v17 offset:49152
    ds_read_b128 v[44:47], v17 offset:51200
    ds_read_b64_tr_b16 v[56:57], v20 offset:51200
    ds_read_b64_tr_b16 v[58:59], v20 offset:51712
    s_waitcnt lgkmcnt(4)
    v_mfma_f32_32x32x16_bf16 v[64:79], v[48:51], v[32:35], v[64:79]
    v_mfma_f32_32x32x16_bf16 v[80:95], v[48:51], v[36:39], v[80:95]
    ds_read_b128 v[32:35], v16 offset:0
    ds_read_b128 v[36:39], v16 offset:2048
    ds_read_b64_tr_b16 v[48:49], v20 offset:0
    ds_read_b64_tr_b16 v[50:51], v20 offset:512
    s_waitcnt lgkmcnt(4)
    v_mfma_f32_32x32x16_bf16 v[64:79], v[56:59], v[40:43], v[64:79]
    v_mfma_f32_32x32x16_bf16 v[80:95], v[56:59], v[44:47], v[80:95]
    s_waitcnt vmcnt(3)
    s_barrier
    s_add_u32 m0, s38, 49152
    s_nop 0
    buffer_load_dwordx4 v21, s[40:43], s28 offen lds
    s_add_u32 m0, s38, 53248
    s_nop 0
    buffer_load_dwordx4 v21, s[40:43], s29 offen lds
    s_add_u32 m0, s38, 57344
    s_nop 0
    buffer_load_dwordx4 v22, s[12:15], s32 offen lds
    s_add_u32 s28, s28, 64
    s_add_u32 s29, s29, 64
    s_add_u32 s32, s32, s36
    ds_read_b128 v[40:43], v17 offset:0
    ds_read_b128 v[44:47], v17 offset:2048
    ds_read_b64_tr_b16 v[56:57], v20 offset:2048
    ds_read_b64_tr_b16 v[58:59], v20 offset:2560
    s_waitcnt lgkmcnt(4)
    v_mfma_f32_32x32x16_bf16 v[64:79], v[48:51], v[32:35], v[64:79]
    v_mfma_f32_32x32x16_bf16 v[80:95], v[48:51], v[36:39], v[80:95]
    ds_read_b128 v[32:35], v16 offset:16384
    ds_read_b128 v[36:39], v16 offset:18432
    ds_read_b64_tr_b16 v[48:49], v20 offset:16384
    ds_read_b64_tr_b16 v[50:51], v20 offset:16896
    s_waitcnt lgkmcnt(4)
    v_mfma_f32_32x32x16_bf16 v[64:79], v[56:59], v[40:43], v[64:79]
    v_mfma_f32_32x32x16_bf16 v[80:95], v[56:59], v[44:47], v[80:95]
    s_waitcnt vmcnt(3)
    s_barrier
    s_add_u32 m0, s38, 0
    s_nop 0
    buffer_load_dwordx4 v21, s[40:43], s28 offen lds
    s_add_u32 m0, s38, 4096
    s_nop 0
    buffer_load_dwordx4 v21, s[40:43], s29 offen lds
    s_add_u32 m0, s38, 8192
    s_nop 0
    buffer_load_dwordx4 v22, s[12:15], s32 offen lds
    s_add_u32 s28, s28, 64
    s_add_u32 s29, s29, 64
    s_add_u32 s32, s32, s36
    ds_read_b128 v[40:43], v17 offset:16384
    ds_read_b128 v[44:47], v17 offset:18432
    ds_read_b64_tr_b16 v[56:57], v20 offset:18432
    ds_read_b64_tr_b16 v[58:59], v20 offset:18944
    s_waitcnt lgkmcnt(4)
    v_mfma_f32_32x32x16_bf16 v[64:79], v[48:51], v[32:35], v[64:79]
    v_mfma_f32_32x32x16_bf16 v[80:95], v[48:51], v[36:39], v[80:95]
    ds_read_b128 v[32:35], v16 offset:32768
    ds_read_b128 v[36:39], v16 offset:34816
    ds_read_b64_tr_b16 v[48:49], v20 offset:32768
    ds_read_b64_tr_b16 v[50:51], v20 offset:33280
    s_waitcnt lgkmcnt(4)
    v_mfma_f32_32x32x16_bf16 v[64:79], v[56:59], v[40:43], v[64:79]
    v_mfma_f32_32x32x16_bf16 v[80:95], v[56:59], v[44:47], v[80:95]
    s_waitcnt vmcnt(3)
    s_barrier
    s_add_u32 m0, s38, 16384
    s_nop 0
    buffer_load_dwordx4 v21, s[40:43], s28 offen lds
    s_add_u32 m0, s38, 20480
    s_nop 0
    buffer_load_dwordx4 v21, s[40:43], s29 offen lds
    s_add_u32 m0, s38, 24576
    s_nop 0
    buffer_load_dwordx4 v22, s[12:15], s32 offen lds
    s_add_u32 s28, s28, 64
    s_add_u32 s29, s29, 64
    s_add_u32 s32, s32, s36
    ds_read_b128 v[40:43], v17 offset:32768
    ds_read_b128 v[44:47], v17 offset:34816
    ds_read_b64_tr_b16 v[56:57], v20 offset:34816
    ds_read_b64_tr_b16 v[58:59], v20 offset:35328
    s_waitcnt lgkmcnt(4)
    v_mfma_f32_32x32x16_bf16 v[64:79], v[48:51], v[32:35], v[64:79]
    v_mfma_f32_32x32x16_bf16 v[80:95], v[48:51], v[36:39], v[80:95]
    ds_read_b128 v[32:35], v16 offset:49152
    ds_read_b128 v[36:39], v16 offset:51200
    ds_read_b64_tr_b16 v[48:49], v20 offset:49152
    ds_read_b64_tr_b16 v[50:51], v20 offset:49664
    s_waitcnt lgkmcnt(4)
    v_mfma_f32_32x32x16_bf16 v[64:79], v[56:59], v[40:43], v[64:79]
    v_mfma_f32_32x32x16_bf16 v[80:95], v[56:59], v[44:47], v[80:95]
    s_waitcnt vmcnt(3)
    s_barrier
    s_add_u32 m0, s38, 32768
    s_nop 0
    buffer_load_dwordx4 v21, s[40:43], s28 offen lds
    s_add_u32 m0, s38, 36864
    s_nop 0
    buffer_load_dwordx4 v21, s[40:43], s29 offen lds
    s_add_u32 m0, s38, 40960
    s_nop 0
    buffer_load_dwordx4 v22, s[12:15], s32 offen lds
    s_add_u32 s28, s28, 64
    s_add_u32 s29, s29, 64
    s_add_u32 s32, s32, s36
    ds_read_b128 v[40:43], v17 offset:49152
    ds_read_b128 v[44:47], v17 offset:51200
    ds_read_b64_tr_b16 v[56:57], v20 offset:51200
    ds_read_b64_tr_b16 v[58:59], v20 offset:51712
    s_waitcnt lgkmcnt(4)
    v_mfma_f32_32x32x16_bf16 v[64:79], v[48:51], v[32:35], v[64:79]
    v_mfma_f32_32x32x16_bf16 v[80:95], v[48:51], v[36:39], v[80:95]
    ds_read_b128 v[32:35], v16 offset:0
    ds_read_b128 v[36:39], v16 offset:2048
    ds_read_b64_tr_b16 v[48:49], v20 offset:0
    ds_read_b64_tr_b16 v[50:51], v20 offset:512
    s_waitcnt lgkmcnt(4)
    v_mfma_f32_32x32x16_bf16 v[64:79], v[56:59], v[40:43], v[64:79]
    v_mfma_f32_32x32x16_bf16 v[80:95], v[56:59], v[44:47], v[80:95]
    s_waitcnt vmcnt(3)
    s_barrier
    s_add_u32 m0, s38, 49152
    s_nop 0
    buffer_load_dwordx4 v21, s[40:43], s28 offen lds
    s_add_u32 m0, s38, 53248
    s_nop 0
    buffer_load_dwordx4 v21, s[40:43], s29 offen lds
    s_add_u32 m0, s38, 57344
    s_nop 0
    buffer_load_dwordx4 v22, s[12:15], s32 offen lds
    s_add_u32 s28, s28, 64
    s_add_u32 s29, s29, 64
    s_add_u32 s32, s32, s36
    ds_read_b128 v[40:43], v17 offset:0
    ds_read_b128 v[44:47], v17 offset:2048
    ds_read_b64_tr_b16 v[56:57], v20 offset:2048
    ds_read_b64_tr_b16 v[58:59], v20 offset:2560
    s_waitcnt lgkmcnt(4)
    v_mfma_f32_32x32x16_bf16 v[64:79], v[48:51], v[32:35], v[64:79]
    v_mfma_f32_32x32x16_bf16 v[80:95], v[48:51], v[36:39], v[80:95]
    ds_read_b128 v[32:35], v16 offset:16384
    ds_read_b128 v[36:39], v16 offset:18432
    ds_read_b64_tr_b16 v[48:49], v20 offset:16384
    ds_read_b64_tr_b16 v[50:51], v20 offset:16896
    s_waitcnt lgkmcnt(4)
    v_mfma_f32_32x32x16_bf16 v[64:79], v[56:59], v[40:43], v[64:79]
    v_mfma_f32_32x32x16_bf16 v[80:95], v[56:59], v[44:47], v[80:95]
    s_waitcnt vmcnt(3)
    s_barrier
    s_add_u32 m0, s38, 0
    s_nop 0
    buffer_load_dwordx4 v21, s[40:43], s28 offen lds
    s_add_u32 m0, s38, 4096
    s_nop 0
    buffer_load_dwordx4 v21, s[40:43], s29 offen lds
    s_add_u32 m0, s38, 8192
    s_nop 0
    buffer_load_dwordx4 v22, s[12:15], s32 offen lds
    s_add_u32 s28, s28, 64
    s_add_u32 s29, s29, 64
    s_add_u32 s32, s32, s36
    ds_read_b128 v[40:43], v17 offset:16384
    ds_read_b128 v[44:47], v17 offset:18432
    ds_read_b64_tr_b16 v[56:57], v20 offset:18432
    ds_read_b64_tr_b16 v[58:59], v20 offset:18944
    s_waitcnt lgkmcnt(4)
    v_mfma_f32_32x32x16_bf16 v[64:79], v[48:51], v[32:35], v[64:79]
    v_mfma_f32_32x32x16_bf16 v[80:95], v[48:51], v[36:39], v[80:95]
    ds_read_b128 v[32:35], v16 offset:32768
    ds_read_b128 v[36:39], v16 offset:34816
    ds_read_b64_tr_b16 v[48:49], v20 offset:32768
    ds_read_b64_tr_b16 v[50:51], v20 offset:33280
    s_waitcnt lgkmcnt(4)
    v_mfma_f32_32x32x16_bf16 v[64:79], v[56:59], v[40:43], v[64:79]
    v_mfma_f32_32x32x16_bf16 v[80:95], v[56:59], v[44:47], v[80:95]
    s_waitcnt vmcnt(3)
    s_barrier
    s_add_u32 m0, s38, 16384
    s_nop 0
    buffer_load_dwordx4 v21, s[40:43], s28 offen lds
    s_add_u32 m0, s38, 20480
    s_nop 0
    buffer_load_dwordx4 v21, s[40:43], s29 offen lds
    s_add_u32 m0, s38, 24576
    s_nop 0
    buffer_load_dwordx4 v22, s[12:15], s32 offen lds
    s_add_u32 s28, s28, 64
    s_add_u32 s29, s29, 64
    s_add_u32 s32, s32, s36
    ds_read_b128 v[40:43], v17 offset:32768
    ds_read_b128 v[44:47], v17 offset:34816
    ds_read_b64_tr_b16 v[56:57], v20 offset:34816
    ds_read_b64_tr_b16 v[58:59], v20 offset:35328
    s_waitcnt lgkmcnt(4)
    v_mfma_f32_32x32x16_bf16 v[64:79], v[48:51], v[32:35], v[64:79]
    v_mfma_f32_32x32x16_bf16 v[80:95], v[48:51], v[36:39], v[80:95]
    ds_read_b128 v[32:35], v16 offset:49152
    ds_read_b128 v[36:39], v16 offset:51200
    ds_read_b64_tr_b16 v[48:49], v20 offset:49152
    ds_read_b64_tr_b16 v[50:51], v20 offset:49664
    s_waitcnt lgkmcnt(4)
    v_mfma_f32_32x32x16_bf16 v[64:79], v[56:59], v[40:43], v[64:79]
    v_mfma_f32_32x32x16_bf16 v[80:95], v[56:59], v[44:47], v[80:95]
    s_waitcnt vmcnt(3)
    s_barrier
    s_add_u32 m0, s38, 32768
    s_nop 0
    buffer_load_dwordx4 v21, s[40:43], s28 offen lds
    s_add_u32 m0, s38, 36864
    s_nop 0
    buffer_load_dwordx4 v21, s[40:43], s29 offen lds
    s_add_u32 m0, s38, 40960
    s_nop 0
    buffer_load_dwordx4 v22, s[12:15], s32 offen lds
    s_add_u32 s28, s28, 64
    s_add_u32 s29, s29, 64
    s_add_u32 s32, s32, s36
    ds_read_b128 v[40:43], v17 offset:49152
    ds_read_b128 v[44:47], v17 offset:51200
    ds_read_b64_tr_b16 v[56:57], v20 offset:51200
    ds_read_b64_tr_b16 v[58:59], v20 offset:51712
    s_waitcnt lgkmcnt(4)
    v_mfma_f32_32x32x16_bf16 v[64:79], v[48:51], v[32:35], v[64:79]
    v_mfma_f32_32x32x16_bf16 v[80:95], v[48:51], v[36:39], v[80:95]
    ds_read_b128 v[32:35], v16 offset:0
    ds_read_b128 v[36:39], v16 offset:2048
    ds_read_b64_tr_b16 v[48:49], v20 offset:0
    ds_read_b64_tr_b16 v[50:51], v20 offset:512
    s_waitcnt lgkmcnt(4)
    v_mfma_f32_32x32x16_bf16 v[64:79], v[56:59], v[40:43], v[64:79]
    v_mfma_f32_32x32x16_bf16 v[80:95], v[56:59], v[44:47], v[80:95]
    s_waitcnt vmcnt(3)
    s_barrier
    s_add_u32 m0, s38, 49152
    s_nop 0
    buffer_load_dwordx4 v21, s[40:43], s28 offen lds
    s_add_u32 m0, s38, 53248
    s_nop 0
    buffer_load_dwordx4 v21, s[40:43], s29 offen lds
    s_add_u32 m0, s38, 57344
    s_nop 0
    buffer_load_dwordx4 v22, s[12:15], s32 offen lds
    s_add_u32 s28, s28, 64
    s_add_u32 s29, s29, 64
    s_add_u32 s32, s32, s36
    ds_read_b128 v[40:43], v17 offset:0
    ds_read_b128 v[44:47], v17 offset:2048
    ds_read_b64_tr_b16 v[56:57], v20 offset:2048
    ds_read_b64_tr_b16 v[58:59], v20 offset:2560
    s_waitcnt lgkmcnt(4)
    v_mfma_f32_32x32x16_bf16 v[64:79], v[48:51], v[32:35], v[64:79]
    v_mfma_f32_32x32x16_bf16 v[80:95], v[48:51], v[36:39], v[80:95]
    ds_read_b128 v[32:35], v16 offset:16384
    ds_read_b128 v[36:39], v16 offset:18432
    ds_read_b64_tr_b16 v[48:49], v20 offset:16384
    ds_read_b64_tr_b16 v[50:51], v20 offset:16896
    s_waitcnt lgkmcnt(4)
    v_mfma_f32_32x32x16_bf16 v[64:79], v[56:59], v[40:43], v[64:79]
    v_mfma_f32_32x32x16_bf16 v[80:95], v[56:59], v[44:47], v[80:95]
    s_waitcnt vmcnt(3)
    s_barrier
    s_add_u32 m0, s38, 0
    s_nop 0
    buffer_load_dwordx4 v21, s[40:43], s28 offen lds
    s_add_u32 m0, s38, 4096
    s_nop 0
    buffer_load_dwordx4 v21, s[40:43], s29 offen lds
    s_add_u32 m0, s38, 8192
    s_nop 0
    buffer_load_dwordx4 v22, s[12:15], s32 offen lds
    s_add_u32 s28, s28, 64
    s_add_u32 s29, s29, 64
    s_add_u32 s32, s32, s36
    ds_read_b128 v[40:43], v17 offset:16384
    ds_read_b128 v[44:47], v17 offset:18432
    ds_read_b64_tr_b16 v[56:57], v20 offset:18432
    ds_read_b64_tr_b16 v[58:59], v20 offset:18944
    s_waitcnt lgkmcnt(4)
    v_mfma_f32_32x32x16_bf16 v[64:79], v[48:51], v[32:35], v[64:79]
    v_mfma_f32_32x32x16_bf16 v[80:95], v[48:51], v[36:39], v[80:95]
    ds_read_b128 v[32:35], v16 offset:32768
    ds_read_b128 v[36:39], v16 offset:34816
    ds_read_b64_tr_b16 v[48:49], v20 offset:32768
    ds_read_b64_tr_b16 v[50:51], v20 offset:33280
    s_waitcnt lgkmcnt(4)
    v_mfma_f32_32x32x16_bf16 v[64:79], v[56:59], v[40:43], v[64:79]
    v_mfma_f32_32x32x16_bf16 v[80:95], v[56:59], v[44:47], v[80:95]
    s_waitcnt vmcnt(3)
    s_barrier
    s_add_u32 m0, s38, 16384
    s_nop 0
    buffer_load_dwordx4 v21, s[40:43], s28 offen lds
    s_add_u32 m0, s38, 20480
    s_nop 0
    buffer_load_dwordx4 v21, s[40:43], s29 offen lds
    s_add_u32 m0, s38, 24576
    s_nop 0
    buffer_load_dwordx4 v22, s[12:15], s32 offen lds
    s_add_u32 s28, s28, 64
    s_add_u32 s29, s29, 64
    s_add_u32 s32, s32, s36
    ds_read_b128 v[40:43], v17 offset:32768
    ds_read_b128 v[44:47], v17 offset:34816
    ds_read_b64_tr_b16 v[56:57], v20 offset:34816
    ds_read_b64_tr_b16 v[58:59], v20 offset:35328
    s_waitcnt lgkmcnt(4)
    v_mfma_f32_32x32x16_bf16 v[64:79], v[48:51], v[32:35], v[64:79]
    v_mfma_f32_32x32x16_bf16 v[80:95], v[48:51], v[36:39], v[80:95]
    ds_read_b128 v[32:35], v16 offset:49152
    ds_read_b128 v[36:39], v16 offset:51200
    ds_read_b64_tr_b16 v[48:49], v20 offset:49152
    ds_read_b64_tr_b16 v[50:51], v20 offset:49664
    s_waitcnt lgkmcnt(4)
    v_mfma_f32_32x32x16_bf16 v[64:79], v[56:59], v[40:43], v[64:79]
    v_mfma_f32_32x32x16_bf16 v[80:95], v[56:59], v[44:47], v[80:95]
    s_waitcnt vmcnt(3)
    s_barrier
    s_add_u32 m0, s38, 32768
    s_nop 0
    buffer_load_dwordx4 v21, s[40:43], s28 offen lds
    s_add_u32 m0, s38, 36864
    s_nop 0
    buffer_load_dwordx4 v21, s[40:43], s29 offen lds
    s_add_u32 m0, s38, 40960
    s_nop 0
    buffer_load_dwordx4 v22, s[12:15], s32 offen lds
    s_add_u32 s28, s28, 64
    s_add_u32 s29, s29, 64
    s_add_u32 s32, s32, s36
    ds_read_b128 v[40:43], v17 offset:49152
    ds_read_b128 v[44:47], v17 offset:51200
    ds_read_b64_tr_b16 v[56:57], v20 offset:51200
    ds_read_b64_tr_b16 v[58:59], v20 offset:51712
    s_waitcnt lgkmcnt(4)
    v_mfma_f32_32x32x16_bf16 v[64:79], v[48:51], v[32:35], v[64:79]
    v_mfma_f32_32x32x16_bf16 v[80:95], v[48:51], v[36:39], v[80:95]
    ds_read_b128 v[32:35], v16 offset:0
    ds_read_b128 v[36:39], v16 offset:2048
    ds_read_b64_tr_b16 v[48:49], v20 offset:0
    ds_read_b64_tr_b16 v[50:51], v20 offset:512
    s_waitcnt lgkmcnt(4)
    v_mfma_f32_32x32x16_bf16 v[64:79], v[56:59], v[40:43], v[64:79]
    v_mfma_f32_32x32x16_bf16 v[80:95], v[56:59], v[44:47], v[80:95]
    s_waitcnt vmcnt(3)
    s_barrier
    s_add_u32 m0, s38, 49152
    s_nop 0
    buffer_load_dwordx4 v21, s[40:43], s28 offen lds
    s_add_u32 m0, s38, 53248
    s_nop 0
    buffer_load_dwordx4 v21, s[40:43], s29 offen lds
    s_add_u32 m0, s38, 57344
    s_nop 0
    buffer_load_dwordx4 v22, s[12:15], s32 offen lds
    s_add_u32 s28, s28, 64
    s_add_u32 s29, s29, 64
    s_add_u32 s32, s32, s36
    ds_read_b128 v[40:43], v17 offset:0
    ds_read_b128 v[44:47], v17 offset:2048
    ds_read_b64_tr_b16 v[56:57], v20 offset:2048
    ds_read_b64_tr_b16 v[58:59], v20 offset:2560
    s_waitcnt lgkmcnt(4)
    v_mfma_f32_32x32x16_bf16 v[64:79], v[48:51], v[32:35], v[64:79]
    v_mfma_f32_32x32x16_bf16 v[80:95], v[48:51], v[36:39], v[80:95]
    ds_read_b128 v[32:35], v16 offset:16384
    ds_read_b128 v[36:39], v16 offset:18432
    ds_read_b64_tr_b16 v[48:49], v20 offset:16384
    ds_read_b64_tr_b16 v[50:51], v20 offset:16896
    s_waitcnt lgkmcnt(4)
    v_mfma_f32_32x32x16_bf16 v[64:79], v[56:59], v[40:43], v[64:79]
    v_mfma_f32_32x32x16_bf16 v[80:95], v[56:59], v[44:47], v[80:95]
    s_waitcnt vmcnt(3)
    s_barrier
    s_add_u32 m0, s38, 0
    s_nop 0
    buffer_load_dwordx4 v21, s[40:43], s28 offen lds
    s_add_u32 m0, s38, 4096
    s_nop 0
    buffer_load_dwordx4 v21, s[40:43], s29 offen lds
    s_add_u32 m0, s38, 8192
    s_nop 0
    buffer_load_dwordx4 v22, s[12:15], s32 offen lds
    s_add_u32 s28, s28, 64
    s_add_u32 s29, s29, 64
    s_add_u32 s32, s32, s36
    ds_read_b128 v[40:43], v17 offset:16384
    ds_read_b128 v[44:47], v17 offset:18432
    ds_read_b64_tr_b16 v[56:57], v20 offset:18432
    ds_read_b64_tr_b16 v[58:59], v20 offset:18944
    s_waitcnt lgkmcnt(4)
    v_mfma_f32_32x32x16_bf16 v[64:79], v[48:51], v[32:35], v[64:79]
    v_mfma_f32_32x32x16_bf16 v[80:95], v[48:51], v[36:39], v[80:95]
    ds_read_b128 v[32:35], v16 offset:32768
    ds_read_b128 v[36:39], v16 offset:34816
    ds_read_b64_tr_b16 v[48:49], v20 offset:32768
    ds_read_b64_tr_b16 v[50:51], v20 offset:33280
    s_waitcnt lgkmcnt(4)
    v_mfma_f32_32x32x16_bf16 v[64:79], v[56:59], v[40:43], v[64:79]
    v_mfma_f32_32x32x16_bf16 v[80:95], v[56:59], v[44:47], v[80:95]
    s_waitcnt vmcnt(3)
    s_barrier
    s_add_u32 m0, s38, 16384
    s_nop 0
    buffer_load_dwordx4 v21, s[40:43], s28 offen lds
    s_add_u32 m0, s38, 20480
    s_nop 0
    buffer_load_dwordx4 v21, s[40:43], s29 offen lds
    s_add_u32 m0, s38, 24576
    s_nop 0
    buffer_load_dwordx4 v22, s[12:15], s32 offen lds
    s_add_u32 s28, s28, 64
    s_add_u32 s29, s29, 64
    s_add_u32 s32, s32, s36
    ds_read_b128 v[40:43], v17 offset:32768
    ds_read_b128 v[44:47], v17 offset:34816
    ds_read_b64_tr_b16 v[56:57], v20 offset:34816
    ds_read_b64_tr_b16 v[58:59], v20 offset:35328
    s_waitcnt lgkmcnt(4)
    v_mfma_f32_32x32x16_bf16 v[64:79], v[48:51], v[32:35], v[64:79]
    v_mfma_f32_32x32x16_bf16 v[80:95], v[48:51], v[36:39], v[80:95]
    ds_read_b128 v[32:35], v16 offset:49152
    ds_read_b128 v[36:39], v16 offset:51200
    ds_read_b64_tr_b16 v[48:49], v20 offset:49152
    ds_read_b64_tr_b16 v[50:51], v20 offset:49664
    s_waitcnt lgkmcnt(4)
    v_mfma_f32_32x32x16_bf16 v[64:79], v[56:59], v[40:43], v[64:79]
    v_mfma_f32_32x32x16_bf16 v[80:95], v[56:59], v[44:47], v[80:95]
    s_waitcnt vmcnt(3)
    s_barrier
    s_add_u32 m0, s38, 32768
    s_nop 0
    buffer_load_dwordx4 v21, s[40:43], s28 offen lds
    s_add_u32 m0, s38, 36864
    s_nop 0
    buffer_load_dwordx4 v21, s[40:43], s29 offen lds
    s_add_u32 m0, s38, 40960
    s_nop 0
    buffer_load_dwordx4 v22, s[12:15], s32 offen lds
    s_add_u32 s28, s28, 64
    s_add_u32 s29, s29, 64
    s_add_u32 s32, s32, s36
    ds_read_b128 v[40:43], v17 offset:49152
    ds_read_b128 v[44:47], v17 offset:51200
    ds_read_b64_tr_b16 v[56:57], v20 offset:51200
    ds_read_b64_tr_b16 v[58:59], v20 offset:51712
    s_waitcnt lgkmcnt(4)
    v_mfma_f32_32x32x16_bf16 v[64:79], v[48:51], v[32:35], v[64:79]
    v_mfma_f32_32x32x16_bf16 v[80:95], v[48:51], v[36:39], v[80:95]
    ds_read_b128 v[32:35], v16 offset:0
    ds_read_b128 v[36:39], v16 offset:2048
    ds_read_b64_tr_b16 v[48:49], v20 offset:0
    ds_read_b64_tr_b16 v[50:51], v20 offset:512
    s_waitcnt lgkmcnt(4)
    v_mfma_f32_32x32x16_bf16 v[64:79], v[56:59], v[40:43], v[64:79]
    v_mfma_f32_32x32x16_bf16 v[80:95], v[56:59], v[44:47], v[80:95]
    s_waitcnt vmcnt(3)
    s_barrier
    s_add_u32 m0, s38, 49152
    s_nop 0
    buffer_load_dwordx4 v21, s[40:43], s28 offen lds
    s_add_u32 m0, s38, 53248
    s_nop 0
    buffer_load_dwordx4 v21, s[40:43], s29 offen lds
    s_add_u32 m0, s38, 57344
    s_nop 0
    buffer_load_dwordx4 v22, s[12:15], s32 offen lds
    s_add_u32 s28, s28, 64
    s_add_u32 s29, s29, 64
    s_add_u32 s32, s32, s36
    ds_read_b128 v[40:43], v17 offset:0
    ds_read_b128 v[44:47], v17 offset:2048
    ds_read_b64_tr_b16 v[56:57], v20 offset:2048
    ds_read_b64_tr_b16 v[58:59], v20 offset:2560
    s_waitcnt lgkmcnt(4)
    v_mfma_f32_32x32x16_bf16 v[64:79], v[48:51], v[32:35], v[64:79]
    v_mfma_f32_32x32x16_bf16 v[80:95], v[48:51], v[36:39], v[80:95]
    ds_read_b128 v[32:35], v16 offset:16384
    ds_read_b128 v[36:39], v16 offset:18432
    ds_read_b64_tr_b16 v[48:49], v20 offset:16384
    ds_read_b64_tr_b16 v[50:51], v20 offset:16896
    s_waitcnt lgkmcnt(4)
    v_mfma_f32_32x32x16_bf16 v[64:79], v[56:59], v[40:43], v[64:79]
    v_mfma_f32_32x32x16_bf16 v[80:95], v[56:59], v[44:47], v[80:95]
    s_waitcnt vmcnt(3)
    s_barrier
    s_add_u32 m0, s38, 0
    s_nop 0
    buffer_load_dwordx4 v21, s[40:43], s28 offen lds
    s_add_u32 m0, s38, 4096
    s_nop 0
    buffer_load_dwordx4 v21, s[40:43], s29 offen lds
    s_add_u32 m0, s38, 8192
    s_nop 0
    buffer_load_dwordx4 v22, s[12:15], s32 offen lds
    s_add_u32 s28, s28, 64
    s_add_u32 s29, s29, 64
    s_add_u32 s32, s32, s36
    ds_read_b128 v[40:43], v17 offset:16384
    ds_read_b128 v[44:47], v17 offset:18432
    ds_read_b64_tr_b16 v[56:57], v20 offset:18432
    ds_read_b64_tr_b16 v[58:59], v20 offset:18944
    s_waitcnt lgkmcnt(4)
    v_mfma_f32_32x32x16_bf16 v[64:79], v[48:51], v[32:35], v[64:79]
    v_mfma_f32_32x32x16_bf16 v[80:95], v[48:51], v[36:39], v[80:95]
    ds_read_b128 v[32:35], v16 offset:32768
    ds_read_b128 v[36:39], v16 offset:34816
    ds_read_b64_tr_b16 v[48:49], v20 offset:32768
    ds_read_b64_tr_b16 v[50:51], v20 offset:33280
    s_waitcnt lgkmcnt(4)
    v_mfma_f32_32x32x16_bf16 v[64:79], v[56:59], v[40:43], v[64:79]
    v_mfma_f32_32x32x16_bf16 v[80:95], v[56:59], v[44:47], v[80:95]
    s_waitcnt vmcnt(3)
    s_barrier
    s_add_u32 m0, s38, 16384
    s_nop 0
    buffer_load_dwordx4 v21, s[40:43], s28 offen lds
    s_add_u32 m0, s38, 20480
    s_nop 0
    buffer_load_dwordx4 v21, s[40:43], s29 offen lds
    s_add_u32 m0, s38, 24576
    s_nop 0
    buffer_load_dwordx4 v22, s[12:15], s32 offen lds
    s_add_u32 s28, s28, 64
    s_add_u32 s29, s29, 64
    s_add_u32 s32, s32, s36
    ds_read_b128 v[40:43], v17 offset:32768
    ds_read_b128 v[44:47], v17 offset:34816
    ds_read_b64_tr_b16 v[56:57], v20 offset:34816
    ds_read_b64_tr_b16 v[58:59], v20 offset:35328
    s_waitcnt lgkmcnt(4)
    v_mfma_f32_32x32x16_bf16 v[64:79], v[48:51], v[32:35], v[64:79]
    v_mfma_f32_32x32x16_bf16 v[80:95], v[48:51], v[36:39], v[80:95]
    ds_read_b128 v[32:35], v16 offset:49152
    ds_read_b128 v[36:39], v16 offset:51200
    ds_read_b64_tr_b16 v[48:49], v20 offset:49152
    ds_read_b64_tr_b16 v[50:51], v20 offset:49664
    s_waitcnt lgkmcnt(4)
    v_mfma_f32_32x32x16_bf16 v[64:79], v[56:59], v[40:43], v[64:79]
    v_mfma_f32_32x32x16_bf16 v[80:95], v[56:59], v[44:47], v[80:95]
    s_waitcnt vmcnt(3)
    s_barrier
    s_add_u32 m0, s38, 32768
    s_nop 0
    buffer_load_dwordx4 v21, s[40:43], s28 offen lds
    s_add_u32 m0, s38, 36864
    s_nop 0
    buffer_load_dwordx4 v21, s[40:43], s29 offen lds
    s_add_u32 m0, s38, 40960
    s_nop 0
    buffer_load_dwordx4 v22, s[12:15], s32 offen lds
    s_add_u32 s28, s28, 64
    s_add_u32 s29, s29, 64
    s_add_u32 s32, s32, s36
    ds_read_b128 v[40:43], v17 offset:49152
    ds_read_b128 v[44:47], v17 offset:51200
    ds_read_b64_tr_b16 v[56:57], v20 offset:51200
    ds_read_b64_tr_b16 v[58:59], v20 offset:51712
    s_waitcnt lgkmcnt(4)
    v_mfma_f32_32x32x16_bf16 v[64:79], v[48:51], v[32:35], v[64:79]
    v_mfma_f32_32x32x16_bf16 v[80:95], v[48:51], v[36:39], v[80:95]
    ds_read_b128 v[32:35], v16 offset:0
    ds_read_b128 v[36:39], v16 offset:2048
    ds_read_b64_tr_b16 v[48:49], v20 offset:0
    ds_read_b64_tr_b16 v[50:51], v20 offset:512
    s_waitcnt lgkmcnt(4)
    v_mfma_f32_32x32x16_bf16 v[64:79], v[56:59], v[40:43], v[64:79]
    v_mfma_f32_32x32x16_bf16 v[80:95], v[56:59], v[44:47], v[80:95]
    s_waitcnt vmcnt(3)
    s_barrier
    s_add_u32 m0, s38, 49152
    s_nop 0
    buffer_load_dwordx4 v21, s[40:43], s28 offen lds
    s_add_u32 m0, s38, 53248
    s_nop 0
    buffer_load_dwordx4 v21, s[40:43], s29 offen lds
    s_add_u32 m0, s38, 57344
    s_nop 0
    buffer_load_dwordx4 v22, s[12:15], s32 offen lds
    s_add_u32 s28, s28, 64
    s_add_u32 s29, s29, 64
    s_add_u32 s32, s32, s36
    ds_read_b128 v[40:43], v17 offset:0
    ds_read_b128 v[44:47], v17 offset:2048
    ds_read_b64_tr_b16 v[56:57], v20 offset:2048
    ds_read_b64_tr_b16 v[58:59], v20 offset:2560
    s_waitcnt lgkmcnt(4)
    v_mfma_f32_32x32x16_bf16 v[64:79], v[48:51], v[32:35], v[64:79]
    v_mfma_f32_32x32x16_bf16 v[80:95], v[48:51], v[36:39], v[80:95]
    ds_read_b128 v[32:35], v16 offset:16384
    ds_read_b128 v[36:39], v16 offset:18432
    ds_read_b64_tr_b16 v[48:49], v20 offset:16384
    ds_read_b64_tr_b16 v[50:51], v20 offset:16896
    s_waitcnt lgkmcnt(4)
    v_mfma_f32_32x32x16_bf16 v[64:79], v[56:59], v[40:43], v[64:79]
    v_mfma_f32_32x32x16_bf16 v[80:95], v[56:59], v[44:47], v[80:95]
    s_waitcnt vmcnt(3)
    s_barrier
    s_add_u32 m0, s38, 0
    s_nop 0
    buffer_load_dwordx4 v21, s[40:43], s28 offen lds
    s_add_u32 m0, s38, 4096
    s_nop 0
    buffer_load_dwordx4 v21, s[40:43], s29 offen lds
    s_add_u32 m0, s38, 8192
    s_nop 0
    buffer_load_dwordx4 v22, s[12:15], s32 offen lds
    s_add_u32 s28, s28, 64
    s_add_u32 s29, s29, 64
    s_add_u32 s32, s32, s36
    ds_read_b128 v[40:43], v17 offset:16384
    ds_read_b128 v[44:47], v17 offset:18432
    ds_read_b64_tr_b16 v[56:57], v20 offset:18432
    ds_read_b64_tr_b16 v[58:59], v20 offset:18944
    s_waitcnt lgkmcnt(4)
    v_mfma_f32_32x32x16_bf16 v[64:79], v[48:51], v[32:35], v[64:79]
    v_mfma_f32_32x32x16_bf16 v[80:95], v[48:51], v[36:39], v[80:95]
    ds_read_b128 v[32:35], v16 offset:32768
    ds_read_b128 v[36:39], v16 offset:34816
    ds_read_b64_tr_b16 v[48:49], v20 offset:32768
    ds_read_b64_tr_b16 v[50:51], v20 offset:33280
    s_waitcnt lgkmcnt(4)
    v_mfma_f32_32x32x16_bf16 v[64:79], v[56:59], v[40:43], v[64:79]
    v_mfma_f32_32x32x16_bf16 v[80:95], v[56:59], v[44:47], v[80:95]
    s_waitcnt vmcnt(3)
    s_barrier
    s_add_u32 m0, s38, 16384
    s_nop 0
    buffer_load_dwordx4 v21, s[40:43], s28 offen lds
    s_add_u32 m0, s38, 20480
    s_nop 0
    buffer_load_dwordx4 v21, s[40:43], s29 offen lds
    s_add_u32 m0, s38, 24576
    s_nop 0
    buffer_load_dwordx4 v22, s[12:15], s32 offen lds
    s_add_u32 s28, s28, 64
    s_add_u32 s29, s29, 64
    s_add_u32 s32, s32, s36
    ds_read_b128 v[40:43], v17 offset:32768
    ds_read_b128 v[44:47], v17 offset:34816
    ds_read_b64_tr_b16 v[56:57], v20 offset:34816
    ds_read_b64_tr_b16 v[58:59], v20 offset:35328
    s_waitcnt lgkmcnt(4)
    v_mfma_f32_32x32x16_bf16 v[64:79], v[48:51], v[32:35], v[64:79]
    v_mfma_f32_32x32x16_bf16 v[80:95], v[48:51], v[36:39], v[80:95]
    ds_read_b128 v[32:35], v16 offset:49152
    ds_read_b128 v[36:39], v16 offset:51200
    ds_read_b64_tr_b16 v[48:49], v20 offset:49152
    ds_read_b64_tr_b16 v[50:51], v20 offset:49664
    s_waitcnt lgkmcnt(4)
    v_mfma_f32_32x32x16_bf16 v[64:79], v[56:59], v[40:43], v[64:79]
    v_mfma_f32_32x32x16_bf16 v[80:95], v[56:59], v[44:47], v[80:95]
    s_waitcnt vmcnt(3)
    s_barrier
    s_add_u32 m0, s38, 32768
    s_nop 0
    buffer_load_dwordx4 v21, s[40:43], s28 offen lds
    s_add_u32 m0, s38, 36864
    s_nop 0
    buffer_load_dwordx4 v21, s[40:43], s29 offen lds
    s_add_u32 m0, s38, 40960
    s_nop 0
    buffer_load_dwordx4 v22, s[12:15], s32 offen lds
    s_add_u32 s28, s28, 64
    s_add_u32 s29, s29, 64
    s_add_u32 s32, s32, s36
    ds_read_b128 v[40:43], v17 offset:49152
    ds_read_b128 v[44:47], v17 offset:51200
    ds_read_b64_tr_b16 v[56:57], v20 offset:51200
    ds_read_b64_tr_b16 v[58:59], v20 offset:51712
    s_waitcnt lgkmcnt(4)
    v_mfma_f32_32x32x16_bf16 v[64:79], v[48:51], v[32:35], v[64:79]
    v_mfma_f32_32x32x16_bf16 v[80:95], v[48:51], v[36:39], v[80:95]
    ds_read_b128 v[32:35], v16 offset:0
    ds_read_b128 v[36:39], v16 offset:2048
    ds_read_b64_tr_b16 v[48:49], v20 offset:0
    ds_read_b64_tr_b16 v[50:51], v20 offset:512
    s_waitcnt lgkmcnt(4)
    v_mfma_f32_32x32x16_bf16 v[64:79], v[56:59], v[40:43], v[64:79]
    v_mfma_f32_32x32x16_bf16 v[80:95], v[56:59], v[44:47], v[80:95]
    s_waitcnt vmcnt(3)
    s_barrier
    s_add_u32 m0, s38, 49152
    s_nop 0
    buffer_load_dwordx4 v21, s[40:43], s28 offen lds
    s_add_u32 m0, s38, 53248
    s_nop 0
    buffer_load_dwordx4 v21, s[40:43], s29 offen lds
    s_add_u32 m0, s38, 57344
    s_nop 0
    buffer_load_dwordx4 v22, s[12:15], s32 offen lds
    s_add_u32 s28, s28, 64
    s_add_u32 s29, s29, 64
    s_add_u32 s32, s32, s36
    ds_read_b128 v[40:43], v17 offset:0
    ds_read_b128 v[44:47], v17 offset:2048
    ds_read_b64_tr_b16 v[56:57], v20 offset:2048
    ds_read_b64_tr_b16 v[58:59], v20 offset:2560
    s_waitcnt lgkmcnt(4)
    v_mfma_f32_32x32x16_bf16 v[64:79], v[48:51], v[32:35], v[64:79]
    v_mfma_f32_32x32x16_bf16 v[80:95], v[48:51], v[36:39], v[80:95]
    ds_read_b128 v[32:35], v16 offset:16384
    ds_read_b128 v[36:39], v16 offset:18432
    ds_read_b64_tr_b16 v[48:49], v20 offset:16384
    ds_read_b64_tr_b16 v[50:51], v20 offset:16896
    s_waitcnt lgkmcnt(4)
    v_mfma_f32_32x32x16_bf16 v[64:79], v[56:59], v[40:43], v[64:79]
    v_mfma_f32_32x32x16_bf16 v[80:95], v[56:59], v[44:47], v[80:95]
    s_waitcnt vmcnt(3)
    s_barrier
    s_add_u32 m0, s38, 0
    s_nop 0
    buffer_load_dwordx4 v21, s[40:43], s28 offen lds
    s_add_u32 m0, s38, 4096
    s_nop 0
    buffer_load_dwordx4 v21, s[40:43], s29 offen lds
    s_add_u32 m0, s38, 8192
    s_nop 0
    buffer_load_dwordx4 v22, s[12:15], s32 offen lds
    s_add_u32 s28, s28, 64
    s_add_u32 s29, s29, 64
    s_add_u32 s32, s32, s36
    ds_read_b128 v[40:43], v17 offset:16384
    ds_read_b128 v[44:47], v17 offset:18432
    ds_read_b64_tr_b16 v[56:57], v20 offset:18432
    ds_read_b64_tr_b16 v[58:59], v20 offset:18944
    s_waitcnt lgkmcnt(4)
    v_mfma_f32_32x32x16_bf16 v[64:79], v[48:51], v[32:35], v[64:79]
    v_mfma_f32_32x32x16_bf16 v[80:95], v[48:51], v[36:39], v[80:95]
    ds_read_b128 v[32:35], v16 offset:32768
    ds_read_b128 v[36:39], v16 offset:34816
    ds_read_b64_tr_b16 v[48:49], v20 offset:32768
    ds_read_b64_tr_b16 v[50:51], v20 offset:33280
    s_waitcnt lgkmcnt(4)
    v_mfma_f32_32x32x16_bf16 v[64:79], v[56:59], v[40:43], v[64:79]
    v_mfma_f32_32x32x16_bf16 v[80:95], v[56:59], v[44:47], v[80:95]
    s_waitcnt vmcnt(3)
    s_barrier
    s_add_u32 m0, s38, 16384
    s_nop 0
    buffer_load_dwordx4 v21, s[40:43], s28 offen lds
    s_add_u32 m0, s38, 20480
    s_nop 0
    buffer_load_dwordx4 v21, s[40:43], s29 offen lds
    s_add_u32 m0, s38, 24576
    s_nop 0
    buffer_load_dwordx4 v22, s[12:15], s32 offen lds
    s_add_u32 s28, s28, 64
    s_add_u32 s29, s29, 64
    s_add_u32 s32, s32, s36
    ds_read_b128 v[40:43], v17 offset:32768
    ds_read_b128 v[44:47], v17 offset:34816
    ds_read_b64_tr_b16 v[56:57], v20 offset:34816
    ds_read_b64_tr_b16 v[58:59], v20 offset:35328
    s_waitcnt lgkmcnt(4)
    v_mfma_f32_32x32x16_bf16 v[64:79], v[48:51], v[32:35], v[64:79]
    v_mfma_f32_32x32x16_bf16 v[80:95], v[48:51], v[36:39], v[80:95]
    ds_read_b128 v[32:35], v16 offset:49152
    ds_read_b128 v[36:39], v16 offset:51200
    ds_read_b64_tr_b16 v[48:49], v20 offset:49152
    ds_read_b64_tr_b16 v[50:51], v20 offset:49664
    s_waitcnt lgkmcnt(4)
    v_mfma_f32_32x32x16_bf16 v[64:79], v[56:59], v[40:43], v[64:79]
    v_mfma_f32_32x32x16_bf16 v[80:95], v[56:59], v[44:47], v[80:95]
    s_waitcnt vmcnt(3)
    s_barrier
    ds_read_b128 v[40:43], v17 offset:49152
    ds_read_b128 v[44:47], v17 offset:51200
    ds_read_b64_tr_b16 v[56:57], v20 offset:51200
    ds_read_b64_tr_b16 v[58:59], v20 offset:51712
    s_waitcnt lgkmcnt(4)
    v_mfma_f32_32x32x16_bf16 v[64:79], v[48:51], v[32:35], v[64:79]
    v_mfma_f32_32x32x16_bf16 v[80:95], v[48:51], v[36:39], v[80:95]
    ds_read_b128 v[32:35], v16 offset:0
    ds_read_b128 v[36:39], v16 offset:2048
    ds_read_b64_tr_b16 v[48:49], v20 offset:0
    ds_read_b64_tr_b16 v[50:51], v20 offset:512
    s_waitcnt lgkmcnt(4)
    v_mfma_f32_32x32x16_bf16 v[64:79], v[56:59], v[40:43], v[64:79]
    v_mfma_f32_32x32x16_bf16 v[80:95], v[56:59], v[44:47], v[80:95]
    s_waitcnt vmcnt(0)
    s_barrier
    ds_read_b128 v[40:43], v17 offset:0
    ds_read_b128 v[44:47], v17 offset:2048
    ds_read_b64_tr_b16 v[56:57], v20 offset:2048
    ds_read_b64_tr_b16 v[58:59], v20 offset:2560
    s_waitcnt lgkmcnt(4)
    v_mfma_f32_32x32x16_bf16 v[64:79], v[48:51], v[32:35], v[64:79]
    v_mfma_f32_32x32x16_bf16 v[80:95], v[48:51], v[36:39], v[80:95]
    ds_read_b128 v[32:35], v16 offset:16384
    ds_read_b128 v[36:39], v16 offset:18432
    ds_read_b64_tr_b16 v[48:49], v20 offset:16384
    ds_read_b64_tr_b16 v[50:51], v20 offset:16896
    s_waitcnt lgkmcnt(4)
    v_mfma_f32_32x32x16_bf16 v[64:79], v[56:59], v[40:43], v[64:79]
    v_mfma_f32_32x32x16_bf16 v[80:95], v[56:59], v[44:47], v[80:95]
    ds_read_b128 v[40:43], v17 offset:16384
    ds_read_b128 v[44:47], v17 offset:18432
    ds_read_b64_tr_b16 v[56:57], v20 offset:18432
    ds_read_b64_tr_b16 v[58:59], v20 offset:18944
    s_waitcnt lgkmcnt(4)
    v_mfma_f32_32x32x16_bf16 v[64:79], v[48:51], v[32:35], v[64:79]
    v_mfma_f32_32x32x16_bf16 v[80:95], v[48:51], v[36:39], v[80:95]
    s_waitcnt lgkmcnt(0)
    v_mfma_f32_32x32x16_bf16 v[64:79], v[56:59], v[40:43], v[64:79]
    v_mfma_f32_32x32x16_bf16 v[80:95], v[56:59], v[44:47], v[80:95]
    s_nop 15
    s_nop 3
    v_cvt_pk_bf16_f32 v12, v64, v65
    v_cvt_pk_bf16_f32 v13, v66, v67
    buffer_store_dwordx2 v[12:13], v25, s[8:11], s48 offen offset:0
    v_cvt_pk_bf16_f32 v14, v68, v69
    v_cvt_pk_bf16_f32 v15, v70, v71
    buffer_store_dwordx2 v[14:15], v25, s[8:11], s48 offen offset:16
    v_cvt_pk_bf16_f32 v12, v72, v73
    v_cvt_pk_bf16_f32 v13, v74, v75
    buffer_store_dwordx2 v[12:13], v25, s[8:11], s48 offen offset:32
    v_cvt_pk_bf16_f32 v14, v76, v77
    v_cvt_pk_bf16_f32 v15, v78, v79
    buffer_store_dwordx2 v[14:15], v25, s[8:11], s48 offen offset:48
    v_cvt_pk_bf16_f32 v12, v80, v81
    v_cvt_pk_bf16_f32 v13, v82, v83
    buffer_store_dwordx2 v[12:13], v26, s[8:11], s48 offen offset:0
    v_cvt_pk_bf16_f32 v14, v84, v85
    v_cvt_pk_bf16_f32 v15, v86, v87
    buffer_store_dwordx2 v[14:15], v26, s[8:11], s48 offen offset:16
    v_cvt_pk_bf16_f32 v12, v88, v89
    v_cvt_pk_bf16_f32 v13, v90, v91
    buffer_store_dwordx2 v[12:13], v26, s[8:11], s48 offen offset:32
    v_cvt_pk_bf16_f32 v14, v92, v93
    v_cvt_pk_bf16_f32 v15, v94, v95
    buffer_store_dwordx2 v[14:15], v26, s[8:11], s48 offen offset:48
dp_end:
    s_endpgm
.globl gemm2_kernel
.p2align 8
.type gemm2_kernel,@function
gemm2_kernel:
    s_cmp_ge_u32 s2, 160
    s_cbranch_scc1 g2_end
    s_load_dwordx2 s[4:5], s[0:1], 16
    s_load_dwordx2 s[6:7], s[0:1], 72
    s_load_dwordx2 s[26:27], s[0:1], 0
    s_load_dwordx2 s[50:51], s[0:1], 56
    v_and_b32 v23, 63, v0
    v_lshrrev_b32 v1, 6, v0
    s_nop 0
    v_readfirstlane_b32 s20, v1
    s_lshr_b32 s21, s20, 1
    s_and_b32 s22, s20, 1
    s_lshl_b32 s38, s20, 10
    v_and_b32 v1, 31, v23
    s_lshl_b32 s3, s21, 6
    v_add_u32 v1, s3, v1
    v_lshlrev_b32 v1, 6, v1
    v_lshrrev_b32 v2, 5, v23
    v_bfe_u32 v3, v23, 2, 2
    v_add_u32 v4, 0, v2
    v_xor_b32 v4, v4, v3
    v_lshl_add_u32 v16, v4, 4, v1
    v_add_u32 v4, 2, v2
    v_xor_b32 v4, v4, v3
    v_lshl_add_u32 v17, v4, 4, v1
    v_lshrrev_b32 v1, 5, v23
    v_lshlrev_b32 v1, 3, v1
    v_bfe_u32 v2, v23, 2, 2
    v_add_u32 v1, v1, v2
    v_lshlrev_b32 v1, 7, v1
    v_bfe_u32 v2, v23, 4, 1
    v_lshlrev_b32 v2, 1, v2
    v_bfe_u32 v3, v23, 1, 1
    v_add_u32 v2, v2, v3
    s_lshl_b32 s3, s22, 2
    v_add_u32 v2, s3, v2
    v_bfe_u32 v3, v23, 3, 1
    v_lshlrev_b32 v3, 2, v3
    v_xor_b32 v2, v2, v3
    v_lshl_add_u32 v1, v2, 4, v1
    v_and_b32 v2, 1, v23
    v_lshl_add_u32 v1, v2, 3, v1
    v_add_u32 v20, 8192, v1
    s_waitcnt lgkmcnt(0)
    s_mov_b32 s8, s6
    s_and_b32 s9, s7, 0xffff
    s_mov_b32 s10, 268435456
    s_mov_b32 s11, 0x00020000
    s_mov_b32 s40, s6
    s_and_b32 s41, s7, 0xffff
    s_mov_b32 s42, 268435456
    s_mov_b32 s43, 0x00020000
    s_mov_b32 s12, s4
    s_and_b32 s13, s5, 0xffff
    s_mov_b32 s14, 819200
    s_mov_b32 s15, 0x00020000
    s_mov_b32 s52, s26
    s_and_b32 s53, s27, 0xffff
    s_mov_b32 s54, 2621440
    s_mov_b32 s55, 0x00020000
    s_mov_b32 s56, s50
    s_and_b32 s57, s51, 0xffff
    s_mov_b32 s58, 2621440
    s_mov_b32 s59, 0x00020000
    s_lshr_b32 s3, s2, 3
    s_and_b32 s5, s2, 7
    s_lshl_b32 s5, s5, 1
    s_cmp_ge_u32 s3, 10
    s_cselect_b32 s4, 1, 0
    s_add_u32 s5, s5, s4
    s_mul_i32 s4, s4, 10
    s_sub_u32 s4, s3, s4
    s_lshl_b32 s23, s5, 7
    s_movk_i32 s44, 1280
    v_lshrrev_b32 v1, 2, v23
    s_mov_b32 s3, 1280
    v_mul_lo_u32 v1, v1, s3
    v_bfe_u32 v2, v23, 4, 2
    v_and_b32 v3, 3, v23
    v_xor_b32 v2, v2, v3
    v_lshl_add_u32 v21, v2, 4, v1
    v_lshrrev_b32 v1, 3, v23
    v_mul_lo_u32 v1, v1, s44
    v_bfe_u32 v2, v23, 4, 1
    v_lshlrev_b32 v2, 2, v2
    v_and_b32 v3, 7, v23
    v_xor_b32 v2, v2, v3
    v_lshl_add_u32 v22, v2, 4, v1
    v_and_b32 v2, 31, v23
    s_lshl_b32 s6, s21, 6
    s_add_u32 s6, s6, s23
    v_add_u32 v2, s6, v2
    s_movk_i32 s7, 1280
    v_mul_lo_u32 v2, v2, s7
    v_lshrrev_b32 v1, 5, v23
    v_lshlrev_b32 v1, 3, v1
    v_add_u32 v25, v2, v1
    v_add_u32 v26, 40960, v25
    s_lshl_b32 s3, s4, 7
    s_lshl_b32 s6, s22, 6
    s_add_u32 s49, s3, s6
    s_add_u32 s48, s49, 27262976
    s_lshl_b32 s6, s4, 7
    s_lshl_b32 s3, s20, 4
    s_add_u32 s3, s3, 0
    s_add_u32 s3, s3, s23
    s_mul_i32 s3, s3, 1280
    s_add_u32 s28, s3, 24117248
    s_lshl_b32 s3, s20, 4
    s_add_u32 s3, s3, 64
    s_add_u32 s3, s3, s23
    s_mul_i32 s3, s3, 1280
    s_add_u32 s29, s3, 24117248
    s_lshl_b32 s3, s20, 3
    s_mul_i32 s3, s3, s44
    s_add_u32 s32, s3, s6
    s_lshl_b32 s36, s44, 5
    v_mov_b32 v64, 0
    v_mov_b32 v65, 0
    v_mov_b32 v66, 0
    v_mov_b32 v67, 0
    v_mov_b32 v68, 0
    v_mov_b32 v69, 0
    v_mov_b32 v70, 0
    v_mov_b32 v71, 0
    v_mov_b32 v72, 0
    v_mov_b32 v73, 0
    v_mov_b32 v74, 0
    v_mov_b32 v75, 0
    v_mov_b32 v76, 0
    v_mov_b32 v77, 0
    v_mov_b32 v78, 0
    v_mov_b32 v79, 0
    v_mov_b32 v80, 0
    v_mov_b32 v81, 0
    v_mov_b32 v82, 0
    v_mov_b32 v83, 0
    v_mov_b32 v84, 0
    v_mov_b32 v85, 0
    v_mov_b32 v86, 0
    v_mov_b32 v87, 0
    v_mov_b32 v88, 0
    v_mov_b32 v89, 0
    v_mov_b32 v90, 0
    v_mov_b32 v91, 0
    v_mov_b32 v92, 0
    v_mov_b32 v93, 0
    v_mov_b32 v94, 0
    v_mov_b32 v95, 0
    s_add_u32 m0, s38, 0
    s_nop 0
    buffer_load_dwordx4 v21, s[40:43], s28 offen lds
    s_add_u32 m0, s38, 4096
    s_nop 0
    buffer_load_dwordx4 v21, s[40:43], s29 offen lds
    s_add_u32 m0, s38, 8192
    s_nop 0
    buffer_load_dwordx4 v22, s[12:15], s32 offen lds
    s_add_u32 s28, s28, 64
    s_add_u32 s29, s29, 64
    s_add_u32 s32, s32, s36
    s_add_u32 m0, s38, 16384
    s_nop 0
    buffer_load_dwordx4 v21, s[40:43], s28 offen lds
    s_add_u32 m0, s38, 20480
    s_nop 0
    buffer_load_dwordx4 v21, s[40:43], s29 offen lds
    s_add_u32 m0, s38, 24576
    s_nop 0
    buffer_load_dwordx4 v22, s[12:15], s32 offen lds
    s_add_u32 s28, s28, 64
    s_add_u32 s29, s29, 64
    s_add_u32 s32, s32, s36
    s_add_u32 m0, s38, 32768
    s_nop 0
    buffer_load_dwordx4 v21, s[40:43], s28 offen lds
    s_add_u32 m0, s38, 36864
    s_nop 0
    buffer_load_dwordx4 v21, s[40:43], s29 offen lds
    s_add_u32 m0, s38, 40960
    s_nop 0
    buffer_load_dwordx4 v22, s[12:15], s32 offen lds
    s_add_u32 s28, s28, 64
    s_add_u32 s29, s29, 64
    s_add_u32 s32, s32, s36
    s_waitcnt vmcnt(6)
    s_barrier
    ds_read_b128 v[32:35], v16 offset:0
    ds_read_b128 v[36:39], v16 offset:2048
    ds_read_b64_tr_b16 v[48:49], v20 offset:0
    ds_read_b64_tr_b16 v[50:51], v20 offset:512
    s_waitcnt vmcnt(3)
    s_barrier
    s_add_u32 m0, s38, 49152
    s_nop 0
    buffer_load_dwordx4 v21, s[40:43], s28 offen lds
    s_add_u32 m0, s38, 53248
    s_nop 0
    buffer_load_dwordx4 v21, s[40:43], s29 offen lds
    s_add_u32 m0, s38, 57344
    s_nop 0
    buffer_load_dwordx4 v22, s[12:15], s32 offen lds
    s_add_u32 s28, s28, 64
    s_add_u32 s29, s29, 64
    s_add_u32 s32, s32, s36
    ds_read_b128 v[40:43], v17 offset:0
    ds_read_b128 v[44:47], v17 offset:2048
    ds_read_b64_tr_b16 v[56:57], v20 offset:2048
    ds_read_b64_tr_b16 v[58:59], v20 offset:2560
    s_waitcnt lgkmcnt(4)
    v_mfma_f32_32x32x16_bf16 v[64:79], v[48:51], v[32:35], v[64:79]
    v_mfma_f32_32x32x16_bf16 v[80:95], v[48:51], v[36:39], v[80:95]
    ds_read_b128 v[32:35], v16 offset:16384
    ds_read_b128 v[36:39], v16 offset:18432
    ds_read_b64_tr_b16 v[48:49], v20 offset:16384
    ds_read_b64_tr_b16 v[50:51], v20 offset:16896
    s_waitcnt lgkmcnt(4)
    v_mfma_f32_32x32x16_bf16 v[64:79], v[56:59], v[40:43], v[64:79]
    v_mfma_f32_32x32x16_bf16 v[80:95], v[56:59], v[44:47], v[80:95]
    s_waitcnt vmcnt(3)
    s_barrier
    s_add_u32 m0, s38, 0
    s_nop 0
    buffer_load_dwordx4 v21, s[40:43], s28 offen lds
    s_add_u32 m0, s38, 4096
    s_nop 0
    buffer_load_dwordx4 v21, s[40:43], s29 offen lds
    s_add_u32 m0, s38, 8192
    s_nop 0
    buffer_load_dwordx4 v22, s[12:15], s32 offen lds
    s_add_u32 s28, s28, 64
    s_add_u32 s29, s29, 64
    s_add_u32 s32, s32, s36
    ds_read_b128 v[40:43], v17 offset:16384
    ds_read_b128 v[44:47], v17 offset:18432
    ds_read_b64_tr_b16 v[56:57], v20 offset:18432
    ds_read_b64_tr_b16 v[58:59], v20 offset:18944
    s_waitcnt lgkmcnt(4)
    v_mfma_f32_32x32x16_bf16 v[64:79], v[48:51], v[32:35], v[64:79]
    v_mfma_f32_32x32x16_bf16 v[80:95], v[48:51], v[36:39], v[80:95]
    ds_read_b128 v[32:35], v16 offset:32768
    ds_read_b128 v[36:39], v16 offset:34816
    ds_read_b64_tr_b16 v[48:49], v20 offset:32768
    ds_read_b64_tr_b16 v[50:51], v20 offset:33280
    s_waitcnt lgkmcnt(4)
    v_mfma_f32_32x32x16_bf16 v[64:79], v[56:59], v[40:43], v[64:79]
    v_mfma_f32_32x32x16_bf16 v[80:95], v[56:59], v[44:47], v[80:95]
    s_waitcnt vmcnt(3)
    s_barrier
    s_add_u32 m0, s38, 16384
    s_nop 0
    buffer_load_dwordx4 v21, s[40:43], s28 offen lds
    s_add_u32 m0, s38, 20480
    s_nop 0
    buffer_load_dwordx4 v21, s[40:43], s29 offen lds
    s_add_u32 m0, s38, 24576
    s_nop 0
    buffer_load_dwordx4 v22, s[12:15], s32 offen lds
    s_add_u32 s28, s28, 64
    s_add_u32 s29, s29, 64
    s_add_u32 s32, s32, s36
    ds_read_b128 v[40:43], v17 offset:32768
    ds_read_b128 v[44:47], v17 offset:34816
    ds_read_b64_tr_b16 v[56:57], v20 offset:34816
    ds_read_b64_tr_b16 v[58:59], v20 offset:35328
    s_waitcnt lgkmcnt(4)
    v_mfma_f32_32x32x16_bf16 v[64:79], v[48:51], v[32:35], v[64:79]
    v_mfma_f32_32x32x16_bf16 v[80:95], v[48:51], v[36:39], v[80:95]
    ds_read_b128 v[32:35], v16 offset:49152
    ds_read_b128 v[36:39], v16 offset:51200
    ds_read_b64_tr_b16 v[48:49], v20 offset:49152
    ds_read_b64_tr_b16 v[50:51], v20 offset:49664
    s_waitcnt lgkmcnt(4)
    v_mfma_f32_32x32x16_bf16 v[64:79], v[56:59], v[40:43], v[64:79]
    v_mfma_f32_32x32x16_bf16 v[80:95], v[56:59], v[44:47], v[80:95]
    s_waitcnt vmcnt(3)
    s_barrier
    s_add_u32 m0, s38, 32768
    s_nop 0
    buffer_load_dwordx4 v21, s[40:43], s28 offen lds
    s_add_u32 m0, s38, 36864
    s_nop 0
    buffer_load_dwordx4 v21, s[40:43], s29 offen lds
    s_add_u32 m0, s38, 40960
    s_nop 0
    buffer_load_dwordx4 v22, s[12:15], s32 offen lds
    s_add_u32 s28, s28, 64
    s_add_u32 s29, s29, 64
    s_add_u32 s32, s32, s36
    ds_read_b128 v[40:43], v17 offset:49152
    ds_read_b128 v[44:47], v17 offset:51200
    ds_read_b64_tr_b16 v[56:57], v20 offset:51200
    ds_read_b64_tr_b16 v[58:59], v20 offset:51712
    s_waitcnt lgkmcnt(4)
    v_mfma_f32_32x32x16_bf16 v[64:79], v[48:51], v[32:35], v[64:79]
    v_mfma_f32_32x32x16_bf16 v[80:95], v[48:51], v[36:39], v[80:95]
    ds_read_b128 v[32:35], v16 offset:0
    ds_read_b128 v[36:39], v16 offset:2048
    ds_read_b64_tr_b16 v[48:49], v20 offset:0
    ds_read_b64_tr_b16 v[50:51], v20 offset:512
    s_waitcnt lgkmcnt(4)
    v_mfma_f32_32x32x16_bf16 v[64:79], v[56:59], v[40:43], v[64:79]
    v_mfma_f32_32x32x16_bf16 v[80:95], v[56:59], v[44:47], v[80:95]
    s_waitcnt vmcnt(3)
    s_barrier
    s_add_u32 m0, s38, 49152
    s_nop 0
    buffer_load_dwordx4 v21, s[40:43], s28 offen lds
    s_add_u32 m0, s38, 53248
    s_nop 0
    buffer_load_dwordx4 v21, s[40:43], s29 offen lds
    s_add_u32 m0, s38, 57344
    s_nop 0
    buffer_load_dwordx4 v22, s[12:15], s32 offen lds
    s_add_u32 s28, s28, 64
    s_add_u32 s29, s29, 64
    s_add_u32 s32, s32, s36
    ds_read_b128 v[40:43], v17 offset:0
    ds_read_b128 v[44:47], v17 offset:2048
    ds_read_b64_tr_b16 v[56:57], v20 offset:2048
    ds_read_b64_tr_b16 v[58:59], v20 offset:2560
    s_waitcnt lgkmcnt(4)
    v_mfma_f32_32x32x16_bf16 v[64:79], v[48:51], v[32:35], v[64:79]
    v_mfma_f32_32x32x16_bf16 v[80:95], v[48:51], v[36:39], v[80:95]
    ds_read_b128 v[32:35], v16 offset:16384
    ds_read_b128 v[36:39], v16 offset:18432
    ds_read_b64_tr_b16 v[48:49], v20 offset:16384
    ds_read_b64_tr_b16 v[50:51], v20 offset:16896
    s_waitcnt lgkmcnt(4)
    v_mfma_f32_32x32x16_bf16 v[64:79], v[56:59], v[40:43], v[64:79]
    v_mfma_f32_32x32x16_bf16 v[80:95], v[56:59], v[44:47], v[80:95]
    s_waitcnt vmcnt(3)
    s_barrier
    s_add_u32 m0, s38, 0
    s_nop 0
    buffer_load_dwordx4 v21, s[40:43], s28 offen lds
    s_add_u32 m0, s38, 4096
    s_nop 0
    buffer_load_dwordx4 v21, s[40:43], s29 offen lds
    s_add_u32 m0, s38, 8192
    s_nop 0
    buffer_load_dwordx4 v22, s[12:15], s32 offen lds
    s_add_u32 s28, s28, 64
    s_add_u32 s29, s29, 64
    s_add_u32 s32, s32, s36
    ds_read_b128 v[40:43], v17 offset:16384
    ds_read_b128 v[44:47], v17 offset:18432
    ds_read_b64_tr_b16 v[56:57], v20 offset:18432
    ds_read_b64_tr_b16 v[58:59], v20 offset:18944
    s_waitcnt lgkmcnt(4)
    v_mfma_f32_32x32x16_bf16 v[64:79], v[48:51], v[32:35], v[64:79]
    v_mfma_f32_32x32x16_bf16 v[80:95], v[48:51], v[36:39], v[80:95]
    ds_read_b128 v[32:35], v16 offset:32768
    ds_read_b128 v[36:39], v16 offset:34816
    ds_read_b64_tr_b16 v[48:49], v20 offset:32768
    ds_read_b64_tr_b16 v[50:51], v20 offset:33280
    s_waitcnt lgkmcnt(4)
    v_mfma_f32_32x32x16_bf16 v[64:79], v[56:59], v[40:43], v[64:79]
    v_mfma_f32_32x32x16_bf16 v[80:95], v[56:59], v[44:47], v[80:95]
    s_waitcnt vmcnt(3)
    s_barrier
    s_add_u32 m0, s38, 16384
    s_nop 0
    buffer_load_dwordx4 v21, s[40:43], s28 offen lds
    s_add_u32 m0, s38, 20480
    s_nop 0
    buffer_load_dwordx4 v21, s[40:43], s29 offen lds
    s_add_u32 m0, s38, 24576
    s_nop 0
    buffer_load_dwordx4 v22, s[12:15], s32 offen lds
    s_add_u32 s28, s28, 64
    s_add_u32 s29, s29, 64
    s_add_u32 s32, s32, s36
    ds_read_b128 v[40:43], v17 offset:32768
    ds_read_b128 v[44:47], v17 offset:34816
    ds_read_b64_tr_b16 v[56:57], v20 offset:34816
    ds_read_b64_tr_b16 v[58:59], v20 offset:35328
    s_waitcnt lgkmcnt(4)
    v_mfma_f32_32x32x16_bf16 v[64:79], v[48:51], v[32:35], v[64:79]
    v_mfma_f32_32x32x16_bf16 v[80:95], v[48:51], v[36:39], v[80:95]
    ds_read_b128 v[32:35], v16 offset:49152
    ds_read_b128 v[36:39], v16 offset:51200
    ds_read_b64_tr_b16 v[48:49], v20 offset:49152
    ds_read_b64_tr_b16 v[50:51], v20 offset:49664
    s_waitcnt lgkmcnt(4)
    v_mfma_f32_32x32x16_bf16 v[64:79], v[56:59], v[40:43], v[64:79]
    v_mfma_f32_32x32x16_bf16 v[80:95], v[56:59], v[44:47], v[80:95]
    s_waitcnt vmcnt(3)
    s_barrier
    s_add_u32 m0, s38, 32768
    s_nop 0
    buffer_load_dwordx4 v21, s[40:43], s28 offen lds
    s_add_u32 m0, s38, 36864
    s_nop 0
    buffer_load_dwordx4 v21, s[40:43], s29 offen lds
    s_add_u32 m0, s38, 40960
    s_nop 0
    buffer_load_dwordx4 v22, s[12:15], s32 offen lds
    s_add_u32 s28, s28, 64
    s_add_u32 s29, s29, 64
    s_add_u32 s32, s32, s36
    ds_read_b128 v[40:43], v17 offset:49152
    ds_read_b128 v[44:47], v17 offset:51200
    ds_read_b64_tr_b16 v[56:57], v20 offset:51200
    ds_read_b64_tr_b16 v[58:59], v20 offset:51712
    s_waitcnt lgkmcnt(4)
    v_mfma_f32_32x32x16_bf16 v[64:79], v[48:51], v[32:35], v[64:79]
    v_mfma_f32_32x32x16_bf16 v[80:95], v[48:51], v[36:39], v[80:95]
    ds_read_b128 v[32:35], v16 offset:0
    ds_read_b128 v[36:39], v16 offset:2048
    ds_read_b64_tr_b16 v[48:49], v20 offset:0
    ds_read_b64_tr_b16 v[50:51], v20 offset:512
    s_waitcnt lgkmcnt(4)
    v_mfma_f32_32x32x16_bf16 v[64:79], v[56:59], v[40:43], v[64:79]
    v_mfma_f32_32x32x16_bf16 v[80:95], v[56:59], v[44:47], v[80:95]
    s_waitcnt vmcnt(3)
    s_barrier
    s_add_u32 m0, s38, 49152
    s_nop 0
    buffer_load_dwordx4 v21, s[40:43], s28 offen lds
    s_add_u32 m0, s38, 53248
    s_nop 0
    buffer_load_dwordx4 v21, s[40:43], s29 offen lds
    s_add_u32 m0, s38, 57344
    s_nop 0
    buffer_load_dwordx4 v22, s[12:15], s32 offen lds
    s_add_u32 s28, s28, 64
    s_add_u32 s29, s29, 64
    s_add_u32 s32, s32, s36
    ds_read_b128 v[40:43], v17 offset:0
    ds_read_b128 v[44:47], v17 offset:2048
    ds_read_b64_tr_b16 v[56:57], v20 offset:2048
    ds_read_b64_tr_b16 v[58:59], v20 offset:2560
    s_waitcnt lgkmcnt(4)
    v_mfma_f32_32x32x16_bf16 v[64:79], v[48:51], v[32:35], v[64:79]
    v_mfma_f32_32x32x16_bf16 v[80:95], v[48:51], v[36:39], v[80:95]
    ds_read_b128 v[32:35], v16 offset:16384
    ds_read_b128 v[36:39], v16 offset:18432
    ds_read_b64_tr_b16 v[48:49], v20 offset:16384
    ds_read_b64_tr_b16 v[50:51], v20 offset:16896
    s_waitcnt lgkmcnt(4)
    v_mfma_f32_32x32x16_bf16 v[64:79], v[56:59], v[40:43], v[64:79]
    v_mfma_f32_32x32x16_bf16 v[80:95], v[56:59], v[44:47], v[80:95]
    s_waitcnt vmcnt(3)
    s_barrier
    s_add_u32 m0, s38, 0
    s_nop 0
    buffer_load_dwordx4 v21, s[40:43], s28 offen lds
    s_add_u32 m0, s38, 4096
    s_nop 0
    buffer_load_dwordx4 v21, s[40:43], s29 offen lds
    s_add_u32 m0, s38, 8192
    s_nop 0
    buffer_load_dwordx4 v22, s[12:15], s32 offen lds
    s_add_u32 s28, s28, 64
    s_add_u32 s29, s29, 64
    s_add_u32 s32, s32, s36
    ds_read_b128 v[40:43], v17 offset:16384
    ds_read_b128 v[44:47], v17 offset:18432
    ds_read_b64_tr_b16 v[56:57], v20 offset:18432
    ds_read_b64_tr_b16 v[58:59], v20 offset:18944
    s_waitcnt lgkmcnt(4)
    v_mfma_f32_32x32x16_bf16 v[64:79], v[48:51], v[32:35], v[64:79]
    v_mfma_f32_32x32x16_bf16 v[80:95], v[48:51], v[36:39], v[80:95]
    ds_read_b128 v[32:35], v16 offset:32768
    ds_read_b128 v[36:39], v16 offset:34816
    ds_read_b64_tr_b16 v[48:49], v20 offset:32768
    ds_read_b64_tr_b16 v[50:51], v20 offset:33280
    s_waitcnt lgkmcnt(4)
    v_mfma_f32_32x32x16_bf16 v[64:79], v[56:59], v[40:43], v[64:79]
    v_mfma_f32_32x32x16_bf16 v[80:95], v[56:59], v[44:47], v[80:95]
    s_waitcnt vmcnt(3)
    s_barrier
    s_add_u32 m0, s38, 16384
    s_nop 0
    buffer_load_dwordx4 v21, s[40:43], s28 offen lds
    s_add_u32 m0, s38, 20480
    s_nop 0
    buffer_load_dwordx4 v21, s[40:43], s29 offen lds
    s_add_u32 m0, s38, 24576
    s_nop 0
    buffer_load_dwordx4 v22, s[12:15], s32 offen lds
    s_add_u32 s28, s28, 64
    s_add_u32 s29, s29, 64
    s_add_u32 s32, s32, s36
    ds_read_b128 v[40:43], v17 offset:32768
    ds_read_b128 v[44:47], v17 offset:34816
    ds_read_b64_tr_b16 v[56:57], v20 offset:34816
    ds_read_b64_tr_b16 v[58:59], v20 offset:35328
    s_waitcnt lgkmcnt(4)
    v_mfma_f32_32x32x16_bf16 v[64:79], v[48:51], v[32:35], v[64:79]
    v_mfma_f32_32x32x16_bf16 v[80:95], v[48:51], v[36:39], v[80:95]
    ds_read_b128 v[32:35], v16 offset:49152
    ds_read_b128 v[36:39], v16 offset:51200
    ds_read_b64_tr_b16 v[48:49], v20 offset:49152
    ds_read_b64_tr_b16 v[50:51], v20 offset:49664
    s_waitcnt lgkmcnt(4)
    v_mfma_f32_32x32x16_bf16 v[64:79], v[56:59], v[40:43], v[64:79]
    v_mfma_f32_32x32x16_bf16 v[80:95], v[56:59], v[44:47], v[80:95]
    s_waitcnt vmcnt(3)
    s_barrier
    s_add_u32 m0, s38, 32768
    s_nop 0
    buffer_load_dwordx4 v21, s[40:43], s28 offen lds
    s_add_u32 m0, s38, 36864
    s_nop 0
    buffer_load_dwordx4 v21, s[40:43], s29 offen lds
    s_add_u32 m0, s38, 40960
    s_nop 0
    buffer_load_dwordx4 v22, s[12:15], s32 offen lds
    s_add_u32 s28, s28, 64
    s_add_u32 s29, s29, 64
    s_add_u32 s32, s32, s36
    ds_read_b128 v[40:43], v17 offset:49152
    ds_read_b128 v[44:47], v17 offset:51200
    ds_read_b64_tr_b16 v[56:57], v20 offset:51200
    ds_read_b64_tr_b16 v[58:59], v20 offset:51712
    s_waitcnt lgkmcnt(4)
    v_mfma_f32_32x32x16_bf16 v[64:79], v[48:51], v[32:35], v[64:79]
    v_mfma_f32_32x32x16_bf16 v[80:95], v[48:51], v[36:39], v[80:95]
    ds_read_b128 v[32:35], v16 offset:0
    ds_read_b128 v[36:39], v16 offset:2048
    ds_read_b64_tr_b16 v[48:49], v20 offset:0
    ds_read_b64_tr_b16 v[50:51], v20 offset:512
    s_waitcnt lgkmcnt(4)
    v_mfma_f32_32x32x16_bf16 v[64:79], v[56:59], v[40:43], v[64:79]
    v_mfma_f32_32x32x16_bf16 v[80:95], v[56:59], v[44:47], v[80:95]
    s_waitcnt vmcnt(3)
    s_barrier
    s_add_u32 m0, s38, 49152
    s_nop 0
    buffer_load_dwordx4 v21, s[40:43], s28 offen lds
    s_add_u32 m0, s38, 53248
    s_nop 0
    buffer_load_dwordx4 v21, s[40:43], s29 offen lds
    s_add_u32 m0, s38, 57344
    s_nop 0
    buffer_load_dwordx4 v22, s[12:15], s32 offen lds
    s_add_u32 s28, s28, 64
    s_add_u32 s29, s29, 64
    s_add_u32 s32, s32, s36
    ds_read_b128 v[40:43], v17 offset:0
    ds_read_b128 v[44:47], v17 offset:2048
    ds_read_b64_tr_b16 v[56:57], v20 offset:2048
    ds_read_b64_tr_b16 v[58:59], v20 offset:2560
    s_waitcnt lgkmcnt(4)
    v_mfma_f32_32x32x16_bf16 v[64:79], v[48:51], v[32:35], v[64:79]
    v_mfma_f32_32x32x16_bf16 v[80:95], v[48:51], v[36:39], v[80:95]
    ds_read_b128 v[32:35], v16 offset:16384
    ds_read_b128 v[36:39], v16 offset:18432
    ds_read_b64_tr_b16 v[48:49], v20 offset:16384
    ds_read_b64_tr_b16 v[50:51], v20 offset:16896
    s_waitcnt lgkmcnt(4)
    v_mfma_f32_32x32x16_bf16 v[64:79], v[56:59], v[40:43], v[64:79]
    v_mfma_f32_32x32x16_bf16 v[80:95], v[56:59], v[44:47], v[80:95]
    s_waitcnt vmcnt(3)
    s_barrier
    s_add_u32 m0, s38, 0
    s_nop 0
    buffer_load_dwordx4 v21, s[40:43], s28 offen lds
    s_add_u32 m0, s38, 4096
    s_nop 0
    buffer_load_dwordx4 v21, s[40:43], s29 offen lds
    s_add_u32 m0, s38, 8192
    s_nop 0
    buffer_load_dwordx4 v22, s[12:15], s32 offen lds
    s_add_u32 s28, s28, 64
    s_add_u32 s29, s29, 64
    s_add_u32 s32, s32, s36
    ds_read_b128 v[40:43], v17 offset:16384
    ds_read_b128 v[44:47], v17 offset:18432
    ds_read_b64_tr_b16 v[56:57], v20 offset:18432
    ds_read_b64_tr_b16 v[58:59], v20 offset:18944
    s_waitcnt lgkmcnt(4)
    v_mfma_f32_32x32x16_bf16 v[64:79], v[48:51], v[32:35], v[64:79]
    v_mfma_f32_32x32x16_bf16 v[80:95], v[48:51], v[36:39], v[80:95]
    ds_read_b128 v[32:35], v16 offset:32768
    ds_read_b128 v[36:39], v16 offset:34816
    ds_read_b64_tr_b16 v[48:49], v20 offset:32768
    ds_read_b64_tr_b16 v[50:51], v20 offset:33280
    s_waitcnt lgkmcnt(4)
    v_mfma_f32_32x32x16_bf16 v[64:79], v[56:59], v[40:43], v[64:79]
    v_mfma_f32_32x32x16_bf16 v[80:95], v[56:59], v[44:47], v[80:95]
    s_waitcnt vmcnt(3)
    s_barrier
    s_add_u32 m0, s38, 16384
    s_nop 0
    buffer_load_dwordx4 v21, s[40:43], s28 offen lds
    s_add_u32 m0, s38, 20480
    s_nop 0
    buffer_load_dwordx4 v21, s[40:43], s29 offen lds
    s_add_u32 m0, s38, 24576
    s_nop 0
    buffer_load_dwordx4 v22, s[12:15], s32 offen lds
    s_add_u32 s28, s28, 64
    s_add_u32 s29, s29, 64
    s_add_u32 s32, s32, s36
    ds_read_b128 v[40:43], v17 offset:32768
    ds_read_b128 v[44:47], v17 offset:34816
    ds_read_b64_tr_b16 v[56:57], v20 offset:34816
    ds_read_b64_tr_b16 v[58:59], v20 offset:35328
    s_waitcnt lgkmcnt(4)
    v_mfma_f32_32x32x16_bf16 v[64:79], v[48:51], v[32:35], v[64:79]
    v_mfma_f32_32x32x16_bf16 v[80:95], v[48:51], v[36:39], v[80:95]
    ds_read_b128 v[32:35], v16 offset:49152
    ds_read_b128 v[36:39], v16 offset:51200
    ds_read_b64_tr_b16 v[48:49], v20 offset:49152
    ds_read_b64_tr_b16 v[50:51], v20 offset:49664
    s_waitcnt lgkmcnt(4)
    v_mfma_f32_32x32x16_bf16 v[64:79], v[56:59], v[40:43], v[64:79]
    v_mfma_f32_32x32x16_bf16 v[80:95], v[56:59], v[44:47], v[80:95]
    s_waitcnt vmcnt(3)
    s_barrier
    s_add_u32 m0, s38, 32768
    s_nop 0
    buffer_load_dwordx4 v21, s[40:43], s28 offen lds
    s_add_u32 m0, s38, 36864
    s_nop 0
    buffer_load_dwordx4 v21, s[40:43], s29 offen lds
    s_add_u32 m0, s38, 40960
    s_nop 0
    buffer_load_dwordx4 v22, s[12:15], s32 offen lds
    s_add_u32 s28, s28, 64
    s_add_u32 s29, s29, 64
    s_add_u32 s32, s32, s36
    ds_read_b128 v[40:43], v17 offset:49152
    ds_read_b128 v[44:47], v17 offset:51200
    ds_read_b64_tr_b16 v[56:57], v20 offset:51200
    ds_read_b64_tr_b16 v[58:59], v20 offset:51712
    s_waitcnt lgkmcnt(4)
    v_mfma_f32_32x32x16_bf16 v[64:79], v[48:51], v[32:35], v[64:79]
    v_mfma_f32_32x32x16_bf16 v[80:95], v[48:51], v[36:39], v[80:95]
    ds_read_b128 v[32:35], v16 offset:0
    ds_read_b128 v[36:39], v16 offset:2048
    ds_read_b64_tr_b16 v[48:49], v20 offset:0
    ds_read_b64_tr_b16 v[50:51], v20 offset:512
    s_waitcnt lgkmcnt(4)
    v_mfma_f32_32x32x16_bf16 v[64:79], v[56:59], v[40:43], v[64:79]
    v_mfma_f32_32x32x16_bf16 v[80:95], v[56:59], v[44:47], v[80:95]
    s_waitcnt vmcnt(3)
    s_barrier
    s_add_u32 m0, s38, 49152
    s_nop 0
    buffer_load_dwordx4 v21, s[40:43], s28 offen lds
    s_add_u32 m0, s38, 53248
    s_nop 0
    buffer_load_dwordx4 v21, s[40:43], s29 offen lds
    s_add_u32 m0, s38, 57344
    s_nop 0
    buffer_load_dwordx4 v22, s[12:15], s32 offen lds
    s_add_u32 s28, s28, 64
    s_add_u32 s29, s29, 64
    s_add_u32 s32, s32, s36
    ds_read_b128 v[40:43], v17 offset:0
    ds_read_b128 v[44:47], v17 offset:2048
    ds_read_b64_tr_b16 v[56:57], v20 offset:2048
    ds_read_b64_tr_b16 v[58:59], v20 offset:2560
    s_waitcnt lgkmcnt(4)
    v_mfma_f32_32x32x16_bf16 v[64:79], v[48:51], v[32:35], v[64:79]
    v_mfma_f32_32x32x16_bf16 v[80:95], v[48:51], v[36:39], v[80:95]
    ds_read_b128 v[32:35], v16 offset:16384
    ds_read_b128 v[36:39], v16 offset:18432
    ds_read_b64_tr_b16 v[48:49], v20 offset:16384
    ds_read_b64_tr_b16 v[50:51], v20 offset:16896
    s_waitcnt lgkmcnt(4)
    v_mfma_f32_32x32x16_bf16 v[64:79], v[56:59], v[40:43], v[64:79]
    v_mfma_f32_32x32x16_bf16 v[80:95], v[56:59], v[44:47], v[80:95]
    s_waitcnt vmcnt(3)
    s_barrier
    ds_read_b128 v[40:43], v17 offset:16384
    ds_read_b128 v[44:47], v17 offset:18432
    ds_read_b64_tr_b16 v[56:57], v20 offset:18432
    ds_read_b64_tr_b16 v[58:59], v20 offset:18944
    s_waitcnt lgkmcnt(4)
    v_mfma_f32_32x32x16_bf16 v[64:79], v[48:51], v[32:35], v[64:79]
    v_mfma_f32_32x32x16_bf16 v[80:95], v[48:51], v[36:39], v[80:95]
    ds_read_b128 v[32:35], v16 offset:32768
    ds_read_b128 v[36:39], v16 offset:34816
    ds_read_b64_tr_b16 v[48:49], v20 offset:32768
    ds_read_b64_tr_b16 v[50:51], v20 offset:33280
    s_waitcnt lgkmcnt(4)
    v_mfma_f32_32x32x16_bf16 v[64:79], v[56:59], v[40:43], v[64:79]
    v_mfma_f32_32x32x16_bf16 v[80:95], v[56:59], v[44:47], v[80:95]
    s_waitcnt vmcnt(0)
    s_barrier
    ds_read_b128 v[40:43], v17 offset:32768
    ds_read_b128 v[44:47], v17 offset:34816
    ds_read_b64_tr_b16 v[56:57], v20 offset:34816
    ds_read_b64_tr_b16 v[58:59], v20 offset:35328
    s_waitcnt lgkmcnt(4)
    v_mfma_f32_32x32x16_bf16 v[64:79], v[48:51], v[32:35], v[64:79]
    v_mfma_f32_32x32x16_bf16 v[80:95], v[48:51], v[36:39], v[80:95]
    ds_read_b128 v[32:35], v16 offset:49152
    ds_read_b128 v[36:39], v16 offset:51200
    ds_read_b64_tr_b16 v[48:49], v20 offset:49152
    ds_read_b64_tr_b16 v[50:51], v20 offset:49664
    s_waitcnt lgkmcnt(4)
    v_mfma_f32_32x32x16_bf16 v[64:79], v[56:59], v[40:43], v[64:79]
    v_mfma_f32_32x32x16_bf16 v[80:95], v[56:59], v[44:47], v[80:95]
    ds_read_b128 v[40:43], v17 offset:49152
    ds_read_b128 v[44:47], v17 offset:51200
    ds_read_b64_tr_b16 v[56:57], v20 offset:51200
    ds_read_b64_tr_b16 v[58:59], v20 offset:51712
    s_waitcnt lgkmcnt(4)
    v_mfma_f32_32x32x16_bf16 v[64:79], v[48:51], v[32:35], v[64:79]
    v_mfma_f32_32x32x16_bf16 v[80:95], v[48:51], v[36:39], v[80:95]
    s_waitcnt lgkmcnt(0)
    v_mfma_f32_32x32x16_bf16 v[64:79], v[56:59], v[40:43], v[64:79]
    v_mfma_f32_32x32x16_bf16 v[80:95], v[56:59], v[44:47], v[80:95]
    s_nop 15
    s_nop 3
    buffer_load_dwordx2 v[32:33], v25, s[52:55], s49 offen offset:0
    buffer_load_dwordx2 v[40:41], v25, s[8:11], s48 offen offset:0
    buffer_load_dwordx2 v[34:35], v25, s[52:55], s49 offen offset:16
    buffer_load_dwordx2 v[42:43], v25, s[8:11], s48 offen offset:16
    buffer_load_dwordx2 v[36:37], v25, s[52:55], s49 offen offset:32
    buffer_load_dwordx2 v[44:45], v25, s[8:11], s48 offen offset:32
    buffer_load_dwordx2 v[38:39], v25, s[52:55], s49 offen offset:48
    buffer_load_dwordx2 v[46:47], v25, s[8:11], s48 offen offset:48
    s_waitcnt vmcnt(0)
    v_cvt_pk_bf16_f32 v10, v64, v64
    v_lshlrev_b32 v10, 16, v10
    v_lshlrev_b32 v11, 16, v32
    v_lshlrev_b32 v3, 16, v40
    v_add_f32 v10, v10, v11
    v_cvt_pk_bf16_f32 v10, v10, v10
    v_lshlrev_b32 v10, 16, v10
    v_add_f32 v4, v10, v3
    v_cvt_pk_bf16_f32 v10, v65, v65
    v_lshlrev_b32 v10, 16, v10
    v_and_b32 v11, 0xffff0000, v32
    v_and_b32 v3, 0xffff0000, v40
    v_add_f32 v10, v10, v11
    v_cvt_pk_bf16_f32 v10, v10, v10
    v_lshlrev_b32 v10, 16, v10
    v_add_f32 v5, v10, v3
    v_cvt_pk_bf16_f32 v10, v66, v66
    v_lshlrev_b32 v10, 16, v10
    v_lshlrev_b32 v11, 16, v33
    v_lshlrev_b32 v3, 16, v41
    v_add_f32 v10, v10, v11
    v_cvt_pk_bf16_f32 v10, v10, v10
    v_lshlrev_b32 v10, 16, v10
    v_add_f32 v6, v10, v3
    v_cvt_pk_bf16_f32 v10, v67, v67
    v_lshlrev_b32 v10, 16, v10
    v_and_b32 v11, 0xffff0000, v33
    v_and_b32 v3, 0xffff0000, v41
    v_add_f32 v10, v10, v11
    v_cvt_pk_bf16_f32 v10, v10, v10
    v_lshlrev_b32 v10, 16, v10
    v_add_f32 v7, v10, v3
    v_cvt_pk_bf16_f32 v12, v4, v5
    v_cvt_pk_bf16_f32 v13, v6, v7
    buffer_store_dwordx2 v[12:13], v25, s[56:59], s49 offen offset:0
    v_cvt_pk_bf16_f32 v10, v68, v68
    v_lshlrev_b32 v10, 16, v10
    v_lshlrev_b32 v11, 16, v34
    v_lshlrev_b32 v3, 16, v42
    v_add_f32 v10, v10, v11
    v_cvt_pk_bf16_f32 v10, v10, v10
    v_lshlrev_b32 v10, 16, v10
    v_add_f32 v4, v10, v3
    v_cvt_pk_bf16_f32 v10, v69, v69
    v_lshlrev_b32 v10, 16, v10
    v_and_b32 v11, 0xffff0000, v34
    v_and_b32 v3, 0xffff0000, v42
    v_add_f32 v10, v10, v11
    v_cvt_pk_bf16_f32 v10, v10, v10
    v_lshlrev_b32 v10, 16, v10
    v_add_f32 v5, v10, v3
    v_cvt_pk_bf16_f32 v10, v70, v70
    v_lshlrev_b32 v10, 16, v10
    v_lshlrev_b32 v11, 16, v35
    v_lshlrev_b32 v3, 16, v43
    v_add_f32 v10, v10, v11
    v_cvt_pk_bf16_f32 v10, v10, v10
    v_lshlrev_b32 v10, 16, v10
    v_add_f32 v6, v10, v3
    v_cvt_pk_bf16_f32 v10, v71, v71
    v_lshlrev_b32 v10, 16, v10
    v_and_b32 v11, 0xffff0000, v35
    v_and_b32 v3, 0xffff0000, v43
    v_add_f32 v10, v10, v11
    v_cvt_pk_bf16_f32 v10, v10, v10
    v_lshlrev_b32 v10, 16, v10
    v_add_f32 v7, v10, v3
    v_cvt_pk_bf16_f32 v14, v4, v5
    v_cvt_pk_bf16_f32 v15, v6, v7
    buffer_store_dwordx2 v[14:15], v25, s[56:59], s49 offen offset:16
    v_cvt_pk_bf16_f32 v10, v72, v72
    v_lshlrev_b32 v10, 16, v10
    v_lshlrev_b32 v11, 16, v36
    v_lshlrev_b32 v3, 16, v44
    v_add_f32 v10, v10, v11
    v_cvt_pk_bf16_f32 v10, v10, v10
    v_lshlrev_b32 v10, 16, v10
    v_add_f32 v4, v10, v3
    v_cvt_pk_bf16_f32 v10, v73, v73
    v_lshlrev_b32 v10, 16, v10
    v_and_b32 v11, 0xffff0000, v36
    v_and_b32 v3, 0xffff0000, v44
    v_add_f32 v10, v10, v11
    v_cvt_pk_bf16_f32 v10, v10, v10
    v_lshlrev_b32 v10, 16, v10
    v_add_f32 v5, v10, v3
    v_cvt_pk_bf16_f32 v10, v74, v74
    v_lshlrev_b32 v10, 16, v10
    v_lshlrev_b32 v11, 16, v37
    v_lshlrev_b32 v3, 16, v45
    v_add_f32 v10, v10, v11
    v_cvt_pk_bf16_f32 v10, v10, v10
    v_lshlrev_b32 v10, 16, v10
    v_add_f32 v6, v10, v3
    v_cvt_pk_bf16_f32 v10, v75, v75
    v_lshlrev_b32 v10, 16, v10
    v_and_b32 v11, 0xffff0000, v37
    v_and_b32 v3, 0xffff0000, v45
    v_add_f32 v10, v10, v11
    v_cvt_pk_bf16_f32 v10, v10, v10
    v_lshlrev_b32 v10, 16, v10
    v_add_f32 v7, v10, v3
    v_cvt_pk_bf16_f32 v12, v4, v5
    v_cvt_pk_bf16_f32 v13, v6, v7
    buffer_store_dwordx2 v[12:13], v25, s[56:59], s49 offen offset:32
    v_cvt_pk_bf16_f32 v10, v76, v76
    v_lshlrev_b32 v10, 16, v10
    v_lshlrev_b32 v11, 16, v38
    v_lshlrev_b32 v3, 16, v46
    v_add_f32 v10, v10, v11
    v_cvt_pk_bf16_f32 v10, v10, v10
    v_lshlrev_b32 v10, 16, v10
    v_add_f32 v4, v10, v3
    v_cvt_pk_bf16_f32 v10, v77, v77
    v_lshlrev_b32 v10, 16, v10
    v_and_b32 v11, 0xffff0000, v38
    v_and_b32 v3, 0xffff0000, v46
    v_add_f32 v10, v10, v11
    v_cvt_pk_bf16_f32 v10, v10, v10
    v_lshlrev_b32 v10, 16, v10
    v_add_f32 v5, v10, v3
    v_cvt_pk_bf16_f32 v10, v78, v78
    v_lshlrev_b32 v10, 16, v10
    v_lshlrev_b32 v11, 16, v39
    v_lshlrev_b32 v3, 16, v47
    v_add_f32 v10, v10, v11
    v_cvt_pk_bf16_f32 v10, v10, v10
    v_lshlrev_b32 v10, 16, v10
    v_add_f32 v6, v10, v3
    v_cvt_pk_bf16_f32 v10, v79, v79
    v_lshlrev_b32 v10, 16, v10
    v_and_b32 v11, 0xffff0000, v39
    v_and_b32 v3, 0xffff0000, v47
    v_add_f32 v10, v10, v11
    v_cvt_pk_bf16_f32 v10, v10, v10
    v_lshlrev_b32 v10, 16, v10
    v_add_f32 v7, v10, v3
    v_cvt_pk_bf16_f32 v14, v4, v5
    v_cvt_pk_bf16_f32 v15, v6, v7
    buffer_store_dwordx2 v[14:15], v25, s[56:59], s49 offen offset:48
    buffer_load_dwordx2 v[32:33], v26, s[52:55], s49 offen offset:0
    buffer_load_dwordx2 v[40:41], v26, s[8:11], s48 offen offset:0
    buffer_load_dwordx2 v[34:35], v26, s[52:55], s49 offen offset:16
    buffer_load_dwordx2 v[42:43], v26, s[8:11], s48 offen offset:16
    buffer_load_dwordx2 v[36:37], v26, s[52:55], s49 offen offset:32
    buffer_load_dwordx2 v[44:45], v26, s[8:11], s48 offen offset:32
    buffer_load_dwordx2 v[38:39], v26, s[52:55], s49 offen offset:48
    buffer_load_dwordx2 v[46:47], v26, s[8:11], s48 offen offset:48
    s_waitcnt vmcnt(0)
    v_cvt_pk_bf16_f32 v10, v80, v80
    v_lshlrev_b32 v10, 16, v10
    v_lshlrev_b32 v11, 16, v32
    v_lshlrev_b32 v3, 16, v40
    v_add_f32 v10, v10, v11
    v_cvt_pk_bf16_f32 v10, v10, v10
    v_lshlrev_b32 v10, 16, v10
    v_add_f32 v4, v10, v3
    v_cvt_pk_bf16_f32 v10, v81, v81
    v_lshlrev_b32 v10, 16, v10
    v_and_b32 v11, 0xffff0000, v32
    v_and_b32 v3, 0xffff0000, v40
    v_add_f32 v10, v10, v11
    v_cvt_pk_bf16_f32 v10, v10, v10
    v_lshlrev_b32 v10, 16, v10
    v_add_f32 v5, v10, v3
    v_cvt_pk_bf16_f32 v10, v82, v82
    v_lshlrev_b32 v10, 16, v10
    v_lshlrev_b32 v11, 16, v33
    v_lshlrev_b32 v3, 16, v41
    v_add_f32 v10, v10, v11
    v_cvt_pk_bf16_f32 v10, v10, v10
    v_lshlrev_b32 v10, 16, v10
    v_add_f32 v6, v10, v3
    v_cvt_pk_bf16_f32 v10, v83, v83
    v_lshlrev_b32 v10, 16, v10
    v_and_b32 v11, 0xffff0000, v33
    v_and_b32 v3, 0xffff0000, v41
    v_add_f32 v10, v10, v11
    v_cvt_pk_bf16_f32 v10, v10, v10
    v_lshlrev_b32 v10, 16, v10
    v_add_f32 v7, v10, v3
    v_cvt_pk_bf16_f32 v12, v4, v5
    v_cvt_pk_bf16_f32 v13, v6, v7
    buffer_store_dwordx2 v[12:13], v26, s[56:59], s49 offen offset:0
    v_cvt_pk_bf16_f32 v10, v84, v84
    v_lshlrev_b32 v10, 16, v10
    v_lshlrev_b32 v11, 16, v34
    v_lshlrev_b32 v3, 16, v42
    v_add_f32 v10, v10, v11
    v_cvt_pk_bf16_f32 v10, v10, v10
    v_lshlrev_b32 v10, 16, v10
    v_add_f32 v4, v10, v3
    v_cvt_pk_bf16_f32 v10, v85, v85
    v_lshlrev_b32 v10, 16, v10
    v_and_b32 v11, 0xffff0000, v34
    v_and_b32 v3, 0xffff0000, v42
    v_add_f32 v10, v10, v11
    v_cvt_pk_bf16_f32 v10, v10, v10
    v_lshlrev_b32 v10, 16, v10
    v_add_f32 v5, v10, v3
    v_cvt_pk_bf16_f32 v10, v86, v86
    v_lshlrev_b32 v10, 16, v10
    v_lshlrev_b32 v11, 16, v35
    v_lshlrev_b32 v3, 16, v43
    v_add_f32 v10, v10, v11
    v_cvt_pk_bf16_f32 v10, v10, v10
    v_lshlrev_b32 v10, 16, v10
    v_add_f32 v6, v10, v3
    v_cvt_pk_bf16_f32 v10, v87, v87
    v_lshlrev_b32 v10, 16, v10
    v_and_b32 v11, 0xffff0000, v35
    v_and_b32 v3, 0xffff0000, v43
    v_add_f32 v10, v10, v11
    v_cvt_pk_bf16_f32 v10, v10, v10
    v_lshlrev_b32 v10, 16, v10
    v_add_f32 v7, v10, v3
    v_cvt_pk_bf16_f32 v14, v4, v5
    v_cvt_pk_bf16_f32 v15, v6, v7
    buffer_store_dwordx2 v[14:15], v26, s[56:59], s49 offen offset:16
    v_cvt_pk_bf16_f32 v10, v88, v88
    v_lshlrev_b32 v10, 16, v10
    v_lshlrev_b32 v11, 16, v36
    v_lshlrev_b32 v3, 16, v44
    v_add_f32 v10, v10, v11
    v_cvt_pk_bf16_f32 v10, v10, v10
    v_lshlrev_b32 v10, 16, v10
    v_add_f32 v4, v10, v3
    v_cvt_pk_bf16_f32 v10, v89, v89
    v_lshlrev_b32 v10, 16, v10
    v_and_b32 v11, 0xffff0000, v36
    v_and_b32 v3, 0xffff0000, v44
    v_add_f32 v10, v10, v11
    v_cvt_pk_bf16_f32 v10, v10, v10
    v_lshlrev_b32 v10, 16, v10
    v_add_f32 v5, v10, v3
    v_cvt_pk_bf16_f32 v10, v90, v90
    v_lshlrev_b32 v10, 16, v10
    v_lshlrev_b32 v11, 16, v37
    v_lshlrev_b32 v3, 16, v45
    v_add_f32 v10, v10, v11
    v_cvt_pk_bf16_f32 v10, v10, v10
    v_lshlrev_b32 v10, 16, v10
    v_add_f32 v6, v10, v3
    v_cvt_pk_bf16_f32 v10, v91, v91
    v_lshlrev_b32 v10, 16, v10
    v_and_b32 v11, 0xffff0000, v37
    v_and_b32 v3, 0xffff0000, v45
    v_add_f32 v10, v10, v11
    v_cvt_pk_bf16_f32 v10, v10, v10
    v_lshlrev_b32 v10, 16, v10
    v_add_f32 v7, v10, v3
    v_cvt_pk_bf16_f32 v12, v4, v5
    v_cvt_pk_bf16_f32 v13, v6, v7
    buffer_store_dwordx2 v[12:13], v26, s[56:59], s49 offen offset:32
    v_cvt_pk_bf16_f32 v10, v92, v92
    v_lshlrev_b32 v10, 16, v10
    v_lshlrev_b32 v11, 16, v38
    v_lshlrev_b32 v3, 16, v46
    v_add_f32 v10, v10, v11
    v_cvt_pk_bf16_f32 v10, v10, v10
    v_lshlrev_b32 v10, 16, v10
    v_add_f32 v4, v10, v3
    v_cvt_pk_bf16_f32 v10, v93, v93
    v_lshlrev_b32 v10, 16, v10
    v_and_b32 v11, 0xffff0000, v38
    v_and_b32 v3, 0xffff0000, v46
    v_add_f32 v10, v10, v11
    v_cvt_pk_bf16_f32 v10, v10, v10
    v_lshlrev_b32 v10, 16, v10
    v_add_f32 v5, v10, v3
    v_cvt_pk_bf16_f32 v10, v94, v94
    v_lshlrev_b32 v10, 16, v10
    v_lshlrev_b32 v11, 16, v39
    v_lshlrev_b32 v3, 16, v47
    v_add_f32 v10, v10, v11
    v_cvt_pk_bf16_f32 v10, v10, v10
    v_lshlrev_b32 v10, 16, v10
    v_add_f32 v6, v10, v3
    v_cvt_pk_bf16_f32 v10, v95, v95
    v_lshlrev_b32 v10, 16, v10
    v_and_b32 v11, 0xffff0000, v39
    v_and_b32 v3, 0xffff0000, v47
    v_add_f32 v10, v10, v11
    v_cvt_pk_bf16_f32 v10, v10, v10
    v_lshlrev_b32 v10, 16, v10
    v_add_f32 v7, v10, v3
    v_cvt_pk_bf16_f32 v14, v4, v5
    v_cvt_pk_bf16_f32 v15, v6, v7
    buffer_store_dwordx2 v[14:15], v26, s[56:59], s49 offen offset:48
g2_end:
    s_endpgm
.section .rodata,"a"
.p2align 6
.amdhsa_kernel ln_kernel
  .amdhsa_next_free_vgpr 48
  .amdhsa_next_free_sgpr 102
  .amdhsa_accum_offset 48
  .amdhsa_group_segment_fixed_size 0
  .amdhsa_kernarg_size 80
  .amdhsa_user_sgpr_count 2
  .amdhsa_user_sgpr_kernarg_segment_ptr 1
  .amdhsa_system_sgpr_workgroup_id_x 1
.end_amdhsa_kernel
.p2align 6
.amdhsa_kernel gemm1_kernel
  .amdhsa_next_free_vgpr 240
  .amdhsa_next_free_sgpr 102
  .amdhsa_accum_offset 240
  .amdhsa_group_segment_fixed_size 0
  .amdhsa_kernarg_size 80
  .amdhsa_user_sgpr_count 2
  .amdhsa_user_sgpr_kernarg_segment_ptr 1
  .amdhsa_system_sgpr_workgroup_id_x 1
.end_amdhsa_kernel
.p2align 6
.amdhsa_kernel attn_kernel
  .amdhsa_next_free_vgpr 128
  .amdhsa_next_free_sgpr 102
  .amdhsa_accum_offset 128
  .amdhsa_group_segment_fixed_size 0
  .amdhsa_kernarg_size 80
  .amdhsa_user_sgpr_count 2
  .amdhsa_user_sgpr_kernarg_segment_ptr 1
  .amdhsa_system_sgpr_workgroup_id_x 1
.end_amdhsa_kernel
.p2align 6
.amdhsa_kernel gemm2_kernel
  .amdhsa_next_free_vgpr 128
  .amdhsa_next_free_sgpr 102
  .amdhsa_accum_offset 128
  .amdhsa_group_segment_fixed_size 0
  .amdhsa_kernarg_size 80
  .amdhsa_user_sgpr_count 2
  .amdhsa_user_sgpr_kernarg_segment_ptr 1
  .amdhsa_system_sgpr_workgroup_id_x 1
.end_amdhsa_kernel
```
